```python
import torch

def _softmax(x, axis=-1):
    return torch.softmax(x, dim=axis)
def _gelu(x):
    return torch.nn.functional.gelu(x, approximate="tanh")
def _silu(x):
    return torch.nn.functional.silu(x)
def _sigmoid(x):
    return torch.sigmoid(x)
def _layernorm(x, axis=-1, eps=1e-5):
    m = x.mean(dim=axis, keepdim=True)
    v = x.var(dim=axis, keepdim=True, unbiased=False)
    return (x - m) / torch.sqrt(v + eps)
def _scatter_add(tgt, idx, src, axis=0):
    return tgt.clone().index_add_(axis, idx, src)
def _segment_sum(src, seg, n):
    out = torch.zeros((n,) + src.shape[1:], dtype=src.dtype)
    return out.index_add_(0, seg, src)
def _pad(x, pw):
    flat = tuple(v for pair in reversed(pw) for v in pair)
    return torch.nn.functional.pad(x, flat)

kernel_name = 'interleave_layers__grouped_kv_mqa__sliding_local_dilated__prompt'

def setup_inputs():

    _w = (lambda a: (lambda t: t.to(torch.bfloat16) if t.is_floating_point() else t)(torch.as_tensor(a)))
    def _A_setup():
        B, S, D, H = 1, 2048, 512, 32
        Dh = D // H
        return {
            "x": _w((lambda *s: torch.randn(*s, dtype=torch.bfloat16) * 0.05)(B, S, D)),
            "wq": _w((lambda *s: torch.randn(*s, dtype=torch.bfloat16) * 0.05)(D, H * Dh)),
            "wk": _w((lambda *s: torch.randn(*s, dtype=torch.bfloat16) * 0.05)(D, Dh)),
            "wv": _w((lambda *s: torch.randn(*s, dtype=torch.bfloat16) * 0.05)(D, Dh)),
            "wo": _w((lambda *s: torch.randn(*s, dtype=torch.bfloat16) * 0.05)(H * Dh, D)),
        }
    _A_in = _A_setup()

    def _B_setup():
        B, S, D = 1, 2048, 512
        return {
            "x": _w((lambda *s: torch.randn(*s, dtype=torch.bfloat16) * 0.05)(B, S, D)),
            "wqkv": _w((lambda *s: torch.randn(*s, dtype=torch.bfloat16) * 0.05)(D, 3 * D)),
            "wo": _w((lambda *s: torch.randn(*s, dtype=torch.bfloat16) * 0.05)(D, D)),
        }
    _B_in = _B_setup()

    return {
        "A_x": _A_in["x"],
        "A_wq": _A_in["wq"],
        "A_wk": _A_in["wk"],
        "A_wv": _A_in["wv"],
        "A_wo": _A_in["wo"],
        "B_x": _B_in["x"],
        "B_wqkv": _B_in["wqkv"],
        "B_wo": _B_in["wo"],
    }

def reference(A_x, A_wq, A_wk, A_wv, A_wo, B_x, B_wqkv, B_wo):
    def _A_ref(x, wq, wk, wv, wo):
        B, S, D = x.shape
        H = 32
        Dh = D // H
        q = (lambda x, *d: x.permute(*d))((x @ wq).reshape(B, S, H, Dh), 0, 2, 1, 3)
        k = x @ wk
        v = x @ wv
        scores = torch.einsum("bhqd,bkd->bhqk", q, k) * (Dh ** -0.5)
        p = _softmax(scores, axis=-1)
        o = torch.einsum("bhqk,bkd->bhqd", p, v)
        return (lambda x, *d: x.permute(*d))(o, 0, 2, 1, 3).reshape(B, S, H * Dh) @ wo

    def _B_ref(x, wqkv, wo):
        B, S, D = x.shape
        H = 32; Dh = D // H
        W, dil = 8, 2
        qkv = (lambda x, *d: x.permute(*d))((x @ wqkv).reshape(B, S, 3, H, Dh), 2, 0, 3, 1, 4)
        q, k, v = qkv[0], qkv[1], qkv[2]
        scale = Dh ** -0.5
        pos = torch.arange(S)
        off = torch.arange(W) * dil
        idx = pos[:, None] - off[None, :]
        mask = idx >= 0
        idx_c = torch.where(mask, idx, 0).reshape(-1)
        kg = k[:, :, idx_c, :].reshape(B, H, S, W, Dh)
        vg = v[:, :, idx_c, :].reshape(B, H, S, W, Dh)
        logits = torch.einsum("bhsd,bhswd->bhsw", q, kg) * scale
        logits = torch.where(mask[None, None, :, :], logits, -1e9)
        attn = _softmax(logits, axis=-1)
        o = torch.einsum("bhsw,bhswd->bhsd", attn, vg)
        return (lambda x, *d: x.permute(*d))(o, 0, 2, 1, 3).reshape(B, S, D) @ wo

    x = A_x
    x = x + _A_ref(_layernorm(x, axis=-1), A_wq, A_wk, A_wv, A_wo)
    x = x + _B_ref(_layernorm(x, axis=-1), B_wqkv, B_wo)
    x = x + _A_ref(_layernorm(x, axis=-1), A_wq, A_wk, A_wv, A_wo)
    x = x + _B_ref(_layernorm(x, axis=-1), B_wqkv, B_wo)
    return x
```

```asm
; @launch grid=(256,1,1) block=(256,1,1) lds=163840
.amdgcn_target "amdgcn-amd-amdhsa--gfx950"
.text
.globl interleave_layers__grouped_kv_mqa__sliding_local_dilated__prompt_kernel
.p2align 8
.type interleave_layers__grouped_kv_mqa__sliding_local_dilated__prompt_kernel,@function
interleave_layers__grouped_kv_mqa__sliding_local_dilated__prompt_kernel:
    s_cmp_ge_u32 s2, 256
    s_cbranch_scc1 L_end_interleave_layers__grouped_kv_mqa__sliding_local_dilated__prompt_kernel
    s_load_dwordx2 s[4:5], s[0:1], 80
    s_load_dwordx2 s[6:7], s[0:1], 0
    s_load_dwordx4 s[40:43], s[0:1], 16
    s_load_dwordx2 s[56:57], s[0:1], 8
    s_load_dwordx2 s[46:47], s[0:1], 32
    s_load_dwordx4 s[60:63], s[0:1], 48
    v_lshrrev_b32 v1, 6, v0
    v_and_b32 v0, 63, v0
    s_and_b32 s20, s2, 7
    s_lshr_b32 s21, s2, 3
    s_lshl_b32 s20, s20, 2
    s_lshr_b32 s23, s21, 3
    s_add_u32 s20, s20, s23
    s_and_b32 s21, s21, 7
    v_readfirstlane_b32 s22, v1
    v_lshlrev_b32 v1, 4, v0
    s_waitcnt lgkmcnt(0)
    s_mov_b32 s8, s4
    s_mov_b32 s9, s5
    s_mov_b32 s10, 33554432
    s_mov_b32 s11, 0x00020000
    s_add_u32 s28, s4, 26316800
    s_addc_u32 s29, s5, 0
    s_load_dwordx2 s[100:101], s[28:29], 0
    s_mov_b32 s12, s6
    s_mov_b32 s13, s7
    s_mov_b32 s14, 2097152
    s_mov_b32 s15, 0x00020000
    s_mov_b32 s55, 0
    s_lshr_b32 s23, s21, 1
    s_add_u32 s23, s23, 0
    s_and_b32 s23, s23, 3
    s_lshl_b32 s23, s23, 2
    s_add_u32 s23, s23, s22
    s_lshl_b32 s23, s23, 2
    s_mul_i32 s24, s23, 1040
    s_add_u32 m0, s24, 74752
    s_lshl_b32 s24, s20, 6
    s_add_u32 s23, s23, s24
    s_lshl_b32 s23, s23, 10
    buffer_load_dwordx4 v1, s[12:15], s23 offen lds
    s_add_u32 m0, m0, 1040
    s_add_u32 s23, s23, 1024
    buffer_load_dwordx4 v1, s[12:15], s23 offen lds
    s_add_u32 m0, m0, 1040
    s_add_u32 s23, s23, 1024
    buffer_load_dwordx4 v1, s[12:15], s23 offen lds
    s_add_u32 m0, m0, 1040
    s_add_u32 s23, s23, 1024
    buffer_load_dwordx4 v1, s[12:15], s23 offen lds
    v_and_b32 v6, 15, v0
    v_lshrrev_b32 v7, 4, v0
    v_mov_b32 v8, 0x3f803f80
    v_mov_b32 v9, 0x3f803f80
    v_mov_b32 v10, 0x3f803f80
    v_mov_b32 v11, 0x3f803f80
    v_lshrrev_b32 v24, 2, v6
    v_lshlrev_b32 v24, 3, v24
    v_and_b32 v25, 3, v6
    v_add_u32 v24, v24, v25
    v_lshrrev_b32 v25, 1, v7
    v_lshl_add_u32 v24, v25, 2, v24
    v_and_b32 v25, 1, v7
    v_lshlrev_b32 v25, 4, v25
    s_bitcmp1_b32 s21, 0
    s_cselect_b32 s28, s42, s40
    s_cselect_b32 s29, s43, s41
    v_lshl_add_u32 v142, v24, 5, v25
    s_lshl_b32 s23, s22, 12
    v_add_u32 v142, s23, v142
    global_load_dwordx4 a[64:67], v142, s[28:29] offset:0
    global_load_dwordx4 a[68:71], v142, s[28:29] offset:1024
    global_load_dwordx4 a[72:75], v142, s[28:29] offset:2048
    global_load_dwordx4 a[76:79], v142, s[28:29] offset:3072
    s_lshr_b32 s23, s21, 1
    s_add_u32 s23, s23, 1
    s_and_b32 s23, s23, 3
    s_lshl_b32 s23, s23, 2
    s_add_u32 s23, s23, s22
    s_lshl_b32 s23, s23, 2
    s_mul_i32 s24, s23, 1040
    s_add_u32 m0, s24, 74752
    s_lshl_b32 s24, s20, 6
    s_add_u32 s23, s23, s24
    s_lshl_b32 s23, s23, 10
    buffer_load_dwordx4 v1, s[12:15], s23 offen lds
    s_add_u32 m0, m0, 1040
    s_add_u32 s23, s23, 1024
    buffer_load_dwordx4 v1, s[12:15], s23 offen lds
    s_add_u32 m0, m0, 1040
    s_add_u32 s23, s23, 1024
    buffer_load_dwordx4 v1, s[12:15], s23 offen lds
    s_add_u32 m0, m0, 1040
    s_add_u32 s23, s23, 1024
    buffer_load_dwordx4 v1, s[12:15], s23 offen lds
    s_lshr_b32 s23, s21, 1
    s_add_u32 s23, s23, 2
    s_and_b32 s23, s23, 3
    s_lshl_b32 s23, s23, 2
    s_add_u32 s23, s23, s22
    s_lshl_b32 s23, s23, 2
    s_mul_i32 s24, s23, 1040
    s_add_u32 m0, s24, 74752
    s_lshl_b32 s24, s20, 6
    s_add_u32 s23, s23, s24
    s_lshl_b32 s23, s23, 10
    buffer_load_dwordx4 v1, s[12:15], s23 offen lds
    s_add_u32 m0, m0, 1040
    s_add_u32 s23, s23, 1024
    buffer_load_dwordx4 v1, s[12:15], s23 offen lds
    s_add_u32 m0, m0, 1040
    s_add_u32 s23, s23, 1024
    buffer_load_dwordx4 v1, s[12:15], s23 offen lds
    s_add_u32 m0, m0, 1040
    s_add_u32 s23, s23, 1024
    buffer_load_dwordx4 v1, s[12:15], s23 offen lds
    s_lshr_b32 s23, s21, 1
    s_add_u32 s23, s23, 3
    s_and_b32 s23, s23, 3
    s_lshl_b32 s23, s23, 2
    s_add_u32 s23, s23, s22
    s_lshl_b32 s23, s23, 2
    s_mul_i32 s24, s23, 1040
    s_add_u32 m0, s24, 74752
    s_lshl_b32 s24, s20, 6
    s_add_u32 s23, s23, s24
    s_lshl_b32 s23, s23, 10
    buffer_load_dwordx4 v1, s[12:15], s23 offen lds
    s_add_u32 m0, m0, 1040
    s_add_u32 s23, s23, 1024
    buffer_load_dwordx4 v1, s[12:15], s23 offen lds
    s_add_u32 m0, m0, 1040
    s_add_u32 s23, s23, 1024
    buffer_load_dwordx4 v1, s[12:15], s23 offen lds
    s_add_u32 m0, m0, 1040
    s_add_u32 s23, s23, 1024
    buffer_load_dwordx4 v1, s[12:15], s23 offen lds
    v_lshrrev_b32 v26, 3, v0
    v_and_b32 v27, 7, v0
    v_and_b32 v28, 2, v26
    v_xor_b32 v27, v27, v28
    v_lshlrev_b32 v27, 4, v27
    v_lshl_add_u32 v26, v26, 10, v27
    s_lshl_b32 s23, s21, 7
    s_lshl_b32 s24, s22, 17
    s_add_u32 s23, s23, s24
    v_add_u32 v26, s23, v26
    v_xor_b32 v27, 64, v26
    s_lshl_b32 s24, s22, 14
    s_add_u32 m0, s24, 0
    v_add_u32 v28, 0, v26
    global_load_lds_dwordx4 v28, s[56:57]
    s_add_u32 m0, m0, 1024
    v_add_u32 v28, 8192, v26
    global_load_lds_dwordx4 v28, s[56:57]
    s_add_u32 m0, m0, 1024
    v_add_u32 v28, 16384, v27
    global_load_lds_dwordx4 v28, s[56:57]
    s_add_u32 m0, m0, 1024
    v_add_u32 v28, 24576, v27
    global_load_lds_dwordx4 v28, s[56:57]
    s_add_u32 m0, m0, 1024
    v_add_u32 v28, 32768, v26
    global_load_lds_dwordx4 v28, s[56:57]
    s_add_u32 m0, m0, 1024
    v_add_u32 v28, 40960, v26
    global_load_lds_dwordx4 v28, s[56:57]
    s_add_u32 m0, m0, 1024
    v_add_u32 v28, 49152, v27
    global_load_lds_dwordx4 v28, s[56:57]
    s_add_u32 m0, m0, 1024
    v_add_u32 v28, 57344, v27
    global_load_lds_dwordx4 v28, s[56:57]
    s_add_u32 m0, m0, 1024
    v_add_u32 v28, 65536, v26
    global_load_lds_dwordx4 v28, s[56:57]
    s_add_u32 m0, m0, 1024
    v_add_u32 v28, 73728, v26
    global_load_lds_dwordx4 v28, s[56:57]
    s_add_u32 m0, m0, 1024
    v_add_u32 v28, 81920, v27
    global_load_lds_dwordx4 v28, s[56:57]
    s_add_u32 m0, m0, 1024
    v_add_u32 v28, 90112, v27
    global_load_lds_dwordx4 v28, s[56:57]
    s_add_u32 m0, m0, 1024
    v_add_u32 v28, 98304, v26
    global_load_lds_dwordx4 v28, s[56:57]
    s_add_u32 m0, m0, 1024
    v_add_u32 v28, 106496, v26
    global_load_lds_dwordx4 v28, s[56:57]
    s_add_u32 m0, m0, 1024
    v_add_u32 v28, 114688, v27
    global_load_lds_dwordx4 v28, s[56:57]
    s_add_u32 m0, m0, 1024
    v_add_u32 v28, 122880, v27
    global_load_lds_dwordx4 v28, s[56:57]
    s_getpc_b64 s[28:29]
L_pc_anchor:
    s_add_u32 s28, s28, interleave_layers__grouped_kv_mqa__sliding_local_dilated__prompt_kernel-L_pc_anchor
    s_addc_u32 s29, s29, -1
    s_lshr_b32 s27, s2, 3
    s_lshl_b32 s27, s27, 2
    s_add_u32 s27, s27, s22
    s_lshl_b32 s27, s27, 9
    v_lshlrev_b32 v14, 6, v0
    v_add_u32 v14, s27, v14
    v_min_u32 v14, L_code_end-interleave_layers__grouped_kv_mqa__sliding_local_dilated__prompt_kernel-4, v14
    s_mov_b64 exec, 0xff
    global_load_dword v13, v14, s[28:29]
    s_mov_b64 exec, -1
    s_lshl_b32 s27, s20, 7
    s_lshl_b32 s28, s21, 3
    s_add_u32 s27, s27, s28
    s_add_u32 s27, s27, 26214400
    v_and_b32 v148, 7, v0
    v_lshlrev_b32 v148, 12, v148
    v_add_u32 v148, s27, v148
    s_lshl_b32 s28, s20, 3
    s_add_u32 s28, s28, s21
    s_lshl_b32 s28, s28, 3
    s_add_u32 s28, s28, 26230784
    v_min_u32 v149, 40, v0
    v_lshlrev_b32 v149, 11, v149
    v_add_u32 v149, s28, v149
    v_cmp_gt_u32 s[38:39], 8, v0
    s_nop 1
    v_cndmask_b32_e64 v148, v149, v148, s[38:39]
    s_lshl_b32 s28, s20, 7
    s_lshl_b32 s27, s21, 3
    s_add_u32 s28, s28, s27
    s_add_u32 s28, s28, 25985024
    v_lshl_add_u32 v149, v0, 13, s28
    v_subrev_u32 v147, 41, v0
    v_cmp_gt_u32 s[38:39], 2, v147
    s_nop 1
    v_cndmask_b32_e64 v148, v148, v149, s[38:39]
    s_cmp_eq_u32 s22, 0
    s_cselect_b64 exec, -1, 0
    buffer_load_dword v15, v148, s[8:11], 0 offen
    s_mov_b64 exec, -1
    s_mov_b32 s32, 0x22222222
    s_mov_b32 s33, 0x22222222
    s_mov_b32 s34, 0x44444444
    s_mov_b32 s35, 0x44444444
    s_mov_b32 s36, 0x88888888
    s_mov_b32 s37, 0x88888888
    v_lshrrev_b32 v48, 2, v6
    v_cmp_eq_u32 s[30:31], v48, v7
    v_lshlrev_b32 v29, 5, v6
    s_lshl_b32 s23, s22, 2
    s_add_u32 s23, s23, 155648
    v_add_u32 v29, s23, v29
    v_mov_b32 v48, 158720
    v_cndmask_b32_e64 v29, v48, v29, s[30:31]
    v_lshlrev_b32 v30, 5, v6
    v_add_u32 v30, 155648, v30
    s_lshl_b32 s23, s22, 7
    s_add_u32 s23, s23, 158208
    v_lshlrev_b32 v28, 2, v6
    v_add_u32 v28, s23, v28
    v_lshlrev_b32 v31, 4, v7
    v_add_u32 v31, s23, v31
    s_lshl_b32 s44, s20, 2
    s_lshr_b32 s28, s21, 1
    s_add_u32 s44, s44, s28
    v_and_b32 v16, 15, v0
    v_lshrrev_b32 v17, 4, v0
    v_and_b32 v19, 1, v16
    v_mov_b32 v20, 0x3f80
    v_lshlrev_b32 v19, 4, v19
    v_lshlrev_b32 v19, v19, v20
    v_and_b32 v18, 7, v16
    v_lshrrev_b32 v18, 1, v18
    v_lshrrev_b32 v20, 1, v17
    v_lshl_add_u32 v18, v20, 2, v18
    v_and_b32 v17, 1, v17
    v_lshrrev_b32 v16, 3, v16
    v_cmp_eq_u32 s[24:25], v17, v16
    v_mov_b32 v20, 0xff
    s_nop 0
    v_cndmask_b32_e64 v18, v20, v18, s[24:25]
    v_cmp_eq_u32 s[24:25], 0, v18
    s_nop 1
    v_cndmask_b32_e64 v158, 0, v19, s[24:25]
    v_cmp_eq_u32 s[24:25], 1, v18
    s_nop 1
    v_cndmask_b32_e64 v159, 0, v19, s[24:25]
    v_cmp_eq_u32 s[24:25], 2, v18
    s_nop 1
    v_cndmask_b32_e64 v160, 0, v19, s[24:25]
    v_cmp_eq_u32 s[24:25], 3, v18
    s_nop 1
    v_cndmask_b32_e64 v161, 0, v19, s[24:25]
    v_cmp_eq_u32 s[24:25], 4, v18
    s_nop 1
    v_cndmask_b32_e64 v162, 0, v19, s[24:25]
    v_cmp_eq_u32 s[24:25], 5, v18
    s_nop 1
    v_cndmask_b32_e64 v163, 0, v19, s[24:25]
    v_cmp_eq_u32 s[24:25], 6, v18
    s_nop 1
    v_cndmask_b32_e64 v164, 0, v19, s[24:25]
    v_cmp_eq_u32 s[24:25], 7, v18
    s_nop 1
    v_cndmask_b32_e64 v165, 0, v19, s[24:25]
    s_bitcmp1_b32 s21, 0
    s_cselect_b64 s[38:39], -1, 0
    v_lshrrev_b32 v48, 1, v7
    v_and_b32 v49, 1, v7
    v_lshlrev_b32 v50, 9, v48
    v_lshl_add_u32 v50, v6, 4, v50
    v_lshl_add_u32 v50, v49, 3, v50
    v_lshlrev_b32 v52, 8, v49
    v_lshl_add_u32 v52, v6, 4, v52
    v_lshl_add_u32 v52, v48, 3, v52
    v_cndmask_b32_e64 v104, v50, v52, s[38:39]
    s_lshl_b32 s23, s22, 11
    s_add_u32 s23, s23, 147456
    v_add_u32 v106, s23, v1
    v_add_u32 v107, 147456, v1
    s_lshr_b32 s23, s44, 1
    s_lshl_b32 s23, s23, 10
    s_and_b32 s28, s44, 1
    s_lshl_b32 s29, s28, 8
    s_add_u32 s29, s29, 3211264
    s_lshl_b32 s28, s28, 9
    s_add_u32 s28, s28, 3276800
    s_bitcmp1_b32 s21, 0
    s_cselect_b32 s28, s28, s29
    s_add_u32 s59, s23, s28
    s_waitcnt lgkmcnt(0)
    s_mul_i32 s50, s100, 0x9e3779b1
    s_xor_b32 s50, s50, s101
    s_add_u32 s50, s50, 0x7f4a7c15
    s_mul_i32 s3, s100, 0x85ebca6b
    s_add_u32 s3, s3, s101
    s_xor_b32 s3, s3, 0x5bd1e995
    s_waitcnt vmcnt(33)
    v_mfma_f32_16x16x32_bf16 v[16:19], a[64:67], v[158:161], 0
    v_mfma_f32_16x16x32_bf16 v[20:23], a[64:67], v[162:165], 0
    s_nop 6
    v_cvt_pk_bf16_f32 v230, v16, v17
    v_cvt_pk_bf16_f32 v231, v18, v19
    v_cvt_pk_bf16_f32 v232, v20, v21
    v_cvt_pk_bf16_f32 v233, v22, v23
    s_waitcnt vmcnt(32)
    v_mfma_f32_16x16x32_bf16 v[16:19], a[68:71], v[158:161], 0
    v_mfma_f32_16x16x32_bf16 v[20:23], a[68:71], v[162:165], 0
    s_nop 6
    v_cvt_pk_bf16_f32 v234, v16, v17
    v_cvt_pk_bf16_f32 v235, v18, v19
    v_cvt_pk_bf16_f32 v236, v20, v21
    v_cvt_pk_bf16_f32 v237, v22, v23
    s_waitcnt vmcnt(31)
    v_mfma_f32_16x16x32_bf16 v[16:19], a[72:75], v[158:161], 0
    v_mfma_f32_16x16x32_bf16 v[20:23], a[72:75], v[162:165], 0
    s_nop 6
    v_cvt_pk_bf16_f32 v238, v16, v17
    v_cvt_pk_bf16_f32 v239, v18, v19
    v_cvt_pk_bf16_f32 v240, v20, v21
    v_cvt_pk_bf16_f32 v241, v22, v23
    s_waitcnt vmcnt(30)
    v_mfma_f32_16x16x32_bf16 v[16:19], a[76:79], v[158:161], 0
    v_mfma_f32_16x16x32_bf16 v[20:23], a[76:79], v[162:165], 0
    s_nop 6
    v_cvt_pk_bf16_f32 v242, v16, v17
    v_cvt_pk_bf16_f32 v243, v18, v19
    v_cvt_pk_bf16_f32 v244, v20, v21
    v_cvt_pk_bf16_f32 v245, v22, v23
    v_mfma_f32_16x16x32_bf16 v[112:115], v[230:233], v[8:11], 0
    v_mfma_f32_16x16x32_bf16 v[116:119], v[8:11], v[230:233], 0
    v_mfma_f32_16x16x32_bf16 v[112:115], v[234:237], v[8:11], v[112:115]
    v_mfma_f32_16x16x32_bf16 v[116:119], v[8:11], v[234:237], v[116:119]
    v_mfma_f32_16x16x32_bf16 v[112:115], v[238:241], v[8:11], v[112:115]
    v_mfma_f32_16x16x32_bf16 v[116:119], v[8:11], v[238:241], v[116:119]
    v_mfma_f32_16x16x32_bf16 v[112:115], v[242:245], v[8:11], v[112:115]
    v_mfma_f32_16x16x32_bf16 v[116:119], v[8:11], v[242:245], v[116:119]
    s_nop 7
    v_cndmask_b32_e64 v112, v112, v116, s[38:39]
    v_cndmask_b32_e64 v113, v113, v116, s[38:39]
    v_cndmask_b32_e64 v114, v114, v116, s[38:39]
    v_cndmask_b32_e64 v115, v115, v116, s[38:39]
    ds_write_b128 v106, v[112:115] offset:1024
    s_barrier
    s_lshl_b32 s23, s21, 3
    s_and_b32 s23, s23, 0x30
    s_mul_i32 s23, s23, 1040
    s_lshl_b32 s28, s22, 8
    s_add_u32 s23, s23, s28
    s_add_u32 s23, s23, 74752
    v_mul_u32_u24 v60, 1040, v6
    v_lshl_add_u32 v60, v7, 4, v60
    v_add_u32 v60, s23, v60
    ds_read_b128 v[64:67], v60 offset:0
    ds_read_b128 v[68:71], v60 offset:64
    ds_read_b128 v[72:75], v60 offset:128
    ds_read_b128 v[76:79], v60 offset:192
    s_waitcnt lgkmcnt(3)
    v_mfma_f32_16x16x32_bf16 v[96:99], v[64:67], v[64:67], 0
    v_mfma_f32_16x16x32_bf16 v[100:103], v[8:11], v[64:67], 0
    v_mfma_f32_16x16x32_bf16 v[80:83], v[230:233], v[64:67], 0
    v_mfma_f32_16x16x32_bf16 v[84:87], v[64:67], v[230:233], 0
    s_waitcnt lgkmcnt(2)
    v_mfma_f32_16x16x32_bf16 v[96:99], v[68:71], v[68:71], v[96:99]
    v_mfma_f32_16x16x32_bf16 v[100:103], v[8:11], v[68:71], v[100:103]
    v_mfma_f32_16x16x32_bf16 v[80:83], v[234:237], v[68:71], v[80:83]
    v_mfma_f32_16x16x32_bf16 v[84:87], v[68:71], v[234:237], v[84:87]
    s_waitcnt lgkmcnt(1)
    v_mfma_f32_16x16x32_bf16 v[96:99], v[72:75], v[72:75], v[96:99]
    v_mfma_f32_16x16x32_bf16 v[100:103], v[8:11], v[72:75], v[100:103]
    v_mfma_f32_16x16x32_bf16 v[80:83], v[238:241], v[72:75], v[80:83]
    v_mfma_f32_16x16x32_bf16 v[84:87], v[72:75], v[238:241], v[84:87]
    s_waitcnt lgkmcnt(0)
    v_mfma_f32_16x16x32_bf16 v[96:99], v[76:79], v[76:79], v[96:99]
    v_mfma_f32_16x16x32_bf16 v[100:103], v[8:11], v[76:79], v[100:103]
    v_mfma_f32_16x16x32_bf16 v[80:83], v[242:245], v[76:79], v[80:83]
    v_mfma_f32_16x16x32_bf16 v[84:87], v[76:79], v[242:245], v[84:87]
    s_nop 4
    v_cndmask_b32_e64 v48, v96, v97, s[32:33]
    v_cndmask_b32_e64 v48, v48, v98, s[34:35]
    v_cndmask_b32_e64 v48, v48, v99, s[36:37]
    ds_write_b32 v29, v100 offset:0
    ds_write_b32 v29, v48 offset:16
    v_cndmask_b32_e64 v80, v80, v84, s[38:39]
    v_cndmask_b32_e64 v81, v81, v85, s[38:39]
    v_cndmask_b32_e64 v82, v82, v86, s[38:39]
    v_cndmask_b32_e64 v83, v83, v87, s[38:39]
    ds_write_b128 v106, v[80:83]
    s_waitcnt lgkmcnt(0)
    s_barrier
    ds_read_b128 v[48:51], v30 offset:0
    ds_read_b128 v[52:55], v30 offset:16
    ds_read_b128 v[108:111], v107 offset:0
    ds_read_b128 v[112:115], v107 offset:2048
    ds_read_b128 v[116:119], v107 offset:4096
    ds_read_b128 v[120:123], v107 offset:6144
    ds_read_b128 v[124:127], v107 offset:1024
    ds_read_b128 v[128:131], v107 offset:3072
    ds_read_b128 v[132:135], v107 offset:5120
    ds_read_b128 v[136:139], v107 offset:7168
    s_waitcnt lgkmcnt(8)
    v_add_f32 v48, v48, v49
    v_add_f32 v52, v52, v53
    v_add_f32 v50, v50, v51
    v_add_f32 v54, v54, v55
    v_add_f32 v48, v48, v50
    v_add_f32 v52, v52, v54
    v_mul_f32 v48, 0x3b000000, v48
    v_mul_f32 v52, 0x3b000000, v52
    v_fma_f32 v52, -v48, v48, v52
    v_max_f32 v52, 0, v52
    v_add_f32 v52, 0x3727c5ac, v52
    v_rsq_f32 v140, v52
    v_sub_f32 v48, 0, v48
    v_mul_f32 v141, v48, v140
    ds_write_b32 v28, v140
    ds_write_b32 v28, v141 offset:64
    s_waitcnt lgkmcnt(0)
    ds_read_b128 v[144:147], v31
    ds_read_b128 v[148:151], v31 offset:64
    v_add_f32 v108, v108, v112
    v_add_f32 v116, v116, v120
    v_add_f32 v109, v109, v113
    v_add_f32 v117, v117, v121
    v_add_f32 v110, v110, v114
    v_add_f32 v118, v118, v122
    v_add_f32 v111, v111, v115
    v_add_f32 v119, v119, v123
    v_add_f32 v108, v108, v116
    v_add_f32 v109, v109, v117
    v_add_f32 v110, v110, v118
    v_add_f32 v111, v111, v119
    v_add_f32 v124, v124, v128
    v_add_f32 v132, v132, v136
    v_add_f32 v125, v125, v129
    v_add_f32 v133, v133, v137
    v_add_f32 v126, v126, v130
    v_add_f32 v134, v134, v138
    v_add_f32 v127, v127, v131
    v_add_f32 v135, v135, v139
    v_add_f32 v124, v124, v132
    v_add_f32 v125, v125, v133
    v_add_f32 v126, v126, v134
    v_add_f32 v127, v127, v135
    s_waitcnt lgkmcnt(0)
    v_cndmask_b32_e64 v144, v140, v144, s[38:39]
    v_cndmask_b32_e64 v148, v141, v148, s[38:39]
    v_cndmask_b32_e64 v145, v140, v145, s[38:39]
    v_cndmask_b32_e64 v149, v141, v149, s[38:39]
    v_cndmask_b32_e64 v146, v140, v146, s[38:39]
    v_cndmask_b32_e64 v150, v141, v150, s[38:39]
    v_cndmask_b32_e64 v147, v140, v147, s[38:39]
    v_cndmask_b32_e64 v151, v141, v151, s[38:39]
    v_mul_f32 v154, v148, v124
    v_mul_f32 v155, v149, v125
    v_mul_f32 v156, v150, v126
    v_mul_f32 v157, v151, v127
    v_fma_f32 v154, v108, v144, v154
    v_fma_f32 v155, v109, v145, v155
    v_fma_f32 v156, v110, v146, v156
    v_fma_f32 v157, v111, v147, v157
    v_cvt_pk_bf16_f32 v152, v154, v155
    v_cvt_pk_bf16_f32 v153, v156, v157
    s_cmp_eq_u32 s22, 0
    s_cselect_b64 exec, -1, 0
    buffer_store_dwordx2 v[152:153], v104, s[8:11], s59 offen sc1
    s_mov_b64 exec, -1
    s_lshl_b32 s58, s2, 2
    s_add_u32 s58, s58, s22
    s_add_u32 s27, s58, 0
    s_min_u32 s27, s27, 2559
    s_add_u32 s27, s27, 512
    s_lshr_b32 s28, s27, 4
    s_and_b32 s29, s27, 15
    s_mov_b32 s24, s46
    s_mov_b32 s25, s47
    s_sub_u32 s45, s28, 32
    s_mov_b32 s26, 1024
    s_sub_u32 s23, s28, 64
    s_cmp_ge_u32 s28, 64
    s_cselect_b32 s24, s62, s24
    s_cselect_b32 s25, s63, s25
    s_cselect_b32 s45, s23, s45
    s_cselect_b32 s26, 1024, s26
    s_sub_u32 s23, s28, 96
    s_cmp_ge_u32 s28, 96
    s_cselect_b32 s24, s60, s24
    s_cselect_b32 s25, s61, s25
    s_cselect_b32 s45, s23, s45
    s_cselect_b32 s26, 3072, s26
    s_lshl_b32 s29, s29, 5
    s_lshl_b32 s45, s45, 5
    v_add_u32 v148, s29, v24
    v_mul_lo_u32 v148, v148, s26
    v_add_u32 v148, v148, v25
    v_add_u32 v148, s45, v148
    v_mov_b32 v137, s25
    v_add_co_u32 v136, vcc, s24, v148
    s_nop 1
    v_addc_co_u32 v137, vcc, 0, v137, vcc
    s_add_u32 s27, s58, 1024
    s_min_u32 s27, s27, 2559
    s_add_u32 s27, s27, 512
    s_lshr_b32 s28, s27, 4
    s_and_b32 s29, s27, 15
    s_mov_b32 s24, s46
    s_mov_b32 s25, s47
    s_sub_u32 s45, s28, 32
    s_mov_b32 s26, 1024
    s_sub_u32 s23, s28, 64
    s_cmp_ge_u32 s28, 64
    s_cselect_b32 s24, s62, s24
    s_cselect_b32 s25, s63, s25
    s_cselect_b32 s45, s23, s45
    s_cselect_b32 s26, 1024, s26
    s_sub_u32 s23, s28, 96
    s_cmp_ge_u32 s28, 96
    s_cselect_b32 s24, s60, s24
    s_cselect_b32 s25, s61, s25
    s_cselect_b32 s45, s23, s45
    s_cselect_b32 s26, 3072, s26
    s_lshl_b32 s29, s29, 5
    s_lshl_b32 s45, s45, 5
    v_add_u32 v148, s29, v24
    v_mul_lo_u32 v148, v148, s26
    v_add_u32 v148, v148, v25
    v_add_u32 v148, s45, v148
    v_mov_b32 v139, s25
    v_add_co_u32 v138, vcc, s24, v148
    s_nop 1
    v_addc_co_u32 v139, vcc, 0, v139, vcc
    s_add_u32 s27, s58, 2048
    s_min_u32 s27, s27, 2559
    s_add_u32 s27, s27, 512
    s_lshr_b32 s28, s27, 4
    s_and_b32 s29, s27, 15
    s_mov_b32 s24, s46
    s_mov_b32 s25, s47
    s_sub_u32 s45, s28, 32
    s_mov_b32 s26, 1024
    s_sub_u32 s23, s28, 64
    s_cmp_ge_u32 s28, 64
    s_cselect_b32 s24, s62, s24
    s_cselect_b32 s25, s63, s25
    s_cselect_b32 s45, s23, s45
    s_cselect_b32 s26, 1024, s26
    s_sub_u32 s23, s28, 96
    s_cmp_ge_u32 s28, 96
    s_cselect_b32 s24, s60, s24
    s_cselect_b32 s25, s61, s25
    s_cselect_b32 s45, s23, s45
    s_cselect_b32 s26, 3072, s26
    s_lshl_b32 s29, s29, 5
    s_lshl_b32 s45, s45, 5
    v_add_u32 v148, s29, v24
    v_mul_lo_u32 v148, v148, s26
    v_add_u32 v148, v148, v25
    v_add_u32 v148, s45, v148
    v_mov_b32 v141, s25
    v_add_co_u32 v140, vcc, s24, v148
    s_nop 1
    v_addc_co_u32 v141, vcc, 0, v141, vcc
    s_mul_i32 s23, s55, 131072
    s_add_u32 s48, s23, 3211264
    s_add_u32 s49, s23, 3276800
    s_mul_i32 s23, s55, 8388608
    s_add_u32 s51, s23, 8388608
    s_mov_b32 s52, 10485760
    s_mov_b32 s53, 12582912
    s_mov_b32 s54, 10485760
    s_lshl_b32 s23, s55, 14
    s_add_u32 s56, s23, 26214400
    s_add_u32 s23, s22, 0
    s_and_b32 s23, s23, 3
    s_lshl_b32 s16, s23, 12
    s_add_u32 s23, s22, 1
    s_and_b32 s23, s23, 3
    s_lshl_b32 s17, s23, 12
    s_add_u32 s23, s22, 2
    s_and_b32 s23, s23, 3
    s_lshl_b32 s18, s23, 12
    s_add_u32 s23, s22, 3
    s_and_b32 s23, s23, 3
    s_lshl_b32 s19, s23, 12
    s_lshl_b32 s57, s21, 2
    s_add_u32 s57, s57, s22
    s_lshl_b32 s57, s57, 14
    s_waitcnt vmcnt(0)
    s_lshl_b32 s28, s20, 3
    s_add_u32 s28, s28, s21
    s_lshl_b32 s28, s28, 3
    s_add_u32 s28, s28, 26247168
    v_lshlrev_b32 v61, 11, v0
    v_mov_b32 v62, s50
    v_mov_b32 v63, s3
    s_cmp_eq_u32 s22, 0
    s_cselect_b64 exec, 0xff, 0
    buffer_store_dwordx2 v[62:63], v61, s[8:11], s28 offen sc1
    s_mov_b64 exec, -1
    s_getreg_b32 s39, hwreg(HW_REG_XCC_ID)
    s_and_b32 s39, s39, 7
    s_add_u32 s39, s39, 16
    s_add_u32 s39, s39, s50
    s_lshl_b32 s28, s20, 3
    s_add_u32 s28, s28, s21
    s_lshl_b32 s28, s28, 3
    s_add_u32 s28, s28, 26312704
    v_lshlrev_b32 v61, 11, v0
    v_mov_b32 v62, s39
    v_mov_b32 v63, s3
    s_cmp_eq_u32 s22, 0
    s_cselect_b64 exec, 1, 0
    buffer_store_dwordx2 v[62:63], v61, s[8:11], s28 offen sc1
    s_mov_b64 exec, -1
    s_mov_b32 s95, s39
    s_load_dwordx2 s[6:7], s[0:1], 64
    s_barrier
    v_and_b32 v26, 2, v24
    v_lshrrev_b32 v27, 2, v24
    v_and_b32 v27, 4, v27
    v_or_b32 v26, v26, v27
    v_lshrrev_b32 v27, 4, v25
    s_lshl_b32 s23, s22, 1
    v_add_u32 v27, s23, v27
    v_xor_b32 v26, v26, v27
    v_lshlrev_b32 v26, 4, v26
    v_lshl_add_u32 v26, v24, 7, v26
    v_add_u32 v28, s16, v26
    v_mov_b32 v27, s16
    v_lshl_add_u32 v28, v27, 2, v26
    v_add_u32 v29, s17, v26
    v_mov_b32 v27, s17
    v_lshl_add_u32 v29, v27, 2, v26
    v_add_u32 v30, s18, v26
    v_mov_b32 v27, s18
    v_lshl_add_u32 v30, v27, 2, v26
    v_add_u32 v31, s19, v26
    v_mov_b32 v27, s19
    v_lshl_add_u32 v31, v27, 2, v26
    ds_read_b128 v[32:35], v28 offset:0
    ds_read_b128 v[36:39], v28 offset:4096
    ds_read_b128 v[40:43], v28 offset:8192
    ds_read_b128 v[44:47], v28 offset:12288
    ds_read_b128 v[48:51], v29 offset:0
    ds_read_b128 v[52:55], v29 offset:4096
    ds_read_b128 v[56:59], v29 offset:8192
    ds_read_b128 v[60:63], v29 offset:12288
    s_waitcnt lgkmcnt(7)
    v_mfma_f32_16x16x32_bf16 v[64:67], v[32:35], v[158:161], 0
    v_mfma_f32_16x16x32_bf16 v[68:71], v[32:35], v[162:165], 0
    ds_read_b128 v[32:35], v30 offset:0
    s_waitcnt lgkmcnt(7)
    v_mfma_f32_16x16x32_bf16 v[72:75], v[36:39], v[158:161], 0
    v_mfma_f32_16x16x32_bf16 v[76:79], v[36:39], v[162:165], 0
    ds_read_b128 v[36:39], v30 offset:4096
    s_nop 1
    v_cvt_pk_bf16_f32 v166, v64, v65
    v_cvt_pk_bf16_f32 v167, v66, v67
    v_cvt_pk_bf16_f32 v168, v68, v69
    v_cvt_pk_bf16_f32 v169, v70, v71
    s_waitcnt lgkmcnt(7)
    v_mfma_f32_16x16x32_bf16 v[64:67], v[40:43], v[158:161], 0
    v_mfma_f32_16x16x32_bf16 v[68:71], v[40:43], v[162:165], 0
    ds_read_b128 v[40:43], v30 offset:8192
    v_cvt_pk_bf16_f32 v170, v72, v73
    v_cvt_pk_bf16_f32 v171, v74, v75
    v_cvt_pk_bf16_f32 v172, v76, v77
    v_cvt_pk_bf16_f32 v173, v78, v79
    s_waitcnt lgkmcnt(7)
    v_mfma_f32_16x16x32_bf16 v[72:75], v[44:47], v[158:161], 0
    v_mfma_f32_16x16x32_bf16 v[76:79], v[44:47], v[162:165], 0
    ds_read_b128 v[44:47], v30 offset:12288
    v_cvt_pk_bf16_f32 v174, v64, v65
    v_cvt_pk_bf16_f32 v175, v66, v67
    v_cvt_pk_bf16_f32 v176, v68, v69
    v_cvt_pk_bf16_f32 v177, v70, v71
    s_waitcnt lgkmcnt(7)
    v_mfma_f32_16x16x32_bf16 v[64:67], v[48:51], v[158:161], 0
    v_mfma_f32_16x16x32_bf16 v[68:71], v[48:51], v[162:165], 0
    ds_read_b128 v[48:51], v31 offset:0
    v_cvt_pk_bf16_f32 v178, v72, v73
    v_cvt_pk_bf16_f32 v179, v74, v75
    v_cvt_pk_bf16_f32 v180, v76, v77
    v_cvt_pk_bf16_f32 v181, v78, v79
    s_waitcnt lgkmcnt(7)
    v_mfma_f32_16x16x32_bf16 v[72:75], v[52:55], v[158:161], 0
    v_mfma_f32_16x16x32_bf16 v[76:79], v[52:55], v[162:165], 0
    ds_read_b128 v[52:55], v31 offset:4096
    v_cvt_pk_bf16_f32 v182, v64, v65
    v_cvt_pk_bf16_f32 v183, v66, v67
    v_cvt_pk_bf16_f32 v184, v68, v69
    v_cvt_pk_bf16_f32 v185, v70, v71
    s_waitcnt lgkmcnt(7)
    v_mfma_f32_16x16x32_bf16 v[64:67], v[56:59], v[158:161], 0
    v_mfma_f32_16x16x32_bf16 v[68:71], v[56:59], v[162:165], 0
    ds_read_b128 v[56:59], v31 offset:8192
    v_cvt_pk_bf16_f32 v186, v72, v73
    v_cvt_pk_bf16_f32 v187, v74, v75
    v_cvt_pk_bf16_f32 v188, v76, v77
    v_cvt_pk_bf16_f32 v189, v78, v79
    s_waitcnt lgkmcnt(7)
    v_mfma_f32_16x16x32_bf16 v[72:75], v[60:63], v[158:161], 0
    v_mfma_f32_16x16x32_bf16 v[76:79], v[60:63], v[162:165], 0
    ds_read_b128 v[60:63], v31 offset:12288
    v_cvt_pk_bf16_f32 v190, v64, v65
    v_cvt_pk_bf16_f32 v191, v66, v67
    v_cvt_pk_bf16_f32 v192, v68, v69
    v_cvt_pk_bf16_f32 v193, v70, v71
    s_waitcnt lgkmcnt(7)
    v_mfma_f32_16x16x32_bf16 v[64:67], v[32:35], v[158:161], 0
    v_mfma_f32_16x16x32_bf16 v[68:71], v[32:35], v[162:165], 0
    v_cvt_pk_bf16_f32 v194, v72, v73
    v_cvt_pk_bf16_f32 v195, v74, v75
    v_cvt_pk_bf16_f32 v196, v76, v77
    v_cvt_pk_bf16_f32 v197, v78, v79
    s_waitcnt lgkmcnt(6)
    v_mfma_f32_16x16x32_bf16 v[72:75], v[36:39], v[158:161], 0
    v_mfma_f32_16x16x32_bf16 v[76:79], v[36:39], v[162:165], 0
    v_cvt_pk_bf16_f32 v198, v64, v65
    v_cvt_pk_bf16_f32 v199, v66, v67
    v_cvt_pk_bf16_f32 v200, v68, v69
    v_cvt_pk_bf16_f32 v201, v70, v71
    s_waitcnt lgkmcnt(5)
    v_mfma_f32_16x16x32_bf16 v[64:67], v[40:43], v[158:161], 0
    v_mfma_f32_16x16x32_bf16 v[68:71], v[40:43], v[162:165], 0
    v_cvt_pk_bf16_f32 v202, v72, v73
    v_cvt_pk_bf16_f32 v203, v74, v75
    v_cvt_pk_bf16_f32 v204, v76, v77
    v_cvt_pk_bf16_f32 v205, v78, v79
    s_waitcnt lgkmcnt(4)
    v_mfma_f32_16x16x32_bf16 v[72:75], v[44:47], v[158:161], 0
    v_mfma_f32_16x16x32_bf16 v[76:79], v[44:47], v[162:165], 0
    v_cvt_pk_bf16_f32 v206, v64, v65
    v_cvt_pk_bf16_f32 v207, v66, v67
    v_cvt_pk_bf16_f32 v208, v68, v69
    v_cvt_pk_bf16_f32 v209, v70, v71
    s_waitcnt lgkmcnt(3)
    v_mfma_f32_16x16x32_bf16 v[64:67], v[48:51], v[158:161], 0
    v_mfma_f32_16x16x32_bf16 v[68:71], v[48:51], v[162:165], 0
    v_cvt_pk_bf16_f32 v210, v72, v73
    v_cvt_pk_bf16_f32 v211, v74, v75
    v_cvt_pk_bf16_f32 v212, v76, v77
    v_cvt_pk_bf16_f32 v213, v78, v79
    s_waitcnt lgkmcnt(2)
    v_mfma_f32_16x16x32_bf16 v[72:75], v[52:55], v[158:161], 0
    v_mfma_f32_16x16x32_bf16 v[76:79], v[52:55], v[162:165], 0
    v_cvt_pk_bf16_f32 v214, v64, v65
    v_cvt_pk_bf16_f32 v215, v66, v67
    v_cvt_pk_bf16_f32 v216, v68, v69
    v_cvt_pk_bf16_f32 v217, v70, v71
    s_waitcnt lgkmcnt(1)
    v_mfma_f32_16x16x32_bf16 v[64:67], v[56:59], v[158:161], 0
    v_mfma_f32_16x16x32_bf16 v[68:71], v[56:59], v[162:165], 0
    v_cvt_pk_bf16_f32 v218, v72, v73
    v_cvt_pk_bf16_f32 v219, v74, v75
    v_cvt_pk_bf16_f32 v220, v76, v77
    v_cvt_pk_bf16_f32 v221, v78, v79
    s_waitcnt lgkmcnt(0)
    v_mfma_f32_16x16x32_bf16 v[72:75], v[60:63], v[158:161], 0
    v_mfma_f32_16x16x32_bf16 v[76:79], v[60:63], v[162:165], 0
    v_cvt_pk_bf16_f32 v222, v64, v65
    v_cvt_pk_bf16_f32 v223, v66, v67
    v_cvt_pk_bf16_f32 v224, v68, v69
    v_cvt_pk_bf16_f32 v225, v70, v71
    s_nop 2
    v_cvt_pk_bf16_f32 v226, v72, v73
    v_cvt_pk_bf16_f32 v227, v74, v75
    v_cvt_pk_bf16_f32 v228, v76, v77
    v_cvt_pk_bf16_f32 v229, v78, v79
    v_mul_u32_u24 v26, 1040, v6
    v_lshl_add_u32 v26, v7, 3, v26
    s_lshl_b32 s23, s21, 7
    s_lshl_b32 s24, s22, 5
    s_add_u32 s23, s23, s24
    s_add_u32 s23, s23, 74752
    v_add_u32 v26, s23, v26
    ds_read_b64 v[246:247], v26 offset:0
    ds_read_b64 v[248:249], v26 offset:16640
    ds_read_b64 v[250:251], v26 offset:33280
    ds_read_b64 v[252:253], v26 offset:49920
    v_mul_u32_u24 v26, 1040, v6
    v_lshl_add_u32 v26, v7, 4, v26
    s_lshr_b32 s23, s16, 4
    s_add_u32 s23, s23, 74752
    v_add_u32 v2, s23, v26
    s_lshr_b32 s23, s17, 4
    s_add_u32 s23, s23, 74752
    v_add_u32 v3, s23, v26
    s_lshr_b32 s23, s18, 4
    s_add_u32 s23, s23, 74752
    v_add_u32 v4, s23, v26
    s_lshr_b32 s23, s19, 4
    s_add_u32 s23, s23, 74752
    v_add_u32 v5, s23, v26
    v_lshrrev_b32 v48, 2, v6
    v_cmp_eq_u32 s[30:31], v48, v7
    v_lshlrev_b32 v45, 5, v6
    s_lshl_b32 s23, s22, 2
    s_add_u32 s23, s23, 141312
    v_add_u32 v45, s23, v45
    v_mov_b32 v48, 144384
    v_cndmask_b32_e64 v45, v48, v45, s[30:31]
    v_lshlrev_b32 v46, 5, v6
    v_add_u32 v46, 141312, v46
    s_lshl_b32 s23, s22, 7
    s_add_u32 s23, s23, 143872
    v_lshlrev_b32 v44, 2, v6
    v_add_u32 v44, s23, v44
    v_lshlrev_b32 v47, 4, v7
    v_add_u32 v47, s23, v47
    s_waitcnt lgkmcnt(0)
    s_mov_b32 s12, s6
    s_mov_b32 s13, s7
    s_mov_b32 s14, 2097152
    s_mov_b32 s15, 0x00020000
    ds_read_b128 v[12:15], v2 offset:0
    ds_read_b128 v[16:19], v2 offset:64
    ds_read_b128 v[20:23], v2 offset:128
    ds_read_b128 v[24:27], v2 offset:192
    ds_read_b128 v[28:31], v3 offset:0
    ds_read_b128 v[32:35], v3 offset:64
    ds_read_b128 v[36:39], v3 offset:128
    ds_read_b128 v[40:43], v3 offset:192
    s_waitcnt lgkmcnt(6)
    v_mfma_f32_16x16x32_bf16 v[64:67], v[166:169], v[12:15], 0
    v_mfma_f32_16x16x32_bf16 v[80:83], v[12:15], v[12:15], 0
    v_mfma_f32_16x16x32_bf16 v[104:107], v[8:11], v[12:15], 0
    ds_read_b128 v[12:15], v4 offset:0
    v_mfma_f32_16x16x32_bf16 v[64:67], v[170:173], v[16:19], v[64:67]
    v_mfma_f32_16x16x32_bf16 v[80:83], v[16:19], v[16:19], v[80:83]
    v_mfma_f32_16x16x32_bf16 v[104:107], v[8:11], v[16:19], v[104:107]
    ds_read_b128 v[16:19], v4 offset:64
    s_waitcnt lgkmcnt(6)
    v_mfma_f32_16x16x32_bf16 v[64:67], v[174:177], v[20:23], v[64:67]
    v_mfma_f32_16x16x32_bf16 v[80:83], v[20:23], v[20:23], v[80:83]
    v_mfma_f32_16x16x32_bf16 v[104:107], v[8:11], v[20:23], v[104:107]
    ds_read_b128 v[20:23], v4 offset:128
    v_mfma_f32_16x16x32_bf16 v[64:67], v[178:181], v[24:27], v[64:67]
    v_mfma_f32_16x16x32_bf16 v[80:83], v[24:27], v[24:27], v[80:83]
    v_mfma_f32_16x16x32_bf16 v[104:107], v[8:11], v[24:27], v[104:107]
    ds_read_b128 v[24:27], v4 offset:192
    s_waitcnt lgkmcnt(6)
    v_mfma_f32_16x16x32_bf16 v[64:67], v[182:185], v[28:31], v[64:67]
    ds_read_b128 v[28:31], v5 offset:0
    v_mfma_f32_16x16x32_bf16 v[124:127], v[166:169], v[8:11], 0
    v_mfma_f32_16x16x32_bf16 v[64:67], v[186:189], v[32:35], v[64:67]
    ds_read_b128 v[32:35], v5 offset:64
    v_mfma_f32_16x16x32_bf16 v[124:127], v[170:173], v[8:11], v[124:127]
    s_waitcnt lgkmcnt(6)
    v_mfma_f32_16x16x32_bf16 v[64:67], v[190:193], v[36:39], v[64:67]
    ds_read_b128 v[36:39], v5 offset:128
    v_cndmask_b32_e64 v48, v80, v81, s[32:33]
    v_mfma_f32_16x16x32_bf16 v[64:67], v[194:197], v[40:43], v[64:67]
    ds_read_b128 v[40:43], v5 offset:192
    v_cndmask_b32_e64 v48, v48, v82, s[34:35]
    s_waitcnt lgkmcnt(6)
    v_mfma_f32_16x16x32_bf16 v[64:67], v[198:201], v[12:15], v[64:67]
    ds_read_b128 v[12:15], v2 offset:16640
    v_cndmask_b32_e64 v48, v48, v83, s[36:37]
    v_mfma_f32_16x16x32_bf16 v[64:67], v[202:205], v[16:19], v[64:67]
    ds_read_b128 v[16:19], v2 offset:16704
    s_waitcnt lgkmcnt(6)
    v_mfma_f32_16x16x32_bf16 v[64:67], v[206:209], v[20:23], v[64:67]
    ds_read_b128 v[20:23], v2 offset:16768
    ds_write_b32 v45, v104 offset:0
    v_mfma_f32_16x16x32_bf16 v[64:67], v[210:213], v[24:27], v[64:67]
    ds_read_b128 v[24:27], v2 offset:16832
    ds_write_b32 v45, v48 offset:16
    s_waitcnt lgkmcnt(8)
    v_mfma_f32_16x16x32_bf16 v[64:67], v[214:217], v[28:31], v[64:67]
    ds_read_b128 v[28:31], v3 offset:16640
    v_mfma_f32_16x16x32_bf16 v[64:67], v[218:221], v[32:35], v[64:67]
    ds_read_b128 v[32:35], v3 offset:16704
    v_mfma_f32_16x16x32_bf16 v[124:127], v[174:177], v[8:11], v[124:127]
    s_waitcnt lgkmcnt(8)
    v_mfma_f32_16x16x32_bf16 v[64:67], v[222:225], v[36:39], v[64:67]
    ds_read_b128 v[36:39], v3 offset:16768
    v_mfma_f32_16x16x32_bf16 v[64:67], v[226:229], v[40:43], v[64:67]
    ds_read_b128 v[40:43], v3 offset:16832
    v_mfma_f32_16x16x32_bf16 v[124:127], v[178:181], v[8:11], v[124:127]
    s_waitcnt lgkmcnt(8)
    v_mfma_f32_16x16x32_bf16 v[68:71], v[166:169], v[12:15], 0
    v_mfma_f32_16x16x32_bf16 v[124:127], v[182:185], v[8:11], v[124:127]
    v_mfma_f32_16x16x32_bf16 v[84:87], v[12:15], v[12:15], 0
    v_mfma_f32_16x16x32_bf16 v[124:127], v[186:189], v[8:11], v[124:127]
    v_mfma_f32_16x16x32_bf16 v[108:111], v[8:11], v[12:15], 0
    ds_read_b128 v[12:15], v4 offset:16640
    v_mfma_f32_16x16x32_bf16 v[68:71], v[170:173], v[16:19], v[68:71]
    v_mfma_f32_16x16x32_bf16 v[124:127], v[190:193], v[8:11], v[124:127]
    v_mfma_f32_16x16x32_bf16 v[84:87], v[16:19], v[16:19], v[84:87]
    v_mfma_f32_16x16x32_bf16 v[124:127], v[194:197], v[8:11], v[124:127]
    v_mfma_f32_16x16x32_bf16 v[108:111], v[8:11], v[16:19], v[108:111]
    ds_read_b128 v[16:19], v4 offset:16704
    v_mfma_f32_16x16x32_bf16 v[124:127], v[198:201], v[8:11], v[124:127]
    s_waitcnt lgkmcnt(7)
    v_mfma_f32_16x16x32_bf16 v[68:71], v[174:177], v[20:23], v[68:71]
    v_mfma_f32_16x16x32_bf16 v[124:127], v[202:205], v[8:11], v[124:127]
    v_mfma_f32_16x16x32_bf16 v[84:87], v[20:23], v[20:23], v[84:87]
    v_mfma_f32_16x16x32_bf16 v[124:127], v[206:209], v[8:11], v[124:127]
    v_mfma_f32_16x16x32_bf16 v[108:111], v[8:11], v[20:23], v[108:111]
    ds_read_b128 v[20:23], v4 offset:16768
    v_mfma_f32_16x16x32_bf16 v[68:71], v[178:181], v[24:27], v[68:71]
    v_mfma_f32_16x16x32_bf16 v[124:127], v[210:213], v[8:11], v[124:127]
    v_mfma_f32_16x16x32_bf16 v[84:87], v[24:27], v[24:27], v[84:87]
    v_mfma_f32_16x16x32_bf16 v[124:127], v[214:217], v[8:11], v[124:127]
    v_mfma_f32_16x16x32_bf16 v[108:111], v[8:11], v[24:27], v[108:111]
    ds_read_b128 v[24:27], v4 offset:16832
    v_mfma_f32_16x16x32_bf16 v[124:127], v[218:221], v[8:11], v[124:127]
    s_waitcnt lgkmcnt(6)
    v_mfma_f32_16x16x32_bf16 v[68:71], v[182:185], v[28:31], v[68:71]
    ds_read_b128 v[28:31], v5 offset:16640
    v_mfma_f32_16x16x32_bf16 v[68:71], v[186:189], v[32:35], v[68:71]
    ds_read_b128 v[32:35], v5 offset:16704
    v_mfma_f32_16x16x32_bf16 v[124:127], v[222:225], v[8:11], v[124:127]
    s_waitcnt lgkmcnt(6)
    v_mfma_f32_16x16x32_bf16 v[68:71], v[190:193], v[36:39], v[68:71]
    ds_read_b128 v[36:39], v5 offset:16768
    v_cndmask_b32_e64 v48, v84, v85, s[32:33]
    v_mfma_f32_16x16x32_bf16 v[68:71], v[194:197], v[40:43], v[68:71]
    ds_read_b128 v[40:43], v5 offset:16832
    v_cndmask_b32_e64 v48, v48, v86, s[34:35]
    s_waitcnt lgkmcnt(6)
    v_mfma_f32_16x16x32_bf16 v[68:71], v[198:201], v[12:15], v[68:71]
    ds_read_b128 v[12:15], v2 offset:33280
    v_cndmask_b32_e64 v48, v48, v87, s[36:37]
    v_mfma_f32_16x16x32_bf16 v[68:71], v[202:205], v[16:19], v[68:71]
    ds_read_b128 v[16:19], v2 offset:33344
    s_waitcnt lgkmcnt(6)
    v_mfma_f32_16x16x32_bf16 v[68:71], v[206:209], v[20:23], v[68:71]
    ds_read_b128 v[20:23], v2 offset:33408
    ds_write_b32 v45, v108 offset:512
    v_mfma_f32_16x16x32_bf16 v[68:71], v[210:213], v[24:27], v[68:71]
    ds_read_b128 v[24:27], v2 offset:33472
    ds_write_b32 v45, v48 offset:528
    s_waitcnt lgkmcnt(8)
    v_mfma_f32_16x16x32_bf16 v[68:71], v[214:217], v[28:31], v[68:71]
    ds_read_b128 v[28:31], v3 offset:33280
    v_mfma_f32_16x16x32_bf16 v[68:71], v[218:221], v[32:35], v[68:71]
    ds_read_b128 v[32:35], v3 offset:33344
    v_mfma_f32_16x16x32_bf16 v[124:127], v[226:229], v[8:11], v[124:127]
    s_waitcnt lgkmcnt(8)
    v_mfma_f32_16x16x32_bf16 v[68:71], v[222:225], v[36:39], v[68:71]
    ds_read_b128 v[36:39], v3 offset:33408
    v_mfma_f32_16x16x32_bf16 v[68:71], v[226:229], v[40:43], v[68:71]
    ds_read_b128 v[40:43], v3 offset:33472
    s_waitcnt lgkmcnt(8)
    v_mfma_f32_16x16x32_bf16 v[72:75], v[166:169], v[12:15], 0
    v_mfma_f32_16x16x32_bf16 v[88:91], v[12:15], v[12:15], 0
    v_mfma_f32_16x16x32_bf16 v[112:115], v[8:11], v[12:15], 0
    ds_read_b128 v[12:15], v4 offset:33280
    v_mfma_f32_16x16x32_bf16 v[72:75], v[170:173], v[16:19], v[72:75]
    v_mfma_f32_16x16x32_bf16 v[88:91], v[16:19], v[16:19], v[88:91]
    v_mfma_f32_16x16x32_bf16 v[112:115], v[8:11], v[16:19], v[112:115]
    ds_read_b128 v[16:19], v4 offset:33344
    s_waitcnt lgkmcnt(7)
    v_mfma_f32_16x16x32_bf16 v[72:75], v[174:177], v[20:23], v[72:75]
    v_mfma_f32_16x16x32_bf16 v[88:91], v[20:23], v[20:23], v[88:91]
    v_mfma_f32_16x16x32_bf16 v[112:115], v[8:11], v[20:23], v[112:115]
    ds_read_b128 v[20:23], v4 offset:33408
    v_mfma_f32_16x16x32_bf16 v[72:75], v[178:181], v[24:27], v[72:75]
    v_mfma_f32_16x16x32_bf16 v[88:91], v[24:27], v[24:27], v[88:91]
    v_mfma_f32_16x16x32_bf16 v[112:115], v[8:11], v[24:27], v[112:115]
    ds_read_b128 v[24:27], v4 offset:33472
    s_waitcnt lgkmcnt(6)
    v_mfma_f32_16x16x32_bf16 v[72:75], v[182:185], v[28:31], v[72:75]
    ds_read_b128 v[28:31], v5 offset:33280
    v_mfma_f32_16x16x32_bf16 v[72:75], v[186:189], v[32:35], v[72:75]
    ds_read_b128 v[32:35], v5 offset:33344
    s_waitcnt lgkmcnt(6)
    v_mfma_f32_16x16x32_bf16 v[72:75], v[190:193], v[36:39], v[72:75]
    ds_read_b128 v[36:39], v5 offset:33408
    v_cndmask_b32_e64 v48, v88, v89, s[32:33]
    v_cndmask_b32_e64 v48, v48, v90, s[34:35]
    v_cndmask_b32_e64 v48, v48, v91, s[36:37]
    v_mfma_f32_16x16x32_bf16 v[72:75], v[194:197], v[40:43], v[72:75]
    ds_read_b128 v[40:43], v5 offset:33472
    s_waitcnt lgkmcnt(6)
    v_mfma_f32_16x16x32_bf16 v[72:75], v[198:201], v[12:15], v[72:75]
    ds_read_b128 v[12:15], v2 offset:49920
    ds_write_b32 v45, v112 offset:1024
    v_mfma_f32_16x16x32_bf16 v[72:75], v[202:205], v[16:19], v[72:75]
    ds_read_b128 v[16:19], v2 offset:49984
    ds_write_b32 v45, v48 offset:1040
    s_waitcnt lgkmcnt(8)
    v_mfma_f32_16x16x32_bf16 v[72:75], v[206:209], v[20:23], v[72:75]
    ds_read_b128 v[20:23], v2 offset:50048
    v_lshlrev_b32 v60, 5, v0
    v_mfma_f32_16x16x32_bf16 v[72:75], v[210:213], v[24:27], v[72:75]
    ds_read_b128 v[24:27], v2 offset:50112
    s_lshl_b32 s47, s55, 14
    s_add_u32 s47, s47, 26247168
    s_waitcnt lgkmcnt(8)
    v_mfma_f32_16x16x32_bf16 v[72:75], v[214:217], v[28:31], v[72:75]
    ds_read_b128 v[28:31], v3 offset:49920
    s_lshr_b32 s28, s20, 2
    s_lshl_b32 s28, s28, 11
    v_mfma_f32_16x16x32_bf16 v[72:75], v[218:221], v[32:35], v[72:75]
    ds_read_b128 v[32:35], v3 offset:49984
    s_add_u32 s47, s47, s28
    s_waitcnt lgkmcnt(8)
    v_mfma_f32_16x16x32_bf16 v[72:75], v[222:225], v[36:39], v[72:75]
    ds_read_b128 v[36:39], v3 offset:50048
    v_mfma_f32_16x16x32_bf16 v[72:75], v[226:229], v[40:43], v[72:75]
    ds_read_b128 v[40:43], v3 offset:50112
    s_cmp_eq_u32 s22, 0
    s_cselect_b64 exec, -1, 0
    buffer_load_dwordx4 v[128:131], v60, s[8:11], s47 offen sc1
    buffer_load_dwordx4 v[132:135], v60, s[8:11], s47 offen offset:16 sc1
    s_mov_b64 exec, -1
    s_waitcnt lgkmcnt(7)
    v_mfma_f32_16x16x32_bf16 v[76:79], v[166:169], v[12:15], 0
    v_mfma_f32_16x16x32_bf16 v[92:95], v[12:15], v[12:15], 0
    v_mfma_f32_16x16x32_bf16 v[116:119], v[8:11], v[12:15], 0
    ds_read_b128 v[12:15], v4 offset:49920
    v_mfma_f32_16x16x32_bf16 v[76:79], v[170:173], v[16:19], v[76:79]
    v_mfma_f32_16x16x32_bf16 v[92:95], v[16:19], v[16:19], v[92:95]
    v_mfma_f32_16x16x32_bf16 v[116:119], v[8:11], v[16:19], v[116:119]
    ds_read_b128 v[16:19], v4 offset:49984
    s_waitcnt lgkmcnt(6)
    v_mfma_f32_16x16x32_bf16 v[76:79], v[174:177], v[20:23], v[76:79]
    v_mfma_f32_16x16x32_bf16 v[92:95], v[20:23], v[20:23], v[92:95]
    v_mfma_f32_16x16x32_bf16 v[116:119], v[8:11], v[20:23], v[116:119]
    ds_read_b128 v[20:23], v4 offset:50048
    v_mfma_f32_16x16x32_bf16 v[76:79], v[178:181], v[24:27], v[76:79]
    v_mfma_f32_16x16x32_bf16 v[92:95], v[24:27], v[24:27], v[92:95]
    v_mfma_f32_16x16x32_bf16 v[116:119], v[8:11], v[24:27], v[116:119]
    ds_read_b128 v[24:27], v4 offset:50112
    s_waitcnt lgkmcnt(6)
    v_mfma_f32_16x16x32_bf16 v[76:79], v[182:185], v[28:31], v[76:79]
    ds_read_b128 v[28:31], v5 offset:49920
    v_mfma_f32_16x16x32_bf16 v[76:79], v[186:189], v[32:35], v[76:79]
    ds_read_b128 v[32:35], v5 offset:49984
    s_waitcnt lgkmcnt(6)
    v_mfma_f32_16x16x32_bf16 v[76:79], v[190:193], v[36:39], v[76:79]
    ds_read_b128 v[36:39], v5 offset:50048
    v_cndmask_b32_e64 v48, v92, v93, s[32:33]
    v_cndmask_b32_e64 v48, v48, v94, s[34:35]
    v_cndmask_b32_e64 v48, v48, v95, s[36:37]
    v_mfma_f32_16x16x32_bf16 v[76:79], v[194:197], v[40:43], v[76:79]
    ds_read_b128 v[40:43], v5 offset:50112
    s_waitcnt lgkmcnt(6)
    v_mfma_f32_16x16x32_bf16 v[76:79], v[198:201], v[12:15], v[76:79]
    ds_write_b32 v45, v116 offset:1536
    ds_write_b32 v45, v48 offset:1552
    v_mfma_f32_16x16x32_bf16 v[76:79], v[202:205], v[16:19], v[76:79]
    s_waitcnt lgkmcnt(6)
    v_mfma_f32_16x16x32_bf16 v[76:79], v[206:209], v[20:23], v[76:79]
    v_mfma_f32_16x16x32_bf16 v[76:79], v[210:213], v[24:27], v[76:79]
    s_waitcnt lgkmcnt(4)
    v_mfma_f32_16x16x32_bf16 v[76:79], v[214:217], v[28:31], v[76:79]
    v_mfma_f32_16x16x32_bf16 v[76:79], v[218:221], v[32:35], v[76:79]
    s_waitcnt lgkmcnt(2)
    v_mfma_f32_16x16x32_bf16 v[76:79], v[222:225], v[36:39], v[76:79]
    v_mfma_f32_16x16x32_bf16 v[76:79], v[226:229], v[40:43], v[76:79]
    global_load_dwordx4 a[80:83], v[136:137], off
    global_load_dwordx4 a[84:87], v[138:139], off
    global_load_dwordx4 a[88:91], v[140:141], off
    s_waitcnt vmcnt(3)
    s_branch L_common
L_layer1:
    s_waitcnt vmcnt(0)
    s_barrier
    s_cmp_lg_u32 s22, 0
    s_cbranch_scc1 L_np3_interleave_layers__grouped_kv_mqa__sliding_local_dilated__prompt_kernel
    s_lshl_b32 s23, s20, 7
    s_lshl_b32 s28, s21, 3
    s_add_u32 s23, s23, s28
    s_add_u32 s23, s23, s56
    s_add_u32 s23, s23, 12288
    v_mov_b32 v61, 0
    v_mov_b32 v62, s50
    v_mov_b32 v63, s3
    s_mov_b64 vcc, s[40:41]
    s_mov_b64 exec, 1
    s_cbranch_vccnz L_slow_0
    buffer_store_dwordx2 v[62:63], v61, s[8:11], s23 offen
L_back_0:
    s_mov_b64 exec, -1
L_np3_interleave_layers__grouped_kv_mqa__sliding_local_dilated__prompt_kernel:
    s_mul_i32 s23, s16, 4
    s_add_u32 s23, s23, 74752
    v_add_u32 v2, s23, v1
    s_mul_i32 s23, s17, 4
    s_add_u32 s23, s23, 74752
    v_add_u32 v3, s23, v1
    s_mul_i32 s23, s18, 4
    s_add_u32 s23, s23, 74752
    v_add_u32 v4, s23, v1
    s_mul_i32 s23, s19, 4
    s_add_u32 s23, s23, 74752
    v_add_u32 v5, s23, v1
    v_lshrrev_b32 v48, 2, v6
    v_cmp_eq_u32 s[30:31], v48, v7
    v_lshlrev_b32 v45, 5, v6
    s_lshl_b32 s23, s22, 2
    s_add_u32 s23, s23, 140288
    v_add_u32 v45, s23, v45
    v_mov_b32 v48, 143360
    v_cndmask_b32_e64 v45, v48, v45, s[30:31]
    v_lshlrev_b32 v46, 5, v6
    v_add_u32 v46, 140288, v46
    s_lshl_b32 s23, s22, 7
    s_add_u32 s23, s23, 142848
    v_lshlrev_b32 v44, 2, v6
    v_add_u32 v44, s23, v44
    v_lshlrev_b32 v47, 4, v7
    v_add_u32 v47, s23, v47
    v_and_b32 v61, 7, v0
    v_lshlrev_b32 v61, 3, v61
    s_lshl_b32 s23, s20, 7
    v_add_u32 v61, s23, v61
    s_add_u32 s45, s56, 12288
    v_add_u32 v61, s45, v61
    buffer_load_dwordx2 v[62:63], v61, s[8:11], 0 offen sc1
    s_waitcnt vmcnt(0)
    v_cmp_ne_u32 vcc, s50, v62
    v_cmp_ne_u32 s[28:29], s3, v63
    s_nop 0
    s_or_b64 vcc, vcc, s[28:29]
    s_cbranch_vccz L_seen3_interleave_layers__grouped_kv_mqa__sliding_local_dilated__prompt_kernel_4
    s_mov_b32 s45, 0x10000
L_poll3_interleave_layers__grouped_kv_mqa__sliding_local_dilated__prompt_kernel_4:
    buffer_load_dwordx2 v[62:63], v61, s[8:11], 0 offen sc1
    s_waitcnt vmcnt(0)
    v_cmp_ne_u32 vcc, s50, v62
    v_cmp_ne_u32 s[28:29], s3, v63
    s_nop 0
    s_or_b64 vcc, vcc, s[28:29]
    s_sub_u32 s45, s45, 1
    s_cmp_eq_u32 s45, 0
    s_cbranch_scc1 L_poll3_interleave_layers__grouped_kv_mqa__sliding_local_dilated__prompt_kernel_4_d
    s_cbranch_vccnz L_poll3_interleave_layers__grouped_kv_mqa__sliding_local_dilated__prompt_kernel_4
L_poll3_interleave_layers__grouped_kv_mqa__sliding_local_dilated__prompt_kernel_4_d:
L_seen3_interleave_layers__grouped_kv_mqa__sliding_local_dilated__prompt_kernel_4:
    s_mov_b32 s55, 1
    s_mul_i32 s23, s55, 131072
    s_add_u32 s48, s23, 3211264
    s_add_u32 s49, s23, 3276800
    s_mul_i32 s23, s55, 8388608
    s_add_u32 s51, s23, 8388608
    s_mov_b32 s52, 10485760
    s_mov_b32 s53, 12582912
    s_mov_b32 s54, 10485760
    s_lshl_b32 s23, s55, 14
    s_add_u32 s56, s23, 26214400
    s_lshl_b32 s23, s44, 14
    s_lshl_b32 s28, s22, 12
    s_add_u32 s23, s23, s28
    s_add_u32 s23, s23, 16777216
    buffer_load_dwordx4 v[64:67], v1, s[8:11], s23 offen offset:0 sc1
    buffer_load_dwordx4 v[68:71], v1, s[8:11], s23 offen offset:1024 sc1
    buffer_load_dwordx4 v[72:75], v1, s[8:11], s23 offen offset:2048 sc1
    buffer_load_dwordx4 v[76:79], v1, s[8:11], s23 offen offset:3072 sc1
    s_lshl_b32 s46, s20, 2
    s_mul_i32 s25, s22, 16384
    s_add_u32 s25, s25, 74752
    s_lshl_b32 s24, s22, 12
    s_add_u32 s24, s24, s51
    s_add_u32 s23, s46, 0
    s_lshl_b32 s23, s23, 14
    s_add_u32 s27, s23, s24
    s_add_u32 m0, s25, 0
    s_nop 0
    buffer_load_dwordx4 v1, s[8:11], s27 offen offset:0 sc1 lds
    buffer_load_dwordx4 v1, s[8:11], s27 offen offset:1024 sc1 lds
    buffer_load_dwordx4 v1, s[8:11], s27 offen offset:2048 sc1 lds
    buffer_load_dwordx4 v1, s[8:11], s27 offen offset:3072 sc1 lds
    s_barrier
    s_add_u32 s23, s46, 1
    s_lshl_b32 s23, s23, 14
    s_add_u32 s27, s23, s24
    s_add_u32 m0, s25, 4096
    s_nop 0
    buffer_load_dwordx4 v1, s[8:11], s27 offen offset:0 sc1 lds
    buffer_load_dwordx4 v1, s[8:11], s27 offen offset:1024 sc1 lds
    buffer_load_dwordx4 v1, s[8:11], s27 offen offset:2048 sc1 lds
    buffer_load_dwordx4 v1, s[8:11], s27 offen offset:3072 sc1 lds
    s_waitcnt vmcnt(11)
    v_mfma_f32_16x16x32_bf16 v[96:99], v[64:67], v[64:67], 0
    v_mfma_f32_16x16x32_bf16 v[100:103], v[8:11], v[64:67], 0
    v_mfma_f32_16x16x32_bf16 v[80:83], v[230:233], v[64:67], 0
    v_mfma_f32_16x16x32_bf16 v[84:87], v[64:67], v[230:233], 0
    s_waitcnt vmcnt(10)
    v_mfma_f32_16x16x32_bf16 v[96:99], v[68:71], v[68:71], v[96:99]
    v_mfma_f32_16x16x32_bf16 v[100:103], v[8:11], v[68:71], v[100:103]
    v_mfma_f32_16x16x32_bf16 v[80:83], v[234:237], v[68:71], v[80:83]
    v_mfma_f32_16x16x32_bf16 v[84:87], v[68:71], v[234:237], v[84:87]
    s_waitcnt vmcnt(9)
    v_mfma_f32_16x16x32_bf16 v[96:99], v[72:75], v[72:75], v[96:99]
    v_mfma_f32_16x16x32_bf16 v[100:103], v[8:11], v[72:75], v[100:103]
    v_mfma_f32_16x16x32_bf16 v[80:83], v[238:241], v[72:75], v[80:83]
    v_mfma_f32_16x16x32_bf16 v[84:87], v[72:75], v[238:241], v[84:87]
    s_waitcnt vmcnt(8)
    v_mfma_f32_16x16x32_bf16 v[96:99], v[76:79], v[76:79], v[96:99]
    v_mfma_f32_16x16x32_bf16 v[100:103], v[8:11], v[76:79], v[100:103]
    v_mfma_f32_16x16x32_bf16 v[80:83], v[242:245], v[76:79], v[80:83]
    v_mfma_f32_16x16x32_bf16 v[84:87], v[76:79], v[242:245], v[84:87]
    s_nop 4
    v_cndmask_b32_e64 v48, v96, v97, s[32:33]
    v_cndmask_b32_e64 v48, v48, v98, s[34:35]
    v_cndmask_b32_e64 v48, v48, v99, s[36:37]
    ds_write_b32 v143, v100 offset:0
    ds_write_b32 v143, v48 offset:16
    v_cndmask_b32_e64 v80, v80, v84, s[38:39]
    v_cndmask_b32_e64 v81, v81, v85, s[38:39]
    v_cndmask_b32_e64 v82, v82, v86, s[38:39]
    v_cndmask_b32_e64 v83, v83, v87, s[38:39]
    ds_write_b128 v106, v[80:83]
    s_waitcnt lgkmcnt(0)
    s_barrier
    ds_read_b128 v[48:51], v158 offset:0
    ds_read_b128 v[52:55], v158 offset:16
    ds_read_b128 v[108:111], v107 offset:0
    ds_read_b128 v[112:115], v107 offset:2048
    ds_read_b128 v[116:119], v107 offset:4096
    ds_read_b128 v[120:123], v107 offset:6144
    ds_read_b128 v[124:127], v107 offset:1024
    ds_read_b128 v[128:131], v107 offset:3072
    ds_read_b128 v[132:135], v107 offset:5120
    ds_read_b128 v[136:139], v107 offset:7168
    s_waitcnt lgkmcnt(8)
    v_add_f32 v48, v48, v49
    v_add_f32 v52, v52, v53
    v_add_f32 v50, v50, v51
    v_add_f32 v54, v54, v55
    v_add_f32 v48, v48, v50
    v_add_f32 v52, v52, v54
    v_mul_f32 v48, 0x3b000000, v48
    v_mul_f32 v52, 0x3b000000, v52
    v_fma_f32 v52, -v48, v48, v52
    v_max_f32 v52, 0, v52
    v_add_f32 v52, 0x3727c5ac, v52
    v_rsq_f32 v140, v52
    v_sub_f32 v48, 0, v48
    v_mul_f32 v141, v48, v140
    ds_write_b32 v142, v140
    ds_write_b32 v142, v141 offset:64
    s_waitcnt lgkmcnt(0)
    ds_read_b128 v[144:147], v159
    ds_read_b128 v[148:151], v159 offset:64
    v_add_f32 v108, v108, v112
    v_add_f32 v116, v116, v120
    v_add_f32 v109, v109, v113
    v_add_f32 v117, v117, v121
    v_add_f32 v110, v110, v114
    v_add_f32 v118, v118, v122
    v_add_f32 v111, v111, v115
    v_add_f32 v119, v119, v123
    v_add_f32 v108, v108, v116
    v_add_f32 v109, v109, v117
    v_add_f32 v110, v110, v118
    v_add_f32 v111, v111, v119
    v_add_f32 v124, v124, v128
    v_add_f32 v132, v132, v136
    v_add_f32 v125, v125, v129
    v_add_f32 v133, v133, v137
    v_add_f32 v126, v126, v130
    v_add_f32 v134, v134, v138
    v_add_f32 v127, v127, v131
    v_add_f32 v135, v135, v139
    v_add_f32 v124, v124, v132
    v_add_f32 v125, v125, v133
    v_add_f32 v126, v126, v134
    v_add_f32 v127, v127, v135
    s_waitcnt lgkmcnt(0)
    v_cndmask_b32_e64 v144, v140, v144, s[38:39]
    v_cndmask_b32_e64 v148, v141, v148, s[38:39]
    v_cndmask_b32_e64 v145, v140, v145, s[38:39]
    v_cndmask_b32_e64 v149, v141, v149, s[38:39]
    v_cndmask_b32_e64 v146, v140, v146, s[38:39]
    v_cndmask_b32_e64 v150, v141, v150, s[38:39]
    v_cndmask_b32_e64 v147, v140, v147, s[38:39]
    v_cndmask_b32_e64 v151, v141, v151, s[38:39]
    v_mul_f32 v154, v148, v124
    v_mul_f32 v155, v149, v125
    v_mul_f32 v156, v150, v126
    v_mul_f32 v157, v151, v127
    v_fma_f32 v154, v108, v144, v154
    v_fma_f32 v155, v109, v145, v155
    v_fma_f32 v156, v110, v146, v156
    v_fma_f32 v157, v111, v147, v157
    v_cvt_pk_bf16_f32 v152, v154, v155
    v_cvt_pk_bf16_f32 v153, v156, v157
    s_cmp_eq_u32 s22, 0
    s_cselect_b64 exec, -1, 0
    buffer_store_dwordx2 v[152:153], v104, s[8:11], s59 offen sc1
    s_mov_b64 exec, -1
    s_waitcnt vmcnt(5)
    s_barrier
    ds_read_b128 v[12:15], v2 offset:0
    ds_read_b128 v[16:19], v2 offset:1024
    ds_read_b128 v[20:23], v2 offset:2048
    ds_read_b128 v[24:27], v2 offset:3072
    ds_read_b128 v[28:31], v3 offset:0
    ds_read_b128 v[32:35], v3 offset:1024
    ds_read_b128 v[36:39], v3 offset:2048
    ds_read_b128 v[40:43], v3 offset:3072
    s_waitcnt lgkmcnt(6)
    v_mfma_f32_16x16x32_bf16 v[64:67], v[166:169], v[12:15], 0
    v_mfma_f32_16x16x32_bf16 v[80:83], v[12:15], v[12:15], 0
    v_mfma_f32_16x16x32_bf16 v[104:107], v[8:11], v[12:15], 0
    ds_read_b128 v[12:15], v4 offset:0
    s_add_u32 s23, s46, 2
    s_lshl_b32 s23, s23, 14
    s_add_u32 s27, s23, s24
    s_add_u32 m0, s25, 8192
    s_nop 0
    buffer_load_dwordx4 v1, s[8:11], s27 offen offset:0 sc1 lds
    v_mfma_f32_16x16x32_bf16 v[64:67], v[170:173], v[16:19], v[64:67]
    v_mfma_f32_16x16x32_bf16 v[80:83], v[16:19], v[16:19], v[80:83]
    v_mfma_f32_16x16x32_bf16 v[104:107], v[8:11], v[16:19], v[104:107]
    ds_read_b128 v[16:19], v4 offset:1024
    buffer_load_dwordx4 v1, s[8:11], s27 offen offset:1024 sc1 lds
    s_waitcnt lgkmcnt(6)
    v_mfma_f32_16x16x32_bf16 v[64:67], v[174:177], v[20:23], v[64:67]
    v_mfma_f32_16x16x32_bf16 v[80:83], v[20:23], v[20:23], v[80:83]
    v_mfma_f32_16x16x32_bf16 v[104:107], v[8:11], v[20:23], v[104:107]
    ds_read_b128 v[20:23], v4 offset:2048
    buffer_load_dwordx4 v1, s[8:11], s27 offen offset:2048 sc1 lds
    v_mfma_f32_16x16x32_bf16 v[64:67], v[178:181], v[24:27], v[64:67]
    v_mfma_f32_16x16x32_bf16 v[80:83], v[24:27], v[24:27], v[80:83]
    v_mfma_f32_16x16x32_bf16 v[104:107], v[8:11], v[24:27], v[104:107]
    ds_read_b128 v[24:27], v4 offset:3072
    buffer_load_dwordx4 v1, s[8:11], s27 offen offset:3072 sc1 lds
    s_waitcnt lgkmcnt(6)
    v_mfma_f32_16x16x32_bf16 v[64:67], v[182:185], v[28:31], v[64:67]
    ds_read_b128 v[28:31], v5 offset:0
    v_mfma_f32_16x16x32_bf16 v[124:127], v[166:169], v[8:11], 0
    v_mfma_f32_16x16x32_bf16 v[64:67], v[186:189], v[32:35], v[64:67]
    ds_read_b128 v[32:35], v5 offset:1024
    v_mfma_f32_16x16x32_bf16 v[124:127], v[170:173], v[8:11], v[124:127]
    s_waitcnt lgkmcnt(6)
    v_mfma_f32_16x16x32_bf16 v[64:67], v[190:193], v[36:39], v[64:67]
    ds_read_b128 v[36:39], v5 offset:2048
    v_cndmask_b32_e64 v48, v80, v81, s[32:33]
    v_mfma_f32_16x16x32_bf16 v[64:67], v[194:197], v[40:43], v[64:67]
    ds_read_b128 v[40:43], v5 offset:3072
    v_cndmask_b32_e64 v48, v48, v82, s[34:35]
    s_waitcnt lgkmcnt(6)
    v_mfma_f32_16x16x32_bf16 v[64:67], v[198:201], v[12:15], v[64:67]
    v_cndmask_b32_e64 v48, v48, v83, s[36:37]
    s_waitcnt vmcnt(5)
    s_barrier
    ds_read_b128 v[12:15], v2 offset:4096
    v_mfma_f32_16x16x32_bf16 v[64:67], v[202:205], v[16:19], v[64:67]
    ds_read_b128 v[16:19], v2 offset:5120
    s_waitcnt lgkmcnt(6)
    v_mfma_f32_16x16x32_bf16 v[64:67], v[206:209], v[20:23], v[64:67]
    ds_read_b128 v[20:23], v2 offset:6144
    ds_write_b32 v45, v104 offset:0
    v_mfma_f32_16x16x32_bf16 v[64:67], v[210:213], v[24:27], v[64:67]
    ds_read_b128 v[24:27], v2 offset:7168
    ds_write_b32 v45, v48 offset:16
    s_waitcnt lgkmcnt(8)
    v_mfma_f32_16x16x32_bf16 v[64:67], v[214:217], v[28:31], v[64:67]
    ds_read_b128 v[28:31], v3 offset:4096
    s_waitcnt vmcnt(4)
    s_lshl_b32 s29, s55, 14
    s_add_u32 s29, s29, 26247168
    v_mfma_f32_16x16x32_bf16 v[64:67], v[218:221], v[32:35], v[64:67]
    ds_read_b128 v[32:35], v3 offset:5120
    s_waitcnt lgkmcnt(8)
    v_mfma_f32_16x16x32_bf16 v[64:67], v[222:225], v[36:39], v[64:67]
    ds_read_b128 v[36:39], v3 offset:6144
    s_lshl_b32 s28, s20, 3
    s_add_u32 s28, s28, s21
    s_lshl_b32 s28, s28, 3
    s_add_u32 s28, s28, s29
    v_lshlrev_b32 v61, 11, v0
    v_mov_b32 v62, s50
    v_mov_b32 v63, s3
    s_cmp_eq_u32 s22, 0
    s_cselect_b64 exec, 0xff, 0
    buffer_store_dwordx2 v[62:63], v61, s[8:11], s28 offen sc1
    s_mov_b64 exec, -1
    v_mfma_f32_16x16x32_bf16 v[64:67], v[226:229], v[40:43], v[64:67]
    ds_read_b128 v[40:43], v3 offset:7168
    s_waitcnt lgkmcnt(8)
    v_mfma_f32_16x16x32_bf16 v[68:71], v[166:169], v[12:15], 0
    v_mfma_f32_16x16x32_bf16 v[84:87], v[12:15], v[12:15], 0
    v_mfma_f32_16x16x32_bf16 v[108:111], v[8:11], v[12:15], 0
    ds_read_b128 v[12:15], v4 offset:4096
    s_add_u32 s23, s46, 3
    s_lshl_b32 s23, s23, 14
    s_add_u32 s27, s23, s24
    s_add_u32 m0, s25, 12288
    s_nop 0
    buffer_load_dwordx4 v1, s[8:11], s27 offen offset:0 sc1 lds
    v_mfma_f32_16x16x32_bf16 v[68:71], v[170:173], v[16:19], v[68:71]
    v_mfma_f32_16x16x32_bf16 v[84:87], v[16:19], v[16:19], v[84:87]
    v_mfma_f32_16x16x32_bf16 v[108:111], v[8:11], v[16:19], v[108:111]
    ds_read_b128 v[16:19], v4 offset:5120
    v_mfma_f32_16x16x32_bf16 v[124:127], v[174:177], v[8:11], v[124:127]
    buffer_load_dwordx4 v1, s[8:11], s27 offen offset:1024 sc1 lds
    s_waitcnt lgkmcnt(7)
    v_mfma_f32_16x16x32_bf16 v[68:71], v[174:177], v[20:23], v[68:71]
    v_mfma_f32_16x16x32_bf16 v[124:127], v[178:181], v[8:11], v[124:127]
    v_mfma_f32_16x16x32_bf16 v[84:87], v[20:23], v[20:23], v[84:87]
    v_mfma_f32_16x16x32_bf16 v[124:127], v[182:185], v[8:11], v[124:127]
    v_mfma_f32_16x16x32_bf16 v[108:111], v[8:11], v[20:23], v[108:111]
    ds_read_b128 v[20:23], v4 offset:6144
    buffer_load_dwordx4 v1, s[8:11], s27 offen offset:2048 sc1 lds
    v_mfma_f32_16x16x32_bf16 v[68:71], v[178:181], v[24:27], v[68:71]
    v_mfma_f32_16x16x32_bf16 v[124:127], v[186:189], v[8:11], v[124:127]
    v_mfma_f32_16x16x32_bf16 v[84:87], v[24:27], v[24:27], v[84:87]
    v_mfma_f32_16x16x32_bf16 v[124:127], v[190:193], v[8:11], v[124:127]
    v_mfma_f32_16x16x32_bf16 v[108:111], v[8:11], v[24:27], v[108:111]
    ds_read_b128 v[24:27], v4 offset:7168
    v_mfma_f32_16x16x32_bf16 v[124:127], v[194:197], v[8:11], v[124:127]
    buffer_load_dwordx4 v1, s[8:11], s27 offen offset:3072 sc1 lds
    s_waitcnt lgkmcnt(6)
    v_mfma_f32_16x16x32_bf16 v[68:71], v[182:185], v[28:31], v[68:71]
    ds_read_b128 v[28:31], v5 offset:4096
    v_mfma_f32_16x16x32_bf16 v[68:71], v[186:189], v[32:35], v[68:71]
    ds_read_b128 v[32:35], v5 offset:5120
    v_mfma_f32_16x16x32_bf16 v[124:127], v[198:201], v[8:11], v[124:127]
    s_waitcnt lgkmcnt(6)
    v_mfma_f32_16x16x32_bf16 v[68:71], v[190:193], v[36:39], v[68:71]
    ds_read_b128 v[36:39], v5 offset:6144
    v_cndmask_b32_e64 v48, v84, v85, s[32:33]
    v_mfma_f32_16x16x32_bf16 v[68:71], v[194:197], v[40:43], v[68:71]
    ds_read_b128 v[40:43], v5 offset:7168
    v_cndmask_b32_e64 v48, v48, v86, s[34:35]
    s_waitcnt lgkmcnt(6)
    v_mfma_f32_16x16x32_bf16 v[68:71], v[198:201], v[12:15], v[68:71]
    v_cndmask_b32_e64 v48, v48, v87, s[36:37]
    s_waitcnt vmcnt(5)
    s_barrier
    ds_read_b128 v[12:15], v2 offset:8192
    v_mfma_f32_16x16x32_bf16 v[68:71], v[202:205], v[16:19], v[68:71]
    ds_read_b128 v[16:19], v2 offset:9216
    s_waitcnt lgkmcnt(6)
    v_mfma_f32_16x16x32_bf16 v[68:71], v[206:209], v[20:23], v[68:71]
    ds_read_b128 v[20:23], v2 offset:10240
    ds_write_b32 v45, v108 offset:512
    v_mfma_f32_16x16x32_bf16 v[68:71], v[210:213], v[24:27], v[68:71]
    ds_read_b128 v[24:27], v2 offset:11264
    ds_write_b32 v45, v48 offset:528
    s_waitcnt lgkmcnt(8)
    v_mfma_f32_16x16x32_bf16 v[68:71], v[214:217], v[28:31], v[68:71]
    ds_read_b128 v[28:31], v3 offset:8192
    v_mfma_f32_16x16x32_bf16 v[68:71], v[218:221], v[32:35], v[68:71]
    ds_read_b128 v[32:35], v3 offset:9216
    v_mfma_f32_16x16x32_bf16 v[124:127], v[202:205], v[8:11], v[124:127]
    s_waitcnt lgkmcnt(8)
    v_mfma_f32_16x16x32_bf16 v[68:71], v[222:225], v[36:39], v[68:71]
    ds_read_b128 v[36:39], v3 offset:10240
    v_mfma_f32_16x16x32_bf16 v[68:71], v[226:229], v[40:43], v[68:71]
    ds_read_b128 v[40:43], v3 offset:11264
    v_mfma_f32_16x16x32_bf16 v[124:127], v[206:209], v[8:11], v[124:127]
    s_waitcnt lgkmcnt(8)
    v_mfma_f32_16x16x32_bf16 v[72:75], v[166:169], v[12:15], 0
    v_mfma_f32_16x16x32_bf16 v[124:127], v[210:213], v[8:11], v[124:127]
    v_mfma_f32_16x16x32_bf16 v[88:91], v[12:15], v[12:15], 0
    v_mfma_f32_16x16x32_bf16 v[124:127], v[214:217], v[8:11], v[124:127]
    v_mfma_f32_16x16x32_bf16 v[112:115], v[8:11], v[12:15], 0
    ds_read_b128 v[12:15], v4 offset:8192
    v_mfma_f32_16x16x32_bf16 v[72:75], v[170:173], v[16:19], v[72:75]
    v_mfma_f32_16x16x32_bf16 v[124:127], v[218:221], v[8:11], v[124:127]
    v_mfma_f32_16x16x32_bf16 v[88:91], v[16:19], v[16:19], v[88:91]
    v_mfma_f32_16x16x32_bf16 v[124:127], v[222:225], v[8:11], v[124:127]
    v_mfma_f32_16x16x32_bf16 v[112:115], v[8:11], v[16:19], v[112:115]
    ds_read_b128 v[16:19], v4 offset:9216
    v_mfma_f32_16x16x32_bf16 v[124:127], v[226:229], v[8:11], v[124:127]
    s_waitcnt lgkmcnt(7)
    v_mfma_f32_16x16x32_bf16 v[72:75], v[174:177], v[20:23], v[72:75]
    v_mfma_f32_16x16x32_bf16 v[88:91], v[20:23], v[20:23], v[88:91]
    v_mfma_f32_16x16x32_bf16 v[112:115], v[8:11], v[20:23], v[112:115]
    ds_read_b128 v[20:23], v4 offset:10240
    v_mfma_f32_16x16x32_bf16 v[72:75], v[178:181], v[24:27], v[72:75]
    v_mfma_f32_16x16x32_bf16 v[88:91], v[24:27], v[24:27], v[88:91]
    v_mfma_f32_16x16x32_bf16 v[112:115], v[8:11], v[24:27], v[112:115]
    ds_read_b128 v[24:27], v4 offset:11264
    s_waitcnt lgkmcnt(6)
    v_mfma_f32_16x16x32_bf16 v[72:75], v[182:185], v[28:31], v[72:75]
    ds_read_b128 v[28:31], v5 offset:8192
    v_mfma_f32_16x16x32_bf16 v[72:75], v[186:189], v[32:35], v[72:75]
    ds_read_b128 v[32:35], v5 offset:9216
    s_waitcnt lgkmcnt(6)
    v_mfma_f32_16x16x32_bf16 v[72:75], v[190:193], v[36:39], v[72:75]
    ds_read_b128 v[36:39], v5 offset:10240
    v_cndmask_b32_e64 v48, v88, v89, s[32:33]
    v_cndmask_b32_e64 v48, v48, v90, s[34:35]
    v_cndmask_b32_e64 v48, v48, v91, s[36:37]
    v_mfma_f32_16x16x32_bf16 v[72:75], v[194:197], v[40:43], v[72:75]
    ds_read_b128 v[40:43], v5 offset:11264
    s_waitcnt lgkmcnt(6)
    v_mfma_f32_16x16x32_bf16 v[72:75], v[198:201], v[12:15], v[72:75]
    ds_write_b32 v45, v112 offset:1024
    ds_write_b32 v45, v48 offset:1040
    s_waitcnt vmcnt(0)
    s_barrier
    ds_read_b128 v[12:15], v2 offset:12288
    v_mfma_f32_16x16x32_bf16 v[72:75], v[202:205], v[16:19], v[72:75]
    ds_read_b128 v[16:19], v2 offset:13312
    s_waitcnt lgkmcnt(8)
    v_mfma_f32_16x16x32_bf16 v[72:75], v[206:209], v[20:23], v[72:75]
    ds_read_b128 v[20:23], v2 offset:14336
    v_mfma_f32_16x16x32_bf16 v[72:75], v[210:213], v[24:27], v[72:75]
    ds_read_b128 v[24:27], v2 offset:15360
    s_waitcnt lgkmcnt(8)
    v_mfma_f32_16x16x32_bf16 v[72:75], v[214:217], v[28:31], v[72:75]
    ds_read_b128 v[28:31], v3 offset:12288
    v_mfma_f32_16x16x32_bf16 v[72:75], v[218:221], v[32:35], v[72:75]
    ds_read_b128 v[32:35], v3 offset:13312
    s_waitcnt lgkmcnt(8)
    v_mfma_f32_16x16x32_bf16 v[72:75], v[222:225], v[36:39], v[72:75]
    ds_read_b128 v[36:39], v3 offset:14336
    v_mfma_f32_16x16x32_bf16 v[72:75], v[226:229], v[40:43], v[72:75]
    ds_read_b128 v[40:43], v3 offset:15360
    s_waitcnt lgkmcnt(6)
    v_mfma_f32_16x16x32_bf16 v[76:79], v[166:169], v[12:15], 0
    v_mfma_f32_16x16x32_bf16 v[92:95], v[12:15], v[12:15], 0
    v_mfma_f32_16x16x32_bf16 v[116:119], v[8:11], v[12:15], 0
    ds_read_b128 v[12:15], v4 offset:12288
    v_mfma_f32_16x16x32_bf16 v[76:79], v[170:173], v[16:19], v[76:79]
    v_mfma_f32_16x16x32_bf16 v[92:95], v[16:19], v[16:19], v[92:95]
    v_mfma_f32_16x16x32_bf16 v[116:119], v[8:11], v[16:19], v[116:119]
    ds_read_b128 v[16:19], v4 offset:13312
    s_waitcnt lgkmcnt(6)
    v_mfma_f32_16x16x32_bf16 v[76:79], v[174:177], v[20:23], v[76:79]
    v_mfma_f32_16x16x32_bf16 v[92:95], v[20:23], v[20:23], v[92:95]
    v_mfma_f32_16x16x32_bf16 v[116:119], v[8:11], v[20:23], v[116:119]
    ds_read_b128 v[20:23], v4 offset:14336
    v_mfma_f32_16x16x32_bf16 v[76:79], v[178:181], v[24:27], v[76:79]
    v_mfma_f32_16x16x32_bf16 v[92:95], v[24:27], v[24:27], v[92:95]
    v_mfma_f32_16x16x32_bf16 v[116:119], v[8:11], v[24:27], v[116:119]
    ds_read_b128 v[24:27], v4 offset:15360
    s_waitcnt lgkmcnt(6)
    v_mfma_f32_16x16x32_bf16 v[76:79], v[182:185], v[28:31], v[76:79]
    ds_read_b128 v[28:31], v5 offset:12288
    v_mfma_f32_16x16x32_bf16 v[76:79], v[186:189], v[32:35], v[76:79]
    ds_read_b128 v[32:35], v5 offset:13312
    s_waitcnt lgkmcnt(6)
    v_mfma_f32_16x16x32_bf16 v[76:79], v[190:193], v[36:39], v[76:79]
    ds_read_b128 v[36:39], v5 offset:14336
    v_cndmask_b32_e64 v48, v92, v93, s[32:33]
    v_cndmask_b32_e64 v48, v48, v94, s[34:35]
    v_cndmask_b32_e64 v48, v48, v95, s[36:37]
    v_mfma_f32_16x16x32_bf16 v[76:79], v[194:197], v[40:43], v[76:79]
    ds_read_b128 v[40:43], v5 offset:15360
    s_waitcnt lgkmcnt(6)
    v_mfma_f32_16x16x32_bf16 v[76:79], v[198:201], v[12:15], v[76:79]
    ds_write_b32 v45, v116 offset:1536
    ds_write_b32 v45, v48 offset:1552
    v_mfma_f32_16x16x32_bf16 v[76:79], v[202:205], v[16:19], v[76:79]
    v_lshlrev_b32 v60, 5, v0
    s_lshl_b32 s47, s55, 14
    s_add_u32 s47, s47, 26247168
    s_waitcnt lgkmcnt(6)
    v_mfma_f32_16x16x32_bf16 v[76:79], v[206:209], v[20:23], v[76:79]
    s_lshr_b32 s28, s20, 2
    s_lshl_b32 s28, s28, 11
    s_add_u32 s47, s47, s28
    v_mfma_f32_16x16x32_bf16 v[76:79], v[210:213], v[24:27], v[76:79]
    s_cmp_eq_u32 s22, 0
    s_cselect_b64 exec, -1, 0
    buffer_load_dwordx4 v[128:131], v60, s[8:11], s47 offen sc1
    buffer_load_dwordx4 v[132:135], v60, s[8:11], s47 offen offset:16 sc1
    s_mov_b64 exec, -1
    s_waitcnt lgkmcnt(4)
    v_mfma_f32_16x16x32_bf16 v[76:79], v[214:217], v[28:31], v[76:79]
    v_mfma_f32_16x16x32_bf16 v[76:79], v[218:221], v[32:35], v[76:79]
    s_waitcnt lgkmcnt(2)
    v_mfma_f32_16x16x32_bf16 v[76:79], v[222:225], v[36:39], v[76:79]
    v_mfma_f32_16x16x32_bf16 v[76:79], v[226:229], v[40:43], v[76:79]
    s_waitcnt vmcnt(0)
L_common:
    s_waitcnt lgkmcnt(0)
    s_barrier
    ds_read_b128 v[16:19], v46 offset:0
    ds_read_b128 v[20:23], v46 offset:16
    ds_read_b128 v[24:27], v46 offset:512
    ds_read_b128 v[28:31], v46 offset:528
    ds_read_b128 v[32:35], v46 offset:1024
    ds_read_b128 v[36:39], v46 offset:1040
    ds_read_b128 v[40:43], v46 offset:1536
    ds_read_b128 v[44:47], v46 offset:1552
    s_cmp_eq_u32 s22, 0
    s_cselect_b64 exec, -1, 0
    v_cmp_ne_u32 vcc, s50, v128
    v_cmp_ne_u32 s[28:29], s3, v129
    s_nop 0
    s_or_b64 vcc, vcc, s[28:29]
    v_cmp_ne_u32 s[28:29], s50, v130
    s_nop 0
    s_or_b64 vcc, vcc, s[28:29]
    v_cmp_ne_u32 s[28:29], s3, v131
    s_nop 0
    s_or_b64 vcc, vcc, s[28:29]
    v_cmp_ne_u32 s[28:29], s50, v132
    s_nop 0
    s_or_b64 vcc, vcc, s[28:29]
    v_cmp_ne_u32 s[28:29], s3, v133
    s_nop 0
    s_or_b64 vcc, vcc, s[28:29]
    v_cmp_ne_u32 s[28:29], s50, v134
    s_nop 0
    s_or_b64 vcc, vcc, s[28:29]
    v_cmp_ne_u32 s[28:29], s3, v135
    s_nop 0
    s_or_b64 vcc, vcc, s[28:29]
    s_cbranch_vccz L_kvok_interleave_layers__grouped_kv_mqa__sliding_local_dilated__prompt_kernel
    s_mov_b32 s45, 0x10000
L_kvp_interleave_layers__grouped_kv_mqa__sliding_local_dilated__prompt_kernel:
    s_sleep 2
    buffer_load_dwordx4 v[128:131], v60, s[8:11], s47 offen sc1
    buffer_load_dwordx4 v[132:135], v60, s[8:11], s47 offen offset:16 sc1
    s_waitcnt vmcnt(0)
    v_cmp_ne_u32 vcc, s50, v128
    v_cmp_ne_u32 s[28:29], s3, v129
    s_nop 0
    s_or_b64 vcc, vcc, s[28:29]
    v_cmp_ne_u32 s[28:29], s50, v130
    s_nop 0
    s_or_b64 vcc, vcc, s[28:29]
    v_cmp_ne_u32 s[28:29], s3, v131
    s_nop 0
    s_or_b64 vcc, vcc, s[28:29]
    v_cmp_ne_u32 s[28:29], s50, v132
    s_nop 0
    s_or_b64 vcc, vcc, s[28:29]
    v_cmp_ne_u32 s[28:29], s3, v133
    s_nop 0
    s_or_b64 vcc, vcc, s[28:29]
    v_cmp_ne_u32 s[28:29], s50, v134
    s_nop 0
    s_or_b64 vcc, vcc, s[28:29]
    v_cmp_ne_u32 s[28:29], s3, v135
    s_nop 0
    s_or_b64 vcc, vcc, s[28:29]
    s_sub_u32 s45, s45, 1
    s_cmp_eq_u32 s45, 0
    s_cbranch_scc1 L_kvp_interleave_layers__grouped_kv_mqa__sliding_local_dilated__prompt_kernel_d
    s_cbranch_vccnz L_kvp_interleave_layers__grouped_kv_mqa__sliding_local_dilated__prompt_kernel
L_kvp_interleave_layers__grouped_kv_mqa__sliding_local_dilated__prompt_kernel_d:
L_kvok_interleave_layers__grouped_kv_mqa__sliding_local_dilated__prompt_kernel:
    s_mov_b64 exec, -1
    s_barrier
    s_lshl_b32 s62, s22, 11
    s_add_u32 s60, s62, s48
    s_add_u32 s61, s62, s49
    s_mul_i32 s63, s22, 2112
    s_add_u32 s63, s63, 65536
    s_add_u32 s23, s60, 0
    s_add_u32 m0, s62, 0
    s_nop 0
    buffer_load_dwordx4 v1, s[8:11], s23 offen sc1 lds
    buffer_load_dwordx4 v1, s[8:11], s23 offen offset:1024 sc1 lds
    s_add_u32 s23, s61, 0
    s_add_u32 m0, s63, 0
    s_nop 0
    buffer_load_dwordx4 v1, s[8:11], s23 offen sc1 lds
    s_add_u32 m0, s63, 32
    s_nop 0
    buffer_load_dwordx4 v1, s[8:11], s23 offen offset:1024 sc1 lds
    s_waitcnt lgkmcnt(0)
    v_add_f32 v16, v16, v17
    v_add_f32 v24, v24, v25
    v_add_f32 v32, v32, v33
    v_add_f32 v40, v40, v41
    v_add_f32 v20, v20, v21
    v_add_f32 v28, v28, v29
    v_add_f32 v36, v36, v37
    v_add_f32 v44, v44, v45
    v_add_f32 v18, v18, v19
    v_add_f32 v26, v26, v27
    v_add_f32 v34, v34, v35
    v_add_f32 v42, v42, v43
    v_add_f32 v22, v22, v23
    v_add_f32 v30, v30, v31
    v_add_f32 v38, v38, v39
    v_add_f32 v46, v46, v47
    v_add_f32 v16, v16, v18
    v_add_f32 v24, v24, v26
    v_add_f32 v32, v32, v34
    v_add_f32 v40, v40, v42
    v_add_f32 v20, v20, v22
    v_add_f32 v28, v28, v30
    v_add_f32 v36, v36, v38
    v_add_f32 v44, v44, v46
    v_mul_f32 v16, 0x3b000000, v16
    v_mul_f32 v24, 0x3b000000, v24
    v_mul_f32 v32, 0x3b000000, v32
    v_mul_f32 v40, 0x3b000000, v40
    v_mul_f32 v20, 0x3b000000, v20
    v_mul_f32 v28, 0x3b000000, v28
    v_mul_f32 v36, 0x3b000000, v36
    v_mul_f32 v44, 0x3b000000, v44
    v_fma_f32 v20, -v16, v16, v20
    v_fma_f32 v28, -v24, v24, v28
    v_fma_f32 v36, -v32, v32, v36
    v_fma_f32 v44, -v40, v40, v44
    v_max_f32 v20, 0, v20
    v_max_f32 v28, 0, v28
    v_max_f32 v36, 0, v36
    v_max_f32 v44, 0, v44
    v_add_f32 v20, 0x3727c5ac, v20
    v_add_f32 v28, 0x3727c5ac, v28
    v_add_f32 v36, 0x3727c5ac, v36
    v_add_f32 v44, 0x3727c5ac, v44
    v_rsq_f32 v48, v20
    v_rsq_f32 v49, v28
    v_rsq_f32 v50, v36
    v_rsq_f32 v51, v44
    v_sub_f32 v16, 0, v16
    v_sub_f32 v24, 0, v24
    v_sub_f32 v32, 0, v32
    v_sub_f32 v40, 0, v40
    v_mul_f32 v52, v16, v48
    v_mul_f32 v53, v24, v49
    v_mul_f32 v54, v32, v50
    v_mul_f32 v55, v40, v51
    v_mul_f32 v48, 0x3eb8aa3b, v48
    v_mul_f32 v52, 0x3eb8aa3b, v52
    v_mul_f32 v49, 0x3eb8aa3b, v49
    v_mul_f32 v53, 0x3eb8aa3b, v53
    v_mul_f32 v50, 0x3eb8aa3b, v50
    v_mul_f32 v54, 0x3eb8aa3b, v54
    v_mul_f32 v51, 0x3eb8aa3b, v51
    v_mul_f32 v55, 0x3eb8aa3b, v55
    v_mul_f32 v16, v52, v124
    v_mul_f32 v17, v52, v125
    v_mul_f32 v18, v52, v126
    v_mul_f32 v19, v52, v127
    v_fma_f32 v16, v64, v48, v16
    v_fma_f32 v17, v65, v48, v17
    v_fma_f32 v18, v66, v48, v18
    v_fma_f32 v19, v67, v48, v19
    v_cvt_pk_bf16_f32 v96, v16, v17
    v_cvt_pk_bf16_f32 v97, v18, v19
    v_mul_f32 v20, v53, v124
    v_mul_f32 v21, v53, v125
    v_mul_f32 v22, v53, v126
    v_mul_f32 v23, v53, v127
    v_fma_f32 v20, v68, v49, v20
    v_fma_f32 v21, v69, v49, v21
    v_fma_f32 v22, v70, v49, v22
    v_fma_f32 v23, v71, v49, v23
    v_cvt_pk_bf16_f32 v98, v20, v21
    v_cvt_pk_bf16_f32 v99, v22, v23
    v_mul_f32 v24, v54, v124
    v_mul_f32 v25, v54, v125
    v_mul_f32 v26, v54, v126
    v_mul_f32 v27, v54, v127
    v_fma_f32 v24, v72, v50, v24
    v_fma_f32 v25, v73, v50, v25
    v_fma_f32 v26, v74, v50, v26
    v_fma_f32 v27, v75, v50, v27
    v_cvt_pk_bf16_f32 v100, v24, v25
    v_cvt_pk_bf16_f32 v101, v26, v27
    v_mul_f32 v28, v55, v124
    v_mul_f32 v29, v55, v125
    v_mul_f32 v30, v55, v126
    v_mul_f32 v31, v55, v127
    v_fma_f32 v28, v76, v51, v28
    v_fma_f32 v29, v77, v51, v29
    v_fma_f32 v30, v78, v51, v30
    v_fma_f32 v31, v79, v51, v31
    v_cvt_pk_bf16_f32 v102, v28, v29
    v_cvt_pk_bf16_f32 v103, v30, v31
    v_permlane16_swap_b32 v96, v98
    v_permlane16_swap_b32 v97, v99
    v_permlane16_swap_b32 v100, v102
    v_permlane16_swap_b32 v101, v103
    v_mov_b32 v2, v1
    v_and_b32 v5, 31, v0
    v_lshrrev_b32 v6, 5, v0
    v_lshlrev_b32 v7, 8, v6
    v_lshl_add_u32 v7, v5, 4, v7
    v_add_u32 v7, 65536, v7
    v_mov_b32 v16, 66576
    v_mov_b32 v17, 66560
    v_and_b32 v18, 27, v5
    v_cmp_eq_u32 s[28:29], 16, v18
    s_nop 1
    v_cndmask_b32_e64 v16, v16, v17, s[28:29]
    v_cmp_gt_u32 s[28:29], 16, v5
    s_nop 1
    v_cndmask_b32_e64 v3, v16, v7, s[28:29]
    v_add_u32 v7, 512, v7
    v_cndmask_b32_e64 v4, v16, v7, s[28:29]
    v_mov_b32 v16, 0x3f803f80
    v_mov_b32 v17, v16
    v_mov_b32 v18, v16
    v_mov_b32 v19, v16
    v_mul_u32_u24 v20, 1056, v0
    v_add_u32 v20, 66560, v20
    s_cmp_lg_u32 s22, 0
    s_cbranch_scc1 L_noones_interleave_layers__grouped_kv_mqa__sliding_local_dilated__prompt_kernel
    ds_write_b128 v20, v[16:19]
    v_mov_b32 v16, 0
    v_mov_b32 v17, 0
    v_mov_b32 v18, 0
    v_mov_b32 v19, 0
    ds_write_b128 v20, v[16:19] offset:16
L_noones_interleave_layers__grouped_kv_mqa__sliding_local_dilated__prompt_kernel:
    v_and_b32 v9, 15, v0
    v_lshrrev_b32 v10, 4, v0
    s_lshl_b32 s23, s21, 11
    s_lshr_b32 s28, s22, 1
    s_lshl_b32 s28, s28, 10
    s_add_u32 s23, s23, s28
    s_and_b32 s28, s22, 1
    s_lshl_b32 s28, s28, 9
    s_add_u32 s23, s23, s28
    v_lshrrev_b32 v11, 1, v10
    v_lshlrev_b32 v11, 8, v11
    v_lshl_add_u32 v11, v9, 4, v11
    v_and_b32 v8, 1, v10
    v_lshl_add_u32 v8, v8, 3, v11
    v_add_u32 v8, s23, v8
    s_lshl_b32 s59, s20, 16
    s_add_u32 s59, s59, s51
    v_mov_b32 v48, 0
    v_mov_b32 v64, 0
    v_mov_b32 v49, 0
    v_mov_b32 v65, 0
    v_mov_b32 v50, 0
    v_mov_b32 v66, 0
    v_mov_b32 v51, 0
    v_mov_b32 v67, 0
    v_mov_b32 v52, 0
    v_mov_b32 v68, 0
    v_mov_b32 v53, 0
    v_mov_b32 v69, 0
    v_mov_b32 v54, 0
    v_mov_b32 v70, 0
    v_mov_b32 v55, 0
    v_mov_b32 v71, 0
    v_mov_b32 v56, 0
    v_mov_b32 v72, 0
    v_mov_b32 v57, 0
    v_mov_b32 v73, 0
    v_mov_b32 v58, 0
    v_mov_b32 v74, 0
    v_mov_b32 v59, 0
    v_mov_b32 v75, 0
    v_mov_b32 v60, 0
    v_mov_b32 v76, 0
    v_mov_b32 v61, 0
    v_mov_b32 v77, 0
    v_mov_b32 v62, 0
    v_mov_b32 v78, 0
    v_mov_b32 v63, 0
    v_mov_b32 v79, 0
    s_waitcnt vmcnt(0)
    s_waitcnt lgkmcnt(0)
    s_barrier
    s_cmp_lg_u32 s55, 0
    s_cbranch_scc1 L_noprep_interleave_layers__grouped_kv_mqa__sliding_local_dilated__prompt_kernel
    s_lshl_b32 s46, s2, 2
    s_add_u32 s46, s46, s22
    v_mfma_f32_16x16x32_bf16 v[128:131], a[80:83], v[158:161], 0
    v_mfma_f32_16x16x32_bf16 v[132:135], a[80:83], v[162:165], 0
    s_nop 6
    v_cvt_pk_bf16_f32 v136, v128, v129
    v_cvt_pk_bf16_f32 v137, v130, v131
    v_cvt_pk_bf16_f32 v138, v132, v133
    v_cvt_pk_bf16_f32 v139, v134, v135
    s_add_u32 s27, s46, 0
    s_cmp_lt_u32 s27, 2560
    s_cselect_b64 exec, -1, 0
    s_add_u32 s27, s27, 512
    s_lshl_b32 s27, s27, 10
    buffer_store_dwordx4 v[136:139], v1, s[8:11], s27 offen sc1
    s_mov_b64 exec, -1
    v_mfma_f32_16x16x32_bf16 v[128:131], a[84:87], v[158:161], 0
    v_mfma_f32_16x16x32_bf16 v[132:135], a[84:87], v[162:165], 0
    s_nop 6
    v_cvt_pk_bf16_f32 v140, v128, v129
    v_cvt_pk_bf16_f32 v141, v130, v131
    v_cvt_pk_bf16_f32 v142, v132, v133
    v_cvt_pk_bf16_f32 v143, v134, v135
    s_add_u32 s27, s46, 1024
    s_cmp_lt_u32 s27, 2560
    s_cselect_b64 exec, -1, 0
    s_add_u32 s27, s27, 512
    s_lshl_b32 s27, s27, 10
    buffer_store_dwordx4 v[140:143], v1, s[8:11], s27 offen sc1
    s_mov_b64 exec, -1
    v_mfma_f32_16x16x32_bf16 v[128:131], a[88:91], v[158:161], 0
    v_mfma_f32_16x16x32_bf16 v[132:135], a[88:91], v[162:165], 0
    s_nop 6
    v_cvt_pk_bf16_f32 v144, v128, v129
    v_cvt_pk_bf16_f32 v145, v130, v131
    v_cvt_pk_bf16_f32 v146, v132, v133
    v_cvt_pk_bf16_f32 v147, v134, v135
    s_add_u32 s27, s46, 2048
    s_cmp_lt_u32 s27, 2560
    s_cselect_b64 exec, -1, 0
    s_add_u32 s27, s27, 512
    s_lshl_b32 s27, s27, 10
    buffer_store_dwordx4 v[144:147], v1, s[8:11], s27 offen sc1
    s_mov_b64 exec, -1
L_noprep_interleave_layers__grouped_kv_mqa__sliding_local_dilated__prompt_kernel:
    ds_read_b128 v[104:107], v2 offset:0
    ds_read_b128 v[108:111], v2 offset:1024
    ds_read_b128 v[112:115], v3 offset:0
    ds_read_b128 v[116:119], v4 offset:0
    s_waitcnt lgkmcnt(0)
    v_mfma_f32_32x32x16_bf16 v[16:31], v[104:107], v[96:99], 0
    v_mfma_f32_32x32x16_bf16 v[32:47], v[104:107], v[100:103], 0
    ds_read_b128 v[104:107], v2 offset:2048
    s_nop 9
    v_exp_f32 v16, v16
    v_exp_f32 v17, v17
    v_exp_f32 v18, v18
    v_exp_f32 v19, v19
    v_cvt_pk_bf16_f32 v80, v16, v17
    v_exp_f32 v20, v20
    v_exp_f32 v21, v21
    v_cvt_pk_bf16_f32 v81, v18, v19
    v_exp_f32 v22, v22
    v_exp_f32 v23, v23
    v_cvt_pk_bf16_f32 v82, v20, v21
    v_exp_f32 v24, v24
    ds_read_b128 v[120:123], v3 offset:1056
    ds_read_b128 v[124:127], v4 offset:1056
    v_exp_f32 v25, v25
    v_cvt_pk_bf16_f32 v83, v22, v23
    v_exp_f32 v26, v26
    v_exp_f32 v27, v27
    v_cvt_pk_bf16_f32 v84, v24, v25
    v_exp_f32 v28, v28
    v_exp_f32 v29, v29
    v_cvt_pk_bf16_f32 v85, v26, v27
    v_exp_f32 v30, v30
    v_exp_f32 v31, v31
    v_cvt_pk_bf16_f32 v86, v28, v29
    v_cvt_pk_bf16_f32 v87, v30, v31
    v_mfma_f32_32x32x16_bf16 v[16:31], v[108:111], v[96:99], 0
    s_add_u32 s23, s60, 8192
    s_add_u32 m0, s62, 8192
    s_nop 0
    buffer_load_dwordx4 v1, s[8:11], s23 offen sc1 lds
    v_exp_f32 v32, v32
    v_exp_f32 v33, v33
    v_exp_f32 v34, v34
    v_exp_f32 v35, v35
    v_cvt_pk_bf16_f32 v88, v32, v33
    v_exp_f32 v36, v36
    v_exp_f32 v37, v37
    v_cvt_pk_bf16_f32 v89, v34, v35
    v_mfma_f32_32x32x16_bf16 v[48:63], v[112:115], v[80:83], v[48:63]
    buffer_load_dwordx4 v1, s[8:11], s23 offen offset:1024 sc1 lds
    v_exp_f32 v38, v38
    v_exp_f32 v39, v39
    v_cvt_pk_bf16_f32 v90, v36, v37
    v_exp_f32 v40, v40
    v_exp_f32 v41, v41
    v_cvt_pk_bf16_f32 v91, v38, v39
    v_exp_f32 v42, v42
    v_exp_f32 v43, v43
    v_mfma_f32_32x32x16_bf16 v[48:63], v[116:119], v[84:87], v[48:63]
    s_waitcnt lgkmcnt(0)
    v_cvt_pk_bf16_f32 v92, v40, v41
    v_exp_f32 v44, v44
    v_exp_f32 v45, v45
    v_cvt_pk_bf16_f32 v93, v42, v43
    v_exp_f32 v46, v46
    v_exp_f32 v47, v47
    v_cvt_pk_bf16_f32 v94, v44, v45
    v_cvt_pk_bf16_f32 v95, v46, v47
    s_add_u32 s23, s61, 8192
    s_add_u32 m0, s63, 8448
    s_nop 0
    buffer_load_dwordx4 v1, s[8:11], s23 offen sc1 lds
    s_add_u32 m0, s63, 8480
    s_nop 0
    buffer_load_dwordx4 v1, s[8:11], s23 offen offset:1024 sc1 lds
    v_mfma_f32_32x32x16_bf16 v[32:47], v[108:111], v[100:103], 0
    ds_read_b128 v[108:111], v2 offset:3072
    v_exp_f32 v16, v16
    v_exp_f32 v17, v17
    v_exp_f32 v18, v18
    v_exp_f32 v19, v19
    v_cvt_pk_bf16_f32 v80, v16, v17
    v_exp_f32 v20, v20
    v_exp_f32 v21, v21
    v_cvt_pk_bf16_f32 v81, v18, v19
    v_mfma_f32_32x32x16_bf16 v[64:79], v[112:115], v[88:91], v[64:79]
    ds_read_b128 v[112:115], v3 offset:2112
    v_exp_f32 v22, v22
    v_exp_f32 v23, v23
    v_cvt_pk_bf16_f32 v82, v20, v21
    v_exp_f32 v24, v24
    v_exp_f32 v25, v25
    v_cvt_pk_bf16_f32 v83, v22, v23
    v_exp_f32 v26, v26
    v_exp_f32 v27, v27
    v_mfma_f32_32x32x16_bf16 v[64:79], v[116:119], v[92:95], v[64:79]
    ds_read_b128 v[116:119], v4 offset:2112
    v_cvt_pk_bf16_f32 v84, v24, v25
    v_exp_f32 v28, v28
    v_exp_f32 v29, v29
    v_cvt_pk_bf16_f32 v85, v26, v27
    v_exp_f32 v30, v30
    v_exp_f32 v31, v31
    v_cvt_pk_bf16_f32 v86, v28, v29
    v_cvt_pk_bf16_f32 v87, v30, v31
    v_mfma_f32_32x32x16_bf16 v[16:31], v[104:107], v[96:99], 0
    s_add_u32 s23, s60, 16384
    s_add_u32 m0, s62, 16384
    s_nop 0
    buffer_load_dwordx4 v1, s[8:11], s23 offen sc1 lds
    v_exp_f32 v32, v32
    v_exp_f32 v33, v33
    v_exp_f32 v34, v34
    v_exp_f32 v35, v35
    v_cvt_pk_bf16_f32 v88, v32, v33
    v_exp_f32 v36, v36
    v_exp_f32 v37, v37
    v_cvt_pk_bf16_f32 v89, v34, v35
    v_mfma_f32_32x32x16_bf16 v[48:63], v[120:123], v[80:83], v[48:63]
    buffer_load_dwordx4 v1, s[8:11], s23 offen offset:1024 sc1 lds
    v_exp_f32 v38, v38
    v_exp_f32 v39, v39
    v_cvt_pk_bf16_f32 v90, v36, v37
    v_exp_f32 v40, v40
    v_exp_f32 v41, v41
    v_cvt_pk_bf16_f32 v91, v38, v39
    v_exp_f32 v42, v42
    v_exp_f32 v43, v43
    v_mfma_f32_32x32x16_bf16 v[48:63], v[124:127], v[84:87], v[48:63]
    s_waitcnt lgkmcnt(0)
    v_cvt_pk_bf16_f32 v92, v40, v41
    v_exp_f32 v44, v44
    v_exp_f32 v45, v45
    v_cvt_pk_bf16_f32 v93, v42, v43
    v_exp_f32 v46, v46
    v_exp_f32 v47, v47
    v_cvt_pk_bf16_f32 v94, v44, v45
    v_cvt_pk_bf16_f32 v95, v46, v47
    s_add_u32 s23, s61, 16384
    s_add_u32 m0, s63, 16896
    s_nop 0
    buffer_load_dwordx4 v1, s[8:11], s23 offen sc1 lds
    s_add_u32 m0, s63, 16928
    s_nop 0
    buffer_load_dwordx4 v1, s[8:11], s23 offen offset:1024 sc1 lds
    v_mfma_f32_32x32x16_bf16 v[32:47], v[104:107], v[100:103], 0
    ds_read_b128 v[104:107], v2 offset:4096
    v_exp_f32 v16, v16
    v_exp_f32 v17, v17
    v_exp_f32 v18, v18
    v_exp_f32 v19, v19
    v_cvt_pk_bf16_f32 v80, v16, v17
    v_exp_f32 v20, v20
    v_exp_f32 v21, v21
    v_cvt_pk_bf16_f32 v81, v18, v19
    v_mfma_f32_32x32x16_bf16 v[64:79], v[120:123], v[88:91], v[64:79]
    ds_read_b128 v[120:123], v3 offset:3168
    v_exp_f32 v22, v22
    v_exp_f32 v23, v23
    v_cvt_pk_bf16_f32 v82, v20, v21
    v_exp_f32 v24, v24
    v_exp_f32 v25, v25
    v_cvt_pk_bf16_f32 v83, v22, v23
    v_exp_f32 v26, v26
    v_exp_f32 v27, v27
    v_mfma_f32_32x32x16_bf16 v[64:79], v[124:127], v[92:95], v[64:79]
    ds_read_b128 v[124:127], v4 offset:3168
    v_cvt_pk_bf16_f32 v84, v24, v25
    v_exp_f32 v28, v28
    v_exp_f32 v29, v29
    v_cvt_pk_bf16_f32 v85, v26, v27
    v_exp_f32 v30, v30
    v_exp_f32 v31, v31
    v_cvt_pk_bf16_f32 v86, v28, v29
    v_cvt_pk_bf16_f32 v87, v30, v31
    v_mfma_f32_32x32x16_bf16 v[16:31], v[108:111], v[96:99], 0
    s_add_u32 s23, s60, 24576
    s_add_u32 m0, s62, 24576
    s_nop 0
    buffer_load_dwordx4 v1, s[8:11], s23 offen sc1 lds
    v_exp_f32 v32, v32
    v_exp_f32 v33, v33
    v_exp_f32 v34, v34
    v_exp_f32 v35, v35
    v_cvt_pk_bf16_f32 v88, v32, v33
    v_exp_f32 v36, v36
    v_exp_f32 v37, v37
    v_cvt_pk_bf16_f32 v89, v34, v35
    v_mfma_f32_32x32x16_bf16 v[48:63], v[112:115], v[80:83], v[48:63]
    buffer_load_dwordx4 v1, s[8:11], s23 offen offset:1024 sc1 lds
    v_exp_f32 v38, v38
    v_exp_f32 v39, v39
    v_cvt_pk_bf16_f32 v90, v36, v37
    v_exp_f32 v40, v40
    v_exp_f32 v41, v41
    v_cvt_pk_bf16_f32 v91, v38, v39
    v_exp_f32 v42, v42
    v_exp_f32 v43, v43
    v_mfma_f32_32x32x16_bf16 v[48:63], v[116:119], v[84:87], v[48:63]
    s_waitcnt lgkmcnt(0)
    v_cvt_pk_bf16_f32 v92, v40, v41
    v_exp_f32 v44, v44
    v_exp_f32 v45, v45
    v_cvt_pk_bf16_f32 v93, v42, v43
    v_exp_f32 v46, v46
    v_exp_f32 v47, v47
    v_cvt_pk_bf16_f32 v94, v44, v45
    v_cvt_pk_bf16_f32 v95, v46, v47
    s_add_u32 s23, s61, 24576
    s_add_u32 m0, s63, 25344
    s_nop 0
    buffer_load_dwordx4 v1, s[8:11], s23 offen sc1 lds
    s_add_u32 m0, s63, 25376
    s_nop 0
    buffer_load_dwordx4 v1, s[8:11], s23 offen offset:1024 sc1 lds
    v_mfma_f32_32x32x16_bf16 v[32:47], v[108:111], v[100:103], 0
    ds_read_b128 v[108:111], v2 offset:5120
    v_exp_f32 v16, v16
    v_exp_f32 v17, v17
    v_exp_f32 v18, v18
    v_exp_f32 v19, v19
    v_cvt_pk_bf16_f32 v80, v16, v17
    v_exp_f32 v20, v20
    v_exp_f32 v21, v21
    v_cvt_pk_bf16_f32 v81, v18, v19
    v_mfma_f32_32x32x16_bf16 v[64:79], v[112:115], v[88:91], v[64:79]
    ds_read_b128 v[112:115], v3 offset:4224
    v_exp_f32 v22, v22
    v_exp_f32 v23, v23
    v_cvt_pk_bf16_f32 v82, v20, v21
    v_exp_f32 v24, v24
    v_exp_f32 v25, v25
    v_cvt_pk_bf16_f32 v83, v22, v23
    v_exp_f32 v26, v26
    v_exp_f32 v27, v27
    v_mfma_f32_32x32x16_bf16 v[64:79], v[116:119], v[92:95], v[64:79]
    ds_read_b128 v[116:119], v4 offset:4224
    v_cvt_pk_bf16_f32 v84, v24, v25
    v_exp_f32 v28, v28
    v_exp_f32 v29, v29
    v_cvt_pk_bf16_f32 v85, v26, v27
    v_exp_f32 v30, v30
    v_exp_f32 v31, v31
    v_cvt_pk_bf16_f32 v86, v28, v29
    v_cvt_pk_bf16_f32 v87, v30, v31
    v_mfma_f32_32x32x16_bf16 v[16:31], v[104:107], v[96:99], 0
    s_add_u32 s23, s60, 32768
    s_add_u32 m0, s62, 32768
    s_nop 0
    buffer_load_dwordx4 v1, s[8:11], s23 offen sc1 lds
    v_exp_f32 v32, v32
    v_exp_f32 v33, v33
    v_exp_f32 v34, v34
    v_exp_f32 v35, v35
    v_cvt_pk_bf16_f32 v88, v32, v33
    v_exp_f32 v36, v36
    v_exp_f32 v37, v37
    v_cvt_pk_bf16_f32 v89, v34, v35
    v_mfma_f32_32x32x16_bf16 v[48:63], v[120:123], v[80:83], v[48:63]
    buffer_load_dwordx4 v1, s[8:11], s23 offen offset:1024 sc1 lds
    v_exp_f32 v38, v38
    v_exp_f32 v39, v39
    v_cvt_pk_bf16_f32 v90, v36, v37
    v_exp_f32 v40, v40
    v_exp_f32 v41, v41
    v_cvt_pk_bf16_f32 v91, v38, v39
    v_exp_f32 v42, v42
    v_exp_f32 v43, v43
    v_mfma_f32_32x32x16_bf16 v[48:63], v[124:127], v[84:87], v[48:63]
    s_waitcnt lgkmcnt(0)
    v_cvt_pk_bf16_f32 v92, v40, v41
    v_exp_f32 v44, v44
    v_exp_f32 v45, v45
    v_cvt_pk_bf16_f32 v93, v42, v43
    v_exp_f32 v46, v46
    v_exp_f32 v47, v47
    v_cvt_pk_bf16_f32 v94, v44, v45
    v_cvt_pk_bf16_f32 v95, v46, v47
    s_add_u32 s23, s61, 32768
    s_add_u32 m0, s63, 33792
    s_nop 0
    buffer_load_dwordx4 v1, s[8:11], s23 offen sc1 lds
    s_add_u32 m0, s63, 33824
    s_nop 0
    buffer_load_dwordx4 v1, s[8:11], s23 offen offset:1024 sc1 lds
    v_mfma_f32_32x32x16_bf16 v[32:47], v[104:107], v[100:103], 0
    ds_read_b128 v[104:107], v2 offset:6144
    v_exp_f32 v16, v16
    v_exp_f32 v17, v17
    v_exp_f32 v18, v18
    v_exp_f32 v19, v19
    v_cvt_pk_bf16_f32 v80, v16, v17
    v_exp_f32 v20, v20
    v_exp_f32 v21, v21
    v_cvt_pk_bf16_f32 v81, v18, v19
    v_mfma_f32_32x32x16_bf16 v[64:79], v[120:123], v[88:91], v[64:79]
    ds_read_b128 v[120:123], v3 offset:5280
    v_exp_f32 v22, v22
    v_exp_f32 v23, v23
    v_cvt_pk_bf16_f32 v82, v20, v21
    v_exp_f32 v24, v24
    v_exp_f32 v25, v25
    v_cvt_pk_bf16_f32 v83, v22, v23
    v_exp_f32 v26, v26
    v_exp_f32 v27, v27
    v_mfma_f32_32x32x16_bf16 v[64:79], v[124:127], v[92:95], v[64:79]
    ds_read_b128 v[124:127], v4 offset:5280
    v_cvt_pk_bf16_f32 v84, v24, v25
    v_exp_f32 v28, v28
    v_exp_f32 v29, v29
    v_cvt_pk_bf16_f32 v85, v26, v27
    v_exp_f32 v30, v30
    v_exp_f32 v31, v31
    v_cvt_pk_bf16_f32 v86, v28, v29
    v_cvt_pk_bf16_f32 v87, v30, v31
    v_mfma_f32_32x32x16_bf16 v[16:31], v[108:111], v[96:99], 0
    s_add_u32 s23, s60, 40960
    s_add_u32 m0, s62, 40960
    s_nop 0
    buffer_load_dwordx4 v1, s[8:11], s23 offen sc1 lds
    v_exp_f32 v32, v32
    v_exp_f32 v33, v33
    v_exp_f32 v34, v34
    v_exp_f32 v35, v35
    v_cvt_pk_bf16_f32 v88, v32, v33
    v_exp_f32 v36, v36
    v_exp_f32 v37, v37
    v_cvt_pk_bf16_f32 v89, v34, v35
    v_mfma_f32_32x32x16_bf16 v[48:63], v[112:115], v[80:83], v[48:63]
    buffer_load_dwordx4 v1, s[8:11], s23 offen offset:1024 sc1 lds
    v_exp_f32 v38, v38
    v_exp_f32 v39, v39
    v_cvt_pk_bf16_f32 v90, v36, v37
    v_exp_f32 v40, v40
    v_exp_f32 v41, v41
    v_cvt_pk_bf16_f32 v91, v38, v39
    v_exp_f32 v42, v42
    v_exp_f32 v43, v43
    v_mfma_f32_32x32x16_bf16 v[48:63], v[116:119], v[84:87], v[48:63]
    s_waitcnt lgkmcnt(0)
    v_cvt_pk_bf16_f32 v92, v40, v41
    v_exp_f32 v44, v44
    v_exp_f32 v45, v45
    v_cvt_pk_bf16_f32 v93, v42, v43
    v_exp_f32 v46, v46
    v_exp_f32 v47, v47
    v_cvt_pk_bf16_f32 v94, v44, v45
    v_cvt_pk_bf16_f32 v95, v46, v47
    s_add_u32 s23, s61, 40960
    s_add_u32 m0, s63, 42240
    s_nop 0
    buffer_load_dwordx4 v1, s[8:11], s23 offen sc1 lds
    s_add_u32 m0, s63, 42272
    s_nop 0
    buffer_load_dwordx4 v1, s[8:11], s23 offen offset:1024 sc1 lds
    v_mfma_f32_32x32x16_bf16 v[32:47], v[108:111], v[100:103], 0
    ds_read_b128 v[108:111], v2 offset:7168
    v_exp_f32 v16, v16
    v_exp_f32 v17, v17
    v_exp_f32 v18, v18
    v_exp_f32 v19, v19
    v_cvt_pk_bf16_f32 v80, v16, v17
    v_exp_f32 v20, v20
    v_exp_f32 v21, v21
    v_cvt_pk_bf16_f32 v81, v18, v19
    v_mfma_f32_32x32x16_bf16 v[64:79], v[112:115], v[88:91], v[64:79]
    ds_read_b128 v[112:115], v3 offset:6336
    v_exp_f32 v22, v22
    v_exp_f32 v23, v23
    v_cvt_pk_bf16_f32 v82, v20, v21
    v_exp_f32 v24, v24
    v_exp_f32 v25, v25
    v_cvt_pk_bf16_f32 v83, v22, v23
    v_exp_f32 v26, v26
    v_exp_f32 v27, v27
    v_mfma_f32_32x32x16_bf16 v[64:79], v[116:119], v[92:95], v[64:79]
    ds_read_b128 v[116:119], v4 offset:6336
    v_cvt_pk_bf16_f32 v84, v24, v25
    v_exp_f32 v28, v28
    v_exp_f32 v29, v29
    v_cvt_pk_bf16_f32 v85, v26, v27
    v_exp_f32 v30, v30
    v_exp_f32 v31, v31
    v_cvt_pk_bf16_f32 v86, v28, v29
    v_cvt_pk_bf16_f32 v87, v30, v31
    v_mfma_f32_32x32x16_bf16 v[16:31], v[104:107], v[96:99], 0
    s_add_u32 s23, s60, 49152
    s_add_u32 m0, s62, 49152
    s_nop 0
    buffer_load_dwordx4 v1, s[8:11], s23 offen sc1 lds
    v_exp_f32 v32, v32
    v_exp_f32 v33, v33
    v_exp_f32 v34, v34
    v_exp_f32 v35, v35
    v_cvt_pk_bf16_f32 v88, v32, v33
    v_exp_f32 v36, v36
    v_exp_f32 v37, v37
    v_cvt_pk_bf16_f32 v89, v34, v35
    v_mfma_f32_32x32x16_bf16 v[48:63], v[120:123], v[80:83], v[48:63]
    buffer_load_dwordx4 v1, s[8:11], s23 offen offset:1024 sc1 lds
    v_exp_f32 v38, v38
    v_exp_f32 v39, v39
    v_cvt_pk_bf16_f32 v90, v36, v37
    v_exp_f32 v40, v40
    v_exp_f32 v41, v41
    v_cvt_pk_bf16_f32 v91, v38, v39
    v_exp_f32 v42, v42
    v_exp_f32 v43, v43
    v_mfma_f32_32x32x16_bf16 v[48:63], v[124:127], v[84:87], v[48:63]
    s_waitcnt lgkmcnt(0)
    v_cvt_pk_bf16_f32 v92, v40, v41
    v_exp_f32 v44, v44
    v_exp_f32 v45, v45
    v_cvt_pk_bf16_f32 v93, v42, v43
    v_exp_f32 v46, v46
    v_exp_f32 v47, v47
    v_cvt_pk_bf16_f32 v94, v44, v45
    v_cvt_pk_bf16_f32 v95, v46, v47
    s_add_u32 s23, s61, 49152
    s_add_u32 m0, s63, 50688
    s_nop 0
    buffer_load_dwordx4 v1, s[8:11], s23 offen sc1 lds
    s_add_u32 m0, s63, 50720
    s_nop 0
    buffer_load_dwordx4 v1, s[8:11], s23 offen offset:1024 sc1 lds
    s_waitcnt vmcnt(20)
    s_barrier
    s_lshl_b32 s28, s20, 3
    s_add_u32 s28, s28, s21
    s_lshl_b32 s28, s28, 3
    s_add_u32 s28, s28, 26279936
    v_lshlrev_b32 v138, 11, v0
    v_mov_b32 v140, s50
    v_mov_b32 v141, s3
    s_cmp_eq_u32 s22, 0
    s_cselect_b64 exec, 0xff, 0
    buffer_store_dwordx2 v[140:141], v138, s[8:11], s28 offen sc1
    s_mov_b64 exec, -1
    v_mfma_f32_32x32x16_bf16 v[32:47], v[104:107], v[100:103], 0
    ds_read_b128 v[104:107], v2 offset:8192
    v_exp_f32 v16, v16
    v_exp_f32 v17, v17
    v_exp_f32 v18, v18
    v_exp_f32 v19, v19
    v_cvt_pk_bf16_f32 v80, v16, v17
    v_exp_f32 v20, v20
    v_exp_f32 v21, v21
    v_cvt_pk_bf16_f32 v81, v18, v19
    v_mfma_f32_32x32x16_bf16 v[64:79], v[120:123], v[88:91], v[64:79]
    ds_read_b128 v[120:123], v3 offset:7392
    v_exp_f32 v22, v22
    v_exp_f32 v23, v23
    v_cvt_pk_bf16_f32 v82, v20, v21
    v_exp_f32 v24, v24
    v_exp_f32 v25, v25
    v_cvt_pk_bf16_f32 v83, v22, v23
    v_exp_f32 v26, v26
    v_exp_f32 v27, v27
    v_mfma_f32_32x32x16_bf16 v[64:79], v[124:127], v[92:95], v[64:79]
    ds_read_b128 v[124:127], v4 offset:7392
    v_cvt_pk_bf16_f32 v84, v24, v25
    v_exp_f32 v28, v28
    v_exp_f32 v29, v29
    v_cvt_pk_bf16_f32 v85, v26, v27
    v_exp_f32 v30, v30
    v_exp_f32 v31, v31
    v_cvt_pk_bf16_f32 v86, v28, v29
    v_cvt_pk_bf16_f32 v87, v30, v31
    v_mfma_f32_32x32x16_bf16 v[16:31], v[108:111], v[96:99], 0
    s_add_u32 s23, s60, 57344
    s_add_u32 m0, s62, 57344
    s_nop 0
    buffer_load_dwordx4 v1, s[8:11], s23 offen sc1 lds
    v_exp_f32 v32, v32
    v_exp_f32 v33, v33
    v_exp_f32 v34, v34
    v_exp_f32 v35, v35
    v_cvt_pk_bf16_f32 v88, v32, v33
    v_exp_f32 v36, v36
    v_exp_f32 v37, v37
    v_cvt_pk_bf16_f32 v89, v34, v35
    v_mfma_f32_32x32x16_bf16 v[48:63], v[112:115], v[80:83], v[48:63]
    buffer_load_dwordx4 v1, s[8:11], s23 offen offset:1024 sc1 lds
    v_exp_f32 v38, v38
    v_exp_f32 v39, v39
    v_cvt_pk_bf16_f32 v90, v36, v37
    v_exp_f32 v40, v40
    v_exp_f32 v41, v41
    v_cvt_pk_bf16_f32 v91, v38, v39
    v_exp_f32 v42, v42
    v_exp_f32 v43, v43
    v_mfma_f32_32x32x16_bf16 v[48:63], v[116:119], v[84:87], v[48:63]
    s_waitcnt lgkmcnt(0)
    v_cvt_pk_bf16_f32 v92, v40, v41
    v_exp_f32 v44, v44
    v_exp_f32 v45, v45
    v_cvt_pk_bf16_f32 v93, v42, v43
    v_exp_f32 v46, v46
    v_exp_f32 v47, v47
    v_cvt_pk_bf16_f32 v94, v44, v45
    v_cvt_pk_bf16_f32 v95, v46, v47
    s_add_u32 s23, s61, 57344
    s_add_u32 m0, s63, 59136
    s_nop 0
    buffer_load_dwordx4 v1, s[8:11], s23 offen sc1 lds
    s_add_u32 m0, s63, 59168
    s_nop 0
    buffer_load_dwordx4 v1, s[8:11], s23 offen offset:1024 sc1 lds
    v_mfma_f32_32x32x16_bf16 v[32:47], v[108:111], v[100:103], 0
    ds_read_b128 v[108:111], v2 offset:9216
    v_exp_f32 v16, v16
    v_exp_f32 v17, v17
    v_exp_f32 v18, v18
    v_exp_f32 v19, v19
    v_cvt_pk_bf16_f32 v80, v16, v17
    v_exp_f32 v20, v20
    v_exp_f32 v21, v21
    v_cvt_pk_bf16_f32 v81, v18, v19
    v_mfma_f32_32x32x16_bf16 v[64:79], v[112:115], v[88:91], v[64:79]
    ds_read_b128 v[112:115], v3 offset:8448
    v_exp_f32 v22, v22
    v_exp_f32 v23, v23
    v_cvt_pk_bf16_f32 v82, v20, v21
    v_exp_f32 v24, v24
    v_exp_f32 v25, v25
    v_cvt_pk_bf16_f32 v83, v22, v23
    v_exp_f32 v26, v26
    v_exp_f32 v27, v27
    v_mfma_f32_32x32x16_bf16 v[64:79], v[116:119], v[92:95], v[64:79]
    ds_read_b128 v[116:119], v4 offset:8448
    v_cvt_pk_bf16_f32 v84, v24, v25
    v_exp_f32 v28, v28
    v_exp_f32 v29, v29
    v_cvt_pk_bf16_f32 v85, v26, v27
    v_exp_f32 v30, v30
    v_exp_f32 v31, v31
    v_cvt_pk_bf16_f32 v86, v28, v29
    v_cvt_pk_bf16_f32 v87, v30, v31
    v_mfma_f32_32x32x16_bf16 v[16:31], v[104:107], v[96:99], 0
    v_exp_f32 v32, v32
    v_exp_f32 v33, v33
    v_exp_f32 v34, v34
    v_exp_f32 v35, v35
    v_cvt_pk_bf16_f32 v88, v32, v33
    v_exp_f32 v36, v36
    v_exp_f32 v37, v37
    v_cvt_pk_bf16_f32 v89, v34, v35
    v_mfma_f32_32x32x16_bf16 v[48:63], v[120:123], v[80:83], v[48:63]
    v_exp_f32 v38, v38
    v_exp_f32 v39, v39
    v_cvt_pk_bf16_f32 v90, v36, v37
    v_exp_f32 v40, v40
    v_exp_f32 v41, v41
    v_cvt_pk_bf16_f32 v91, v38, v39
    v_exp_f32 v42, v42
    v_exp_f32 v43, v43
    v_mfma_f32_32x32x16_bf16 v[48:63], v[124:127], v[84:87], v[48:63]
    s_waitcnt lgkmcnt(0)
    v_cvt_pk_bf16_f32 v92, v40, v41
    v_exp_f32 v44, v44
    v_exp_f32 v45, v45
    v_cvt_pk_bf16_f32 v93, v42, v43
    v_exp_f32 v46, v46
    v_exp_f32 v47, v47
    v_cvt_pk_bf16_f32 v94, v44, v45
    v_cvt_pk_bf16_f32 v95, v46, v47
    v_mfma_f32_32x32x16_bf16 v[32:47], v[104:107], v[100:103], 0
    ds_read_b128 v[104:107], v2 offset:10240
    v_exp_f32 v16, v16
    v_exp_f32 v17, v17
    v_exp_f32 v18, v18
    v_exp_f32 v19, v19
    v_cvt_pk_bf16_f32 v80, v16, v17
    v_exp_f32 v20, v20
    v_exp_f32 v21, v21
    v_cvt_pk_bf16_f32 v81, v18, v19
    v_mfma_f32_32x32x16_bf16 v[64:79], v[120:123], v[88:91], v[64:79]
    ds_read_b128 v[120:123], v3 offset:9504
    v_exp_f32 v22, v22
    v_exp_f32 v23, v23
    v_cvt_pk_bf16_f32 v82, v20, v21
    v_exp_f32 v24, v24
    v_exp_f32 v25, v25
    v_cvt_pk_bf16_f32 v83, v22, v23
    v_exp_f32 v26, v26
    v_exp_f32 v27, v27
    v_mfma_f32_32x32x16_bf16 v[64:79], v[124:127], v[92:95], v[64:79]
    ds_read_b128 v[124:127], v4 offset:9504
    v_cvt_pk_bf16_f32 v84, v24, v25
    v_exp_f32 v28, v28
    v_exp_f32 v29, v29
    v_cvt_pk_bf16_f32 v85, v26, v27
    v_exp_f32 v30, v30
    v_exp_f32 v31, v31
    v_cvt_pk_bf16_f32 v86, v28, v29
    v_cvt_pk_bf16_f32 v87, v30, v31
    v_mfma_f32_32x32x16_bf16 v[16:31], v[108:111], v[96:99], 0
    v_exp_f32 v32, v32
    v_exp_f32 v33, v33
    v_exp_f32 v34, v34
    v_exp_f32 v35, v35
    v_cvt_pk_bf16_f32 v88, v32, v33
    v_exp_f32 v36, v36
    v_exp_f32 v37, v37
    v_cvt_pk_bf16_f32 v89, v34, v35
    v_mfma_f32_32x32x16_bf16 v[48:63], v[112:115], v[80:83], v[48:63]
    v_exp_f32 v38, v38
    v_exp_f32 v39, v39
    v_cvt_pk_bf16_f32 v90, v36, v37
    v_exp_f32 v40, v40
    v_exp_f32 v41, v41
    v_cvt_pk_bf16_f32 v91, v38, v39
    v_exp_f32 v42, v42
    v_exp_f32 v43, v43
    v_mfma_f32_32x32x16_bf16 v[48:63], v[116:119], v[84:87], v[48:63]
    s_waitcnt lgkmcnt(0)
    v_cvt_pk_bf16_f32 v92, v40, v41
    v_exp_f32 v44, v44
    v_exp_f32 v45, v45
    v_cvt_pk_bf16_f32 v93, v42, v43
    v_exp_f32 v46, v46
    v_exp_f32 v47, v47
    v_cvt_pk_bf16_f32 v94, v44, v45
    v_cvt_pk_bf16_f32 v95, v46, v47
    v_mfma_f32_32x32x16_bf16 v[32:47], v[108:111], v[100:103], 0
    ds_read_b128 v[108:111], v2 offset:11264
    v_exp_f32 v16, v16
    v_exp_f32 v17, v17
    v_exp_f32 v18, v18
    v_exp_f32 v19, v19
    v_cvt_pk_bf16_f32 v80, v16, v17
    v_exp_f32 v20, v20
    v_exp_f32 v21, v21
    v_cvt_pk_bf16_f32 v81, v18, v19
    v_mfma_f32_32x32x16_bf16 v[64:79], v[112:115], v[88:91], v[64:79]
    ds_read_b128 v[112:115], v3 offset:10560
    v_exp_f32 v22, v22
    v_exp_f32 v23, v23
    v_cvt_pk_bf16_f32 v82, v20, v21
    v_exp_f32 v24, v24
    v_exp_f32 v25, v25
    v_cvt_pk_bf16_f32 v83, v22, v23
    v_exp_f32 v26, v26
    v_exp_f32 v27, v27
    v_mfma_f32_32x32x16_bf16 v[64:79], v[116:119], v[92:95], v[64:79]
    ds_read_b128 v[116:119], v4 offset:10560
    v_cvt_pk_bf16_f32 v84, v24, v25
    v_exp_f32 v28, v28
    v_exp_f32 v29, v29
    v_cvt_pk_bf16_f32 v85, v26, v27
    v_exp_f32 v30, v30
    v_exp_f32 v31, v31
    v_cvt_pk_bf16_f32 v86, v28, v29
    v_cvt_pk_bf16_f32 v87, v30, v31
    v_mfma_f32_32x32x16_bf16 v[16:31], v[104:107], v[96:99], 0
    v_exp_f32 v32, v32
    v_exp_f32 v33, v33
    v_exp_f32 v34, v34
    v_exp_f32 v35, v35
    v_cvt_pk_bf16_f32 v88, v32, v33
    v_exp_f32 v36, v36
    v_exp_f32 v37, v37
    v_cvt_pk_bf16_f32 v89, v34, v35
    v_mfma_f32_32x32x16_bf16 v[48:63], v[120:123], v[80:83], v[48:63]
    v_exp_f32 v38, v38
    v_exp_f32 v39, v39
    v_cvt_pk_bf16_f32 v90, v36, v37
    v_exp_f32 v40, v40
    v_exp_f32 v41, v41
    v_cvt_pk_bf16_f32 v91, v38, v39
    v_exp_f32 v42, v42
    v_exp_f32 v43, v43
    v_mfma_f32_32x32x16_bf16 v[48:63], v[124:127], v[84:87], v[48:63]
    s_waitcnt lgkmcnt(0)
    v_cvt_pk_bf16_f32 v92, v40, v41
    v_exp_f32 v44, v44
    v_exp_f32 v45, v45
    v_cvt_pk_bf16_f32 v93, v42, v43
    v_exp_f32 v46, v46
    v_exp_f32 v47, v47
    v_cvt_pk_bf16_f32 v94, v44, v45
    v_cvt_pk_bf16_f32 v95, v46, v47
    v_mfma_f32_32x32x16_bf16 v[32:47], v[104:107], v[100:103], 0
    ds_read_b128 v[104:107], v2 offset:12288
    v_exp_f32 v16, v16
    v_exp_f32 v17, v17
    v_exp_f32 v18, v18
    v_exp_f32 v19, v19
    v_cvt_pk_bf16_f32 v80, v16, v17
    v_exp_f32 v20, v20
    v_exp_f32 v21, v21
    v_cvt_pk_bf16_f32 v81, v18, v19
    v_mfma_f32_32x32x16_bf16 v[64:79], v[120:123], v[88:91], v[64:79]
    ds_read_b128 v[120:123], v3 offset:11616
    v_exp_f32 v22, v22
    v_exp_f32 v23, v23
    v_cvt_pk_bf16_f32 v82, v20, v21
    v_exp_f32 v24, v24
    v_exp_f32 v25, v25
    v_cvt_pk_bf16_f32 v83, v22, v23
    v_exp_f32 v26, v26
    v_exp_f32 v27, v27
    v_mfma_f32_32x32x16_bf16 v[64:79], v[124:127], v[92:95], v[64:79]
    ds_read_b128 v[124:127], v4 offset:11616
    v_cvt_pk_bf16_f32 v84, v24, v25
    v_exp_f32 v28, v28
    v_exp_f32 v29, v29
    v_cvt_pk_bf16_f32 v85, v26, v27
    v_exp_f32 v30, v30
    v_exp_f32 v31, v31
    v_cvt_pk_bf16_f32 v86, v28, v29
    v_cvt_pk_bf16_f32 v87, v30, v31
    v_mfma_f32_32x32x16_bf16 v[16:31], v[108:111], v[96:99], 0
    v_exp_f32 v32, v32
    v_exp_f32 v33, v33
    v_exp_f32 v34, v34
    v_exp_f32 v35, v35
    v_cvt_pk_bf16_f32 v88, v32, v33
    v_exp_f32 v36, v36
    v_exp_f32 v37, v37
    v_cvt_pk_bf16_f32 v89, v34, v35
    v_mfma_f32_32x32x16_bf16 v[48:63], v[112:115], v[80:83], v[48:63]
    v_exp_f32 v38, v38
    v_exp_f32 v39, v39
    v_cvt_pk_bf16_f32 v90, v36, v37
    v_exp_f32 v40, v40
    v_exp_f32 v41, v41
    v_cvt_pk_bf16_f32 v91, v38, v39
    v_exp_f32 v42, v42
    v_exp_f32 v43, v43
    v_mfma_f32_32x32x16_bf16 v[48:63], v[116:119], v[84:87], v[48:63]
    s_waitcnt lgkmcnt(0)
    v_cvt_pk_bf16_f32 v92, v40, v41
    v_exp_f32 v44, v44
    v_exp_f32 v45, v45
    v_cvt_pk_bf16_f32 v93, v42, v43
    v_exp_f32 v46, v46
    v_exp_f32 v47, v47
    v_cvt_pk_bf16_f32 v94, v44, v45
    v_cvt_pk_bf16_f32 v95, v46, v47
    v_mfma_f32_32x32x16_bf16 v[32:47], v[108:111], v[100:103], 0
    ds_read_b128 v[108:111], v2 offset:13312
    v_exp_f32 v16, v16
    v_exp_f32 v17, v17
    v_exp_f32 v18, v18
    v_exp_f32 v19, v19
    v_cvt_pk_bf16_f32 v80, v16, v17
    v_exp_f32 v20, v20
    v_exp_f32 v21, v21
    v_cvt_pk_bf16_f32 v81, v18, v19
    v_mfma_f32_32x32x16_bf16 v[64:79], v[112:115], v[88:91], v[64:79]
    ds_read_b128 v[112:115], v3 offset:12672
    v_exp_f32 v22, v22
    v_exp_f32 v23, v23
    v_cvt_pk_bf16_f32 v82, v20, v21
    v_exp_f32 v24, v24
    v_exp_f32 v25, v25
    v_cvt_pk_bf16_f32 v83, v22, v23
    v_exp_f32 v26, v26
    v_exp_f32 v27, v27
    v_mfma_f32_32x32x16_bf16 v[64:79], v[116:119], v[92:95], v[64:79]
    ds_read_b128 v[116:119], v4 offset:12672
    v_cvt_pk_bf16_f32 v84, v24, v25
    v_exp_f32 v28, v28
    v_exp_f32 v29, v29
    v_cvt_pk_bf16_f32 v85, v26, v27
    v_exp_f32 v30, v30
    v_exp_f32 v31, v31
    v_cvt_pk_bf16_f32 v86, v28, v29
    v_cvt_pk_bf16_f32 v87, v30, v31
    v_mfma_f32_32x32x16_bf16 v[16:31], v[104:107], v[96:99], 0
    v_lshlrev_b32 v136, 5, v0
    s_lshr_b32 s47, s20, 2
    s_lshl_b32 s47, s47, 11
    s_add_u32 s47, s47, 26279936
    s_cmp_eq_u32 s22, 0
    s_cselect_b64 exec, -1, 0
    buffer_load_dwordx4 v[128:131], v136, s[8:11], s47 offen sc1
    buffer_load_dwordx4 v[132:135], v136, s[8:11], s47 offen offset:16 sc1
    s_mov_b64 exec, -1
    v_exp_f32 v32, v32
    v_exp_f32 v33, v33
    v_exp_f32 v34, v34
    v_exp_f32 v35, v35
    v_cvt_pk_bf16_f32 v88, v32, v33
    v_exp_f32 v36, v36
    v_exp_f32 v37, v37
    v_cvt_pk_bf16_f32 v89, v34, v35
    v_mfma_f32_32x32x16_bf16 v[48:63], v[120:123], v[80:83], v[48:63]
    v_exp_f32 v38, v38
    v_exp_f32 v39, v39
    v_cvt_pk_bf16_f32 v90, v36, v37
    v_exp_f32 v40, v40
    v_exp_f32 v41, v41
    v_cvt_pk_bf16_f32 v91, v38, v39
    v_exp_f32 v42, v42
    v_exp_f32 v43, v43
    v_mfma_f32_32x32x16_bf16 v[48:63], v[124:127], v[84:87], v[48:63]
    s_waitcnt lgkmcnt(0)
    v_cvt_pk_bf16_f32 v92, v40, v41
    v_exp_f32 v44, v44
    v_exp_f32 v45, v45
    v_cvt_pk_bf16_f32 v93, v42, v43
    v_exp_f32 v46, v46
    v_exp_f32 v47, v47
    v_cvt_pk_bf16_f32 v94, v44, v45
    v_cvt_pk_bf16_f32 v95, v46, v47
    v_mfma_f32_32x32x16_bf16 v[32:47], v[104:107], v[100:103], 0
    ds_read_b128 v[104:107], v2 offset:14336
    v_exp_f32 v16, v16
    v_exp_f32 v17, v17
    v_exp_f32 v18, v18
    v_exp_f32 v19, v19
    v_cvt_pk_bf16_f32 v80, v16, v17
    v_exp_f32 v20, v20
    v_exp_f32 v21, v21
    v_cvt_pk_bf16_f32 v81, v18, v19
    v_mfma_f32_32x32x16_bf16 v[64:79], v[120:123], v[88:91], v[64:79]
    ds_read_b128 v[120:123], v3 offset:13728
    v_exp_f32 v22, v22
    v_exp_f32 v23, v23
    v_cvt_pk_bf16_f32 v82, v20, v21
    v_exp_f32 v24, v24
    v_exp_f32 v25, v25
    v_cvt_pk_bf16_f32 v83, v22, v23
    v_exp_f32 v26, v26
    v_exp_f32 v27, v27
    v_mfma_f32_32x32x16_bf16 v[64:79], v[124:127], v[92:95], v[64:79]
    ds_read_b128 v[124:127], v4 offset:13728
    v_cvt_pk_bf16_f32 v84, v24, v25
    v_exp_f32 v28, v28
    v_exp_f32 v29, v29
    v_cvt_pk_bf16_f32 v85, v26, v27
    v_exp_f32 v30, v30
    v_exp_f32 v31, v31
    v_cvt_pk_bf16_f32 v86, v28, v29
    v_cvt_pk_bf16_f32 v87, v30, v31
    v_mfma_f32_32x32x16_bf16 v[16:31], v[108:111], v[96:99], 0
    v_exp_f32 v32, v32
    v_exp_f32 v33, v33
    v_exp_f32 v34, v34
    v_exp_f32 v35, v35
    v_cvt_pk_bf16_f32 v88, v32, v33
    v_exp_f32 v36, v36
    v_exp_f32 v37, v37
    v_cvt_pk_bf16_f32 v89, v34, v35
    v_mfma_f32_32x32x16_bf16 v[48:63], v[112:115], v[80:83], v[48:63]
    v_exp_f32 v38, v38
    v_exp_f32 v39, v39
    v_cvt_pk_bf16_f32 v90, v36, v37
    v_exp_f32 v40, v40
    v_exp_f32 v41, v41
    v_cvt_pk_bf16_f32 v91, v38, v39
    v_exp_f32 v42, v42
    v_exp_f32 v43, v43
    v_mfma_f32_32x32x16_bf16 v[48:63], v[116:119], v[84:87], v[48:63]
    s_waitcnt lgkmcnt(0)
    v_cvt_pk_bf16_f32 v92, v40, v41
    v_exp_f32 v44, v44
    v_exp_f32 v45, v45
    v_cvt_pk_bf16_f32 v93, v42, v43
    v_exp_f32 v46, v46
    v_exp_f32 v47, v47
    v_cvt_pk_bf16_f32 v94, v44, v45
    v_cvt_pk_bf16_f32 v95, v46, v47
    v_mfma_f32_32x32x16_bf16 v[32:47], v[108:111], v[100:103], 0
    ds_read_b128 v[108:111], v2 offset:15360
    v_exp_f32 v16, v16
    v_exp_f32 v17, v17
    v_exp_f32 v18, v18
    v_exp_f32 v19, v19
    v_cvt_pk_bf16_f32 v80, v16, v17
    v_exp_f32 v20, v20
    v_exp_f32 v21, v21
    v_cvt_pk_bf16_f32 v81, v18, v19
    v_mfma_f32_32x32x16_bf16 v[64:79], v[112:115], v[88:91], v[64:79]
    ds_read_b128 v[112:115], v3 offset:14784
    v_exp_f32 v22, v22
    v_exp_f32 v23, v23
    v_cvt_pk_bf16_f32 v82, v20, v21
    v_exp_f32 v24, v24
    v_exp_f32 v25, v25
    v_cvt_pk_bf16_f32 v83, v22, v23
    v_exp_f32 v26, v26
    v_exp_f32 v27, v27
    v_mfma_f32_32x32x16_bf16 v[64:79], v[116:119], v[92:95], v[64:79]
    ds_read_b128 v[116:119], v4 offset:14784
    v_cvt_pk_bf16_f32 v84, v24, v25
    v_exp_f32 v28, v28
    v_exp_f32 v29, v29
    v_cvt_pk_bf16_f32 v85, v26, v27
    v_exp_f32 v30, v30
    v_exp_f32 v31, v31
    v_cvt_pk_bf16_f32 v86, v28, v29
    v_cvt_pk_bf16_f32 v87, v30, v31
    v_mfma_f32_32x32x16_bf16 v[16:31], v[104:107], v[96:99], 0
    v_exp_f32 v32, v32
    v_exp_f32 v33, v33
    v_exp_f32 v34, v34
    v_exp_f32 v35, v35
    v_cvt_pk_bf16_f32 v88, v32, v33
    v_exp_f32 v36, v36
    v_exp_f32 v37, v37
    v_cvt_pk_bf16_f32 v89, v34, v35
    v_mfma_f32_32x32x16_bf16 v[48:63], v[120:123], v[80:83], v[48:63]
    v_exp_f32 v38, v38
    v_exp_f32 v39, v39
    v_cvt_pk_bf16_f32 v90, v36, v37
    v_exp_f32 v40, v40
    v_exp_f32 v41, v41
    v_cvt_pk_bf16_f32 v91, v38, v39
    v_exp_f32 v42, v42
    v_exp_f32 v43, v43
    v_mfma_f32_32x32x16_bf16 v[48:63], v[124:127], v[84:87], v[48:63]
    s_waitcnt lgkmcnt(0)
    v_cvt_pk_bf16_f32 v92, v40, v41
    v_exp_f32 v44, v44
    v_exp_f32 v45, v45
    v_cvt_pk_bf16_f32 v93, v42, v43
    v_exp_f32 v46, v46
    v_exp_f32 v47, v47
    v_cvt_pk_bf16_f32 v94, v44, v45
    v_cvt_pk_bf16_f32 v95, v46, v47
    s_waitcnt vmcnt(2)
    s_waitcnt vmcnt(0)
    s_cmp_eq_u32 s22, 0
    s_cselect_b64 exec, -1, 0
    v_cmp_ne_u32 vcc, s50, v128
    v_cmp_ne_u32 s[28:29], s3, v129
    s_nop 0
    s_or_b64 vcc, vcc, s[28:29]
    v_cmp_ne_u32 s[28:29], s50, v130
    s_nop 0
    s_or_b64 vcc, vcc, s[28:29]
    v_cmp_ne_u32 s[28:29], s3, v131
    s_nop 0
    s_or_b64 vcc, vcc, s[28:29]
    v_cmp_ne_u32 s[28:29], s50, v132
    s_nop 0
    s_or_b64 vcc, vcc, s[28:29]
    v_cmp_ne_u32 s[28:29], s3, v133
    s_nop 0
    s_or_b64 vcc, vcc, s[28:29]
    v_cmp_ne_u32 s[28:29], s50, v134
    s_nop 0
    s_or_b64 vcc, vcc, s[28:29]
    v_cmp_ne_u32 s[28:29], s3, v135
    s_nop 0
    s_or_b64 vcc, vcc, s[28:29]
    s_cbranch_vccz L_prepok_interleave_layers__grouped_kv_mqa__sliding_local_dilated__prompt_kernel
    s_mov_b32 s45, 0x10000
L_prepp_interleave_layers__grouped_kv_mqa__sliding_local_dilated__prompt_kernel:
    s_sleep 2
    buffer_load_dwordx4 v[128:131], v136, s[8:11], s47 offen sc1
    buffer_load_dwordx4 v[132:135], v136, s[8:11], s47 offen offset:16 sc1
    s_waitcnt vmcnt(0)
    v_cmp_ne_u32 vcc, s50, v128
    v_cmp_ne_u32 s[28:29], s3, v129
    s_nop 0
    s_or_b64 vcc, vcc, s[28:29]
    v_cmp_ne_u32 s[28:29], s50, v130
    s_nop 0
    s_or_b64 vcc, vcc, s[28:29]
    v_cmp_ne_u32 s[28:29], s3, v131
    s_nop 0
    s_or_b64 vcc, vcc, s[28:29]
    v_cmp_ne_u32 s[28:29], s50, v132
    s_nop 0
    s_or_b64 vcc, vcc, s[28:29]
    v_cmp_ne_u32 s[28:29], s3, v133
    s_nop 0
    s_or_b64 vcc, vcc, s[28:29]
    v_cmp_ne_u32 s[28:29], s50, v134
    s_nop 0
    s_or_b64 vcc, vcc, s[28:29]
    v_cmp_ne_u32 s[28:29], s3, v135
    s_nop 0
    s_or_b64 vcc, vcc, s[28:29]
    s_sub_u32 s45, s45, 1
    s_cmp_eq_u32 s45, 0
    s_cbranch_scc1 L_prepp_interleave_layers__grouped_kv_mqa__sliding_local_dilated__prompt_kernel_d
    s_cbranch_vccnz L_prepp_interleave_layers__grouped_kv_mqa__sliding_local_dilated__prompt_kernel
L_prepp_interleave_layers__grouped_kv_mqa__sliding_local_dilated__prompt_kernel_d:
L_prepok_interleave_layers__grouped_kv_mqa__sliding_local_dilated__prompt_kernel:
    s_mov_b64 exec, -1
    s_barrier
    v_mfma_f32_32x32x16_bf16 v[32:47], v[104:107], v[100:103], 0
    ds_read_b128 v[104:107], v2 offset:16384
    v_exp_f32 v16, v16
    v_exp_f32 v17, v17
    v_exp_f32 v18, v18
    v_exp_f32 v19, v19
    v_cvt_pk_bf16_f32 v80, v16, v17
    v_exp_f32 v20, v20
    v_exp_f32 v21, v21
    v_cvt_pk_bf16_f32 v81, v18, v19
    v_mfma_f32_32x32x16_bf16 v[64:79], v[120:123], v[88:91], v[64:79]
    ds_read_b128 v[120:123], v3 offset:15840
    v_exp_f32 v22, v22
    v_exp_f32 v23, v23
    v_cvt_pk_bf16_f32 v82, v20, v21
    v_exp_f32 v24, v24
    v_exp_f32 v25, v25
    v_cvt_pk_bf16_f32 v83, v22, v23
    v_exp_f32 v26, v26
    v_exp_f32 v27, v27
    v_mfma_f32_32x32x16_bf16 v[64:79], v[124:127], v[92:95], v[64:79]
    ds_read_b128 v[124:127], v4 offset:15840
    v_cvt_pk_bf16_f32 v84, v24, v25
    v_exp_f32 v28, v28
    v_exp_f32 v29, v29
    v_cvt_pk_bf16_f32 v85, v26, v27
    v_exp_f32 v30, v30
    v_exp_f32 v31, v31
    v_cvt_pk_bf16_f32 v86, v28, v29
    v_cvt_pk_bf16_f32 v87, v30, v31
    v_mfma_f32_32x32x16_bf16 v[16:31], v[108:111], v[96:99], 0
    s_add_u32 s58, s57, s16
    s_add_u32 s58, s58, 524288
    buffer_load_dwordx4 a[192:195], v1, s[8:11], s58 offen offset:0 sc1
    v_exp_f32 v32, v32
    v_exp_f32 v33, v33
    v_exp_f32 v34, v34
    v_exp_f32 v35, v35
    v_cvt_pk_bf16_f32 v88, v32, v33
    v_exp_f32 v36, v36
    v_exp_f32 v37, v37
    v_cvt_pk_bf16_f32 v89, v34, v35
    v_mfma_f32_32x32x16_bf16 v[48:63], v[112:115], v[80:83], v[48:63]
    buffer_load_dwordx4 a[196:199], v1, s[8:11], s58 offen offset:1024 sc1
    v_exp_f32 v38, v38
    v_exp_f32 v39, v39
    v_cvt_pk_bf16_f32 v90, v36, v37
    v_exp_f32 v40, v40
    v_exp_f32 v41, v41
    v_cvt_pk_bf16_f32 v91, v38, v39
    v_exp_f32 v42, v42
    v_exp_f32 v43, v43
    v_mfma_f32_32x32x16_bf16 v[48:63], v[116:119], v[84:87], v[48:63]
    s_waitcnt lgkmcnt(0)
    v_cvt_pk_bf16_f32 v92, v40, v41
    v_exp_f32 v44, v44
    v_exp_f32 v45, v45
    v_cvt_pk_bf16_f32 v93, v42, v43
    v_exp_f32 v46, v46
    v_exp_f32 v47, v47
    v_cvt_pk_bf16_f32 v94, v44, v45
    v_cvt_pk_bf16_f32 v95, v46, v47
    v_mfma_f32_32x32x16_bf16 v[32:47], v[108:111], v[100:103], 0
    ds_read_b128 v[108:111], v2 offset:17408
    v_exp_f32 v16, v16
    v_exp_f32 v17, v17
    v_exp_f32 v18, v18
    v_exp_f32 v19, v19
    v_cvt_pk_bf16_f32 v80, v16, v17
    v_exp_f32 v20, v20
    v_exp_f32 v21, v21
    v_cvt_pk_bf16_f32 v81, v18, v19
    v_mfma_f32_32x32x16_bf16 v[64:79], v[112:115], v[88:91], v[64:79]
    ds_read_b128 v[112:115], v3 offset:16896
    v_exp_f32 v22, v22
    v_exp_f32 v23, v23
    v_cvt_pk_bf16_f32 v82, v20, v21
    v_exp_f32 v24, v24
    v_exp_f32 v25, v25
    v_cvt_pk_bf16_f32 v83, v22, v23
    v_exp_f32 v26, v26
    v_exp_f32 v27, v27
    v_mfma_f32_32x32x16_bf16 v[64:79], v[116:119], v[92:95], v[64:79]
    ds_read_b128 v[116:119], v4 offset:16896
    v_cvt_pk_bf16_f32 v84, v24, v25
    v_exp_f32 v28, v28
    v_exp_f32 v29, v29
    v_cvt_pk_bf16_f32 v85, v26, v27
    v_exp_f32 v30, v30
    v_exp_f32 v31, v31
    v_cvt_pk_bf16_f32 v86, v28, v29
    v_cvt_pk_bf16_f32 v87, v30, v31
    v_mfma_f32_32x32x16_bf16 v[16:31], v[104:107], v[96:99], 0
    buffer_load_dwordx4 a[200:203], v1, s[8:11], s58 offen offset:2048 sc1
    v_exp_f32 v32, v32
    v_exp_f32 v33, v33
    v_exp_f32 v34, v34
    v_exp_f32 v35, v35
    v_cvt_pk_bf16_f32 v88, v32, v33
    v_exp_f32 v36, v36
    v_exp_f32 v37, v37
    v_cvt_pk_bf16_f32 v89, v34, v35
    v_mfma_f32_32x32x16_bf16 v[48:63], v[120:123], v[80:83], v[48:63]
    buffer_load_dwordx4 a[204:207], v1, s[8:11], s58 offen offset:3072 sc1
    v_exp_f32 v38, v38
    v_exp_f32 v39, v39
    v_cvt_pk_bf16_f32 v90, v36, v37
    v_exp_f32 v40, v40
    v_exp_f32 v41, v41
    v_cvt_pk_bf16_f32 v91, v38, v39
    v_exp_f32 v42, v42
    v_exp_f32 v43, v43
    v_mfma_f32_32x32x16_bf16 v[48:63], v[124:127], v[84:87], v[48:63]
    s_waitcnt lgkmcnt(0)
    v_cvt_pk_bf16_f32 v92, v40, v41
    v_exp_f32 v44, v44
    v_exp_f32 v45, v45
    v_cvt_pk_bf16_f32 v93, v42, v43
    v_exp_f32 v46, v46
    v_exp_f32 v47, v47
    v_cvt_pk_bf16_f32 v94, v44, v45
    v_cvt_pk_bf16_f32 v95, v46, v47
    v_mfma_f32_32x32x16_bf16 v[32:47], v[104:107], v[100:103], 0
    ds_read_b128 v[104:107], v2 offset:18432
    v_exp_f32 v16, v16
    v_exp_f32 v17, v17
    v_exp_f32 v18, v18
    v_exp_f32 v19, v19
    v_cvt_pk_bf16_f32 v80, v16, v17
    v_exp_f32 v20, v20
    v_exp_f32 v21, v21
    v_cvt_pk_bf16_f32 v81, v18, v19
    v_mfma_f32_32x32x16_bf16 v[64:79], v[120:123], v[88:91], v[64:79]
    ds_read_b128 v[120:123], v3 offset:17952
    v_exp_f32 v22, v22
    v_exp_f32 v23, v23
    v_cvt_pk_bf16_f32 v82, v20, v21
    v_exp_f32 v24, v24
    v_exp_f32 v25, v25
    v_cvt_pk_bf16_f32 v83, v22, v23
    v_exp_f32 v26, v26
    v_exp_f32 v27, v27
    v_mfma_f32_32x32x16_bf16 v[64:79], v[124:127], v[92:95], v[64:79]
    ds_read_b128 v[124:127], v4 offset:17952
    v_cvt_pk_bf16_f32 v84, v24, v25
    v_exp_f32 v28, v28
    v_exp_f32 v29, v29
    v_cvt_pk_bf16_f32 v85, v26, v27
    v_exp_f32 v30, v30
    v_exp_f32 v31, v31
    v_cvt_pk_bf16_f32 v86, v28, v29
    v_cvt_pk_bf16_f32 v87, v30, v31
    v_mfma_f32_32x32x16_bf16 v[16:31], v[108:111], v[96:99], 0
    s_add_u32 s58, s57, s17
    s_add_u32 s58, s58, 524288
    buffer_load_dwordx4 a[208:211], v1, s[8:11], s58 offen offset:0 sc1
    v_exp_f32 v32, v32
    v_exp_f32 v33, v33
    v_exp_f32 v34, v34
    v_exp_f32 v35, v35
    v_cvt_pk_bf16_f32 v88, v32, v33
    v_exp_f32 v36, v36
    v_exp_f32 v37, v37
    v_cvt_pk_bf16_f32 v89, v34, v35
    v_mfma_f32_32x32x16_bf16 v[48:63], v[112:115], v[80:83], v[48:63]
    buffer_load_dwordx4 a[212:215], v1, s[8:11], s58 offen offset:1024 sc1
    v_exp_f32 v38, v38
    v_exp_f32 v39, v39
    v_cvt_pk_bf16_f32 v90, v36, v37
    v_exp_f32 v40, v40
    v_exp_f32 v41, v41
    v_cvt_pk_bf16_f32 v91, v38, v39
    v_exp_f32 v42, v42
    v_exp_f32 v43, v43
    v_mfma_f32_32x32x16_bf16 v[48:63], v[116:119], v[84:87], v[48:63]
    s_waitcnt lgkmcnt(0)
    v_cvt_pk_bf16_f32 v92, v40, v41
    v_exp_f32 v44, v44
    v_exp_f32 v45, v45
    v_cvt_pk_bf16_f32 v93, v42, v43
    v_exp_f32 v46, v46
    v_exp_f32 v47, v47
    v_cvt_pk_bf16_f32 v94, v44, v45
    v_cvt_pk_bf16_f32 v95, v46, v47
    v_mfma_f32_32x32x16_bf16 v[32:47], v[108:111], v[100:103], 0
    ds_read_b128 v[108:111], v2 offset:19456
    v_exp_f32 v16, v16
    v_exp_f32 v17, v17
    v_exp_f32 v18, v18
    v_exp_f32 v19, v19
    v_cvt_pk_bf16_f32 v80, v16, v17
    v_exp_f32 v20, v20
    v_exp_f32 v21, v21
    v_cvt_pk_bf16_f32 v81, v18, v19
    v_mfma_f32_32x32x16_bf16 v[64:79], v[112:115], v[88:91], v[64:79]
    ds_read_b128 v[112:115], v3 offset:19008
    v_exp_f32 v22, v22
    v_exp_f32 v23, v23
    v_cvt_pk_bf16_f32 v82, v20, v21
    v_exp_f32 v24, v24
    v_exp_f32 v25, v25
    v_cvt_pk_bf16_f32 v83, v22, v23
    v_exp_f32 v26, v26
    v_exp_f32 v27, v27
    v_mfma_f32_32x32x16_bf16 v[64:79], v[116:119], v[92:95], v[64:79]
    ds_read_b128 v[116:119], v4 offset:19008
    v_cvt_pk_bf16_f32 v84, v24, v25
    v_exp_f32 v28, v28
    v_exp_f32 v29, v29
    v_cvt_pk_bf16_f32 v85, v26, v27
    v_exp_f32 v30, v30
    v_exp_f32 v31, v31
    v_cvt_pk_bf16_f32 v86, v28, v29
    v_cvt_pk_bf16_f32 v87, v30, v31
    v_mfma_f32_32x32x16_bf16 v[16:31], v[104:107], v[96:99], 0
    buffer_load_dwordx4 a[216:219], v1, s[8:11], s58 offen offset:2048 sc1
    v_exp_f32 v32, v32
    v_exp_f32 v33, v33
    v_exp_f32 v34, v34
    v_exp_f32 v35, v35
    v_cvt_pk_bf16_f32 v88, v32, v33
    v_exp_f32 v36, v36
    v_exp_f32 v37, v37
    v_cvt_pk_bf16_f32 v89, v34, v35
    v_mfma_f32_32x32x16_bf16 v[48:63], v[120:123], v[80:83], v[48:63]
    buffer_load_dwordx4 a[220:223], v1, s[8:11], s58 offen offset:3072 sc1
    v_exp_f32 v38, v38
    v_exp_f32 v39, v39
    v_cvt_pk_bf16_f32 v90, v36, v37
    v_exp_f32 v40, v40
    v_exp_f32 v41, v41
    v_cvt_pk_bf16_f32 v91, v38, v39
    v_exp_f32 v42, v42
    v_exp_f32 v43, v43
    v_mfma_f32_32x32x16_bf16 v[48:63], v[124:127], v[84:87], v[48:63]
    s_waitcnt lgkmcnt(0)
    v_cvt_pk_bf16_f32 v92, v40, v41
    v_exp_f32 v44, v44
    v_exp_f32 v45, v45
    v_cvt_pk_bf16_f32 v93, v42, v43
    v_exp_f32 v46, v46
    v_exp_f32 v47, v47
    v_cvt_pk_bf16_f32 v94, v44, v45
    v_cvt_pk_bf16_f32 v95, v46, v47
    v_mfma_f32_32x32x16_bf16 v[32:47], v[104:107], v[100:103], 0
    ds_read_b128 v[104:107], v2 offset:20480
    v_exp_f32 v16, v16
    v_exp_f32 v17, v17
    v_exp_f32 v18, v18
    v_exp_f32 v19, v19
    v_cvt_pk_bf16_f32 v80, v16, v17
    v_exp_f32 v20, v20
    v_exp_f32 v21, v21
    v_cvt_pk_bf16_f32 v81, v18, v19
    v_mfma_f32_32x32x16_bf16 v[64:79], v[120:123], v[88:91], v[64:79]
    ds_read_b128 v[120:123], v3 offset:20064
    v_exp_f32 v22, v22
    v_exp_f32 v23, v23
    v_cvt_pk_bf16_f32 v82, v20, v21
    v_exp_f32 v24, v24
    v_exp_f32 v25, v25
    v_cvt_pk_bf16_f32 v83, v22, v23
    v_exp_f32 v26, v26
    v_exp_f32 v27, v27
    v_mfma_f32_32x32x16_bf16 v[64:79], v[124:127], v[92:95], v[64:79]
    ds_read_b128 v[124:127], v4 offset:20064
    v_cvt_pk_bf16_f32 v84, v24, v25
    v_exp_f32 v28, v28
    v_exp_f32 v29, v29
    v_cvt_pk_bf16_f32 v85, v26, v27
    v_exp_f32 v30, v30
    v_exp_f32 v31, v31
    v_cvt_pk_bf16_f32 v86, v28, v29
    v_cvt_pk_bf16_f32 v87, v30, v31
    v_mfma_f32_32x32x16_bf16 v[16:31], v[108:111], v[96:99], 0
    s_add_u32 s58, s57, s18
    s_add_u32 s58, s58, 524288
    buffer_load_dwordx4 a[224:227], v1, s[8:11], s58 offen offset:0 sc1
    v_exp_f32 v32, v32
    v_exp_f32 v33, v33
    v_exp_f32 v34, v34
    v_exp_f32 v35, v35
    v_cvt_pk_bf16_f32 v88, v32, v33
    v_exp_f32 v36, v36
    v_exp_f32 v37, v37
    v_cvt_pk_bf16_f32 v89, v34, v35
    v_mfma_f32_32x32x16_bf16 v[48:63], v[112:115], v[80:83], v[48:63]
    buffer_load_dwordx4 a[228:231], v1, s[8:11], s58 offen offset:1024 sc1
    v_exp_f32 v38, v38
    v_exp_f32 v39, v39
    v_cvt_pk_bf16_f32 v90, v36, v37
    v_exp_f32 v40, v40
    v_exp_f32 v41, v41
    v_cvt_pk_bf16_f32 v91, v38, v39
    v_exp_f32 v42, v42
    v_exp_f32 v43, v43
    v_mfma_f32_32x32x16_bf16 v[48:63], v[116:119], v[84:87], v[48:63]
    s_waitcnt lgkmcnt(0)
    v_cvt_pk_bf16_f32 v92, v40, v41
    v_exp_f32 v44, v44
    v_exp_f32 v45, v45
    v_cvt_pk_bf16_f32 v93, v42, v43
    v_exp_f32 v46, v46
    v_exp_f32 v47, v47
    v_cvt_pk_bf16_f32 v94, v44, v45
    v_cvt_pk_bf16_f32 v95, v46, v47
    v_mfma_f32_32x32x16_bf16 v[32:47], v[108:111], v[100:103], 0
    ds_read_b128 v[108:111], v2 offset:21504
    v_exp_f32 v16, v16
    v_exp_f32 v17, v17
    v_exp_f32 v18, v18
    v_exp_f32 v19, v19
    v_cvt_pk_bf16_f32 v80, v16, v17
    v_exp_f32 v20, v20
    v_exp_f32 v21, v21
    v_cvt_pk_bf16_f32 v81, v18, v19
    v_mfma_f32_32x32x16_bf16 v[64:79], v[112:115], v[88:91], v[64:79]
    ds_read_b128 v[112:115], v3 offset:21120
    v_exp_f32 v22, v22
    v_exp_f32 v23, v23
    v_cvt_pk_bf16_f32 v82, v20, v21
    v_exp_f32 v24, v24
    v_exp_f32 v25, v25
    v_cvt_pk_bf16_f32 v83, v22, v23
    v_exp_f32 v26, v26
    v_exp_f32 v27, v27
    v_mfma_f32_32x32x16_bf16 v[64:79], v[116:119], v[92:95], v[64:79]
    ds_read_b128 v[116:119], v4 offset:21120
    v_cvt_pk_bf16_f32 v84, v24, v25
    v_exp_f32 v28, v28
    v_exp_f32 v29, v29
    v_cvt_pk_bf16_f32 v85, v26, v27
    v_exp_f32 v30, v30
    v_exp_f32 v31, v31
    v_cvt_pk_bf16_f32 v86, v28, v29
    v_cvt_pk_bf16_f32 v87, v30, v31
    v_mfma_f32_32x32x16_bf16 v[16:31], v[104:107], v[96:99], 0
    buffer_load_dwordx4 a[232:235], v1, s[8:11], s58 offen offset:2048 sc1
    v_exp_f32 v32, v32
    v_exp_f32 v33, v33
    v_exp_f32 v34, v34
    v_exp_f32 v35, v35
    v_cvt_pk_bf16_f32 v88, v32, v33
    v_exp_f32 v36, v36
    v_exp_f32 v37, v37
    v_cvt_pk_bf16_f32 v89, v34, v35
    v_mfma_f32_32x32x16_bf16 v[48:63], v[120:123], v[80:83], v[48:63]
    buffer_load_dwordx4 a[236:239], v1, s[8:11], s58 offen offset:3072 sc1
    v_exp_f32 v38, v38
    v_exp_f32 v39, v39
    v_cvt_pk_bf16_f32 v90, v36, v37
    v_exp_f32 v40, v40
    v_exp_f32 v41, v41
    v_cvt_pk_bf16_f32 v91, v38, v39
    v_exp_f32 v42, v42
    v_exp_f32 v43, v43
    v_mfma_f32_32x32x16_bf16 v[48:63], v[124:127], v[84:87], v[48:63]
    s_waitcnt lgkmcnt(0)
    v_cvt_pk_bf16_f32 v92, v40, v41
    v_exp_f32 v44, v44
    v_exp_f32 v45, v45
    v_cvt_pk_bf16_f32 v93, v42, v43
    v_exp_f32 v46, v46
    v_exp_f32 v47, v47
    v_cvt_pk_bf16_f32 v94, v44, v45
    v_cvt_pk_bf16_f32 v95, v46, v47
    v_mfma_f32_32x32x16_bf16 v[32:47], v[104:107], v[100:103], 0
    ds_read_b128 v[104:107], v2 offset:22528
    v_exp_f32 v16, v16
    v_exp_f32 v17, v17
    v_exp_f32 v18, v18
    v_exp_f32 v19, v19
    v_cvt_pk_bf16_f32 v80, v16, v17
    v_exp_f32 v20, v20
    v_exp_f32 v21, v21
    v_cvt_pk_bf16_f32 v81, v18, v19
    v_mfma_f32_32x32x16_bf16 v[64:79], v[120:123], v[88:91], v[64:79]
    ds_read_b128 v[120:123], v3 offset:22176
    v_exp_f32 v22, v22
    v_exp_f32 v23, v23
    v_cvt_pk_bf16_f32 v82, v20, v21
    v_exp_f32 v24, v24
    v_exp_f32 v25, v25
    v_cvt_pk_bf16_f32 v83, v22, v23
    v_exp_f32 v26, v26
    v_exp_f32 v27, v27
    v_mfma_f32_32x32x16_bf16 v[64:79], v[124:127], v[92:95], v[64:79]
    ds_read_b128 v[124:127], v4 offset:22176
    v_cvt_pk_bf16_f32 v84, v24, v25
    v_exp_f32 v28, v28
    v_exp_f32 v29, v29
    v_cvt_pk_bf16_f32 v85, v26, v27
    v_exp_f32 v30, v30
    v_exp_f32 v31, v31
    v_cvt_pk_bf16_f32 v86, v28, v29
    v_cvt_pk_bf16_f32 v87, v30, v31
    v_mfma_f32_32x32x16_bf16 v[16:31], v[108:111], v[96:99], 0
    s_add_u32 s58, s57, s19
    s_add_u32 s58, s58, 524288
    buffer_load_dwordx4 a[240:243], v1, s[8:11], s58 offen offset:0 sc1
    v_exp_f32 v32, v32
    v_exp_f32 v33, v33
    v_exp_f32 v34, v34
    v_exp_f32 v35, v35
    v_cvt_pk_bf16_f32 v88, v32, v33
    v_exp_f32 v36, v36
    v_exp_f32 v37, v37
    v_cvt_pk_bf16_f32 v89, v34, v35
    v_mfma_f32_32x32x16_bf16 v[48:63], v[112:115], v[80:83], v[48:63]
    buffer_load_dwordx4 a[244:247], v1, s[8:11], s58 offen offset:1024 sc1
    v_exp_f32 v38, v38
    v_exp_f32 v39, v39
    v_cvt_pk_bf16_f32 v90, v36, v37
    v_exp_f32 v40, v40
    v_exp_f32 v41, v41
    v_cvt_pk_bf16_f32 v91, v38, v39
    v_exp_f32 v42, v42
    v_exp_f32 v43, v43
    v_mfma_f32_32x32x16_bf16 v[48:63], v[116:119], v[84:87], v[48:63]
    s_waitcnt lgkmcnt(0)
    v_cvt_pk_bf16_f32 v92, v40, v41
    v_exp_f32 v44, v44
    v_exp_f32 v45, v45
    v_cvt_pk_bf16_f32 v93, v42, v43
    v_exp_f32 v46, v46
    v_exp_f32 v47, v47
    v_cvt_pk_bf16_f32 v94, v44, v45
    v_cvt_pk_bf16_f32 v95, v46, v47
    v_mfma_f32_32x32x16_bf16 v[32:47], v[108:111], v[100:103], 0
    ds_read_b128 v[108:111], v2 offset:23552
    v_exp_f32 v16, v16
    v_exp_f32 v17, v17
    v_exp_f32 v18, v18
    v_exp_f32 v19, v19
    v_cvt_pk_bf16_f32 v80, v16, v17
    v_exp_f32 v20, v20
    v_exp_f32 v21, v21
    v_cvt_pk_bf16_f32 v81, v18, v19
    v_mfma_f32_32x32x16_bf16 v[64:79], v[112:115], v[88:91], v[64:79]
    ds_read_b128 v[112:115], v3 offset:23232
    v_exp_f32 v22, v22
    v_exp_f32 v23, v23
    v_cvt_pk_bf16_f32 v82, v20, v21
    v_exp_f32 v24, v24
    v_exp_f32 v25, v25
    v_cvt_pk_bf16_f32 v83, v22, v23
    v_exp_f32 v26, v26
    v_exp_f32 v27, v27
    v_mfma_f32_32x32x16_bf16 v[64:79], v[116:119], v[92:95], v[64:79]
    ds_read_b128 v[116:119], v4 offset:23232
    v_cvt_pk_bf16_f32 v84, v24, v25
    v_exp_f32 v28, v28
    v_exp_f32 v29, v29
    v_cvt_pk_bf16_f32 v85, v26, v27
    v_exp_f32 v30, v30
    v_exp_f32 v31, v31
    v_cvt_pk_bf16_f32 v86, v28, v29
    v_cvt_pk_bf16_f32 v87, v30, v31
    v_mfma_f32_32x32x16_bf16 v[16:31], v[104:107], v[96:99], 0
    buffer_load_dwordx4 a[248:251], v1, s[8:11], s58 offen offset:2048 sc1
    v_exp_f32 v32, v32
    v_exp_f32 v33, v33
    v_exp_f32 v34, v34
    v_exp_f32 v35, v35
    v_cvt_pk_bf16_f32 v88, v32, v33
    v_exp_f32 v36, v36
    v_exp_f32 v37, v37
    v_cvt_pk_bf16_f32 v89, v34, v35
    v_mfma_f32_32x32x16_bf16 v[48:63], v[120:123], v[80:83], v[48:63]
    buffer_load_dwordx4 a[252:255], v1, s[8:11], s58 offen offset:3072 sc1
    v_exp_f32 v38, v38
    v_exp_f32 v39, v39
    v_cvt_pk_bf16_f32 v90, v36, v37
    v_exp_f32 v40, v40
    v_exp_f32 v41, v41
    v_cvt_pk_bf16_f32 v91, v38, v39
    v_exp_f32 v42, v42
    v_exp_f32 v43, v43
    v_mfma_f32_32x32x16_bf16 v[48:63], v[124:127], v[84:87], v[48:63]
    s_waitcnt lgkmcnt(0)
    v_cvt_pk_bf16_f32 v92, v40, v41
    v_exp_f32 v44, v44
    v_exp_f32 v45, v45
    v_cvt_pk_bf16_f32 v93, v42, v43
    v_exp_f32 v46, v46
    v_exp_f32 v47, v47
    v_cvt_pk_bf16_f32 v94, v44, v45
    v_cvt_pk_bf16_f32 v95, v46, v47
    v_mfma_f32_32x32x16_bf16 v[32:47], v[104:107], v[100:103], 0
    ds_read_b128 v[104:107], v2 offset:24576
    v_exp_f32 v16, v16
    v_exp_f32 v17, v17
    v_exp_f32 v18, v18
    v_exp_f32 v19, v19
    v_cvt_pk_bf16_f32 v80, v16, v17
    v_exp_f32 v20, v20
    v_exp_f32 v21, v21
    v_cvt_pk_bf16_f32 v81, v18, v19
    v_mfma_f32_32x32x16_bf16 v[64:79], v[120:123], v[88:91], v[64:79]
    ds_read_b128 v[120:123], v3 offset:24288
    v_exp_f32 v22, v22
    v_exp_f32 v23, v23
    v_cvt_pk_bf16_f32 v82, v20, v21
    v_exp_f32 v24, v24
    v_exp_f32 v25, v25
    v_cvt_pk_bf16_f32 v83, v22, v23
    v_exp_f32 v26, v26
    v_exp_f32 v27, v27
    v_mfma_f32_32x32x16_bf16 v[64:79], v[124:127], v[92:95], v[64:79]
    ds_read_b128 v[124:127], v4 offset:24288
    v_cvt_pk_bf16_f32 v84, v24, v25
    v_exp_f32 v28, v28
    v_exp_f32 v29, v29
    v_cvt_pk_bf16_f32 v85, v26, v27
    v_exp_f32 v30, v30
    v_exp_f32 v31, v31
    v_cvt_pk_bf16_f32 v86, v28, v29
    v_cvt_pk_bf16_f32 v87, v30, v31
    v_mfma_f32_32x32x16_bf16 v[16:31], v[108:111], v[96:99], 0
    s_cmp_eq_u32 s55, 1
    s_cselect_b64 exec, -1, 0
    buffer_load_dwordx2 v[246:247], v8, s[8:11], s59 offen sc1
    s_add_u32 s59, s59, 16384
    buffer_load_dwordx2 v[248:249], v8, s[8:11], s59 offen sc1
    s_add_u32 s59, s59, 16384
    buffer_load_dwordx2 v[250:251], v8, s[8:11], s59 offen sc1
    s_add_u32 s59, s59, 16384
    buffer_load_dwordx2 v[252:253], v8, s[8:11], s59 offen sc1
    s_mov_b64 exec, -1
    v_exp_f32 v32, v32
    v_exp_f32 v33, v33
    v_exp_f32 v34, v34
    v_exp_f32 v35, v35
    v_cvt_pk_bf16_f32 v88, v32, v33
    v_exp_f32 v36, v36
    v_exp_f32 v37, v37
    v_cvt_pk_bf16_f32 v89, v34, v35
    v_mfma_f32_32x32x16_bf16 v[48:63], v[112:115], v[80:83], v[48:63]
    s_add_u32 s58, s57, s16
    s_add_u32 s58, s58, 1572864
    buffer_load_dwordx4 a[0:3], v1, s[8:11], s58 offen offset:0 sc1
    v_exp_f32 v38, v38
    v_exp_f32 v39, v39
    v_cvt_pk_bf16_f32 v90, v36, v37
    v_exp_f32 v40, v40
    v_exp_f32 v41, v41
    v_cvt_pk_bf16_f32 v91, v38, v39
    v_exp_f32 v42, v42
    v_exp_f32 v43, v43
    v_mfma_f32_32x32x16_bf16 v[48:63], v[116:119], v[84:87], v[48:63]
    s_waitcnt lgkmcnt(0)
    v_cvt_pk_bf16_f32 v92, v40, v41
    v_exp_f32 v44, v44
    v_exp_f32 v45, v45
    v_cvt_pk_bf16_f32 v93, v42, v43
    v_exp_f32 v46, v46
    v_exp_f32 v47, v47
    v_cvt_pk_bf16_f32 v94, v44, v45
    v_cvt_pk_bf16_f32 v95, v46, v47
    v_mfma_f32_32x32x16_bf16 v[32:47], v[108:111], v[100:103], 0
    ds_read_b128 v[108:111], v2 offset:25600
    v_exp_f32 v16, v16
    v_exp_f32 v17, v17
    v_exp_f32 v18, v18
    v_exp_f32 v19, v19
    v_cvt_pk_bf16_f32 v80, v16, v17
    v_exp_f32 v20, v20
    v_exp_f32 v21, v21
    v_cvt_pk_bf16_f32 v81, v18, v19
    v_mfma_f32_32x32x16_bf16 v[64:79], v[112:115], v[88:91], v[64:79]
    ds_read_b128 v[112:115], v3 offset:25344
    v_exp_f32 v22, v22
    v_exp_f32 v23, v23
    v_cvt_pk_bf16_f32 v82, v20, v21
    v_exp_f32 v24, v24
    v_exp_f32 v25, v25
    v_cvt_pk_bf16_f32 v83, v22, v23
    v_exp_f32 v26, v26
    v_exp_f32 v27, v27
    v_mfma_f32_32x32x16_bf16 v[64:79], v[116:119], v[92:95], v[64:79]
    ds_read_b128 v[116:119], v4 offset:25344
    v_cvt_pk_bf16_f32 v84, v24, v25
    v_exp_f32 v28, v28
    v_exp_f32 v29, v29
    v_cvt_pk_bf16_f32 v85, v26, v27
    v_exp_f32 v30, v30
    v_exp_f32 v31, v31
    v_cvt_pk_bf16_f32 v86, v28, v29
    v_cvt_pk_bf16_f32 v87, v30, v31
    v_mfma_f32_32x32x16_bf16 v[16:31], v[104:107], v[96:99], 0
    buffer_load_dwordx4 a[4:7], v1, s[8:11], s58 offen offset:1024 sc1
    v_exp_f32 v32, v32
    v_exp_f32 v33, v33
    v_exp_f32 v34, v34
    v_exp_f32 v35, v35
    v_cvt_pk_bf16_f32 v88, v32, v33
    v_exp_f32 v36, v36
    v_exp_f32 v37, v37
    v_cvt_pk_bf16_f32 v89, v34, v35
    v_mfma_f32_32x32x16_bf16 v[48:63], v[120:123], v[80:83], v[48:63]
    buffer_load_dwordx4 a[8:11], v1, s[8:11], s58 offen offset:2048 sc1
    v_exp_f32 v38, v38
    v_exp_f32 v39, v39
    v_cvt_pk_bf16_f32 v90, v36, v37
    v_exp_f32 v40, v40
    v_exp_f32 v41, v41
    v_cvt_pk_bf16_f32 v91, v38, v39
    v_exp_f32 v42, v42
    v_exp_f32 v43, v43
    v_mfma_f32_32x32x16_bf16 v[48:63], v[124:127], v[84:87], v[48:63]
    s_waitcnt lgkmcnt(0)
    v_cvt_pk_bf16_f32 v92, v40, v41
    v_exp_f32 v44, v44
    v_exp_f32 v45, v45
    v_cvt_pk_bf16_f32 v93, v42, v43
    v_exp_f32 v46, v46
    v_exp_f32 v47, v47
    v_cvt_pk_bf16_f32 v94, v44, v45
    v_cvt_pk_bf16_f32 v95, v46, v47
    v_mfma_f32_32x32x16_bf16 v[32:47], v[104:107], v[100:103], 0
    ds_read_b128 v[104:107], v2 offset:26624
    v_exp_f32 v16, v16
    v_exp_f32 v17, v17
    v_exp_f32 v18, v18
    v_exp_f32 v19, v19
    v_cvt_pk_bf16_f32 v80, v16, v17
    v_exp_f32 v20, v20
    v_exp_f32 v21, v21
    v_cvt_pk_bf16_f32 v81, v18, v19
    v_mfma_f32_32x32x16_bf16 v[64:79], v[120:123], v[88:91], v[64:79]
    ds_read_b128 v[120:123], v3 offset:26400
    v_exp_f32 v22, v22
    v_exp_f32 v23, v23
    v_cvt_pk_bf16_f32 v82, v20, v21
    v_exp_f32 v24, v24
    v_exp_f32 v25, v25
    v_cvt_pk_bf16_f32 v83, v22, v23
    v_exp_f32 v26, v26
    v_exp_f32 v27, v27
    v_mfma_f32_32x32x16_bf16 v[64:79], v[124:127], v[92:95], v[64:79]
    ds_read_b128 v[124:127], v4 offset:26400
    v_cvt_pk_bf16_f32 v84, v24, v25
    v_exp_f32 v28, v28
    v_exp_f32 v29, v29
    v_cvt_pk_bf16_f32 v85, v26, v27
    v_exp_f32 v30, v30
    v_exp_f32 v31, v31
    v_cvt_pk_bf16_f32 v86, v28, v29
    v_cvt_pk_bf16_f32 v87, v30, v31
    v_mfma_f32_32x32x16_bf16 v[16:31], v[108:111], v[96:99], 0
    buffer_load_dwordx4 a[12:15], v1, s[8:11], s58 offen offset:3072 sc1
    v_exp_f32 v32, v32
    v_exp_f32 v33, v33
    v_exp_f32 v34, v34
    v_exp_f32 v35, v35
    v_cvt_pk_bf16_f32 v88, v32, v33
    v_exp_f32 v36, v36
    v_exp_f32 v37, v37
    v_cvt_pk_bf16_f32 v89, v34, v35
    v_mfma_f32_32x32x16_bf16 v[48:63], v[112:115], v[80:83], v[48:63]
    s_add_u32 s58, s57, s17
    s_add_u32 s58, s58, 1572864
    buffer_load_dwordx4 a[16:19], v1, s[8:11], s58 offen offset:0 sc1
    v_exp_f32 v38, v38
    v_exp_f32 v39, v39
    v_cvt_pk_bf16_f32 v90, v36, v37
    v_exp_f32 v40, v40
    v_exp_f32 v41, v41
    v_cvt_pk_bf16_f32 v91, v38, v39
    v_exp_f32 v42, v42
    v_exp_f32 v43, v43
    v_mfma_f32_32x32x16_bf16 v[48:63], v[116:119], v[84:87], v[48:63]
    s_waitcnt lgkmcnt(0)
    v_cvt_pk_bf16_f32 v92, v40, v41
    v_exp_f32 v44, v44
    v_exp_f32 v45, v45
    v_cvt_pk_bf16_f32 v93, v42, v43
    v_exp_f32 v46, v46
    v_exp_f32 v47, v47
    v_cvt_pk_bf16_f32 v94, v44, v45
    v_cvt_pk_bf16_f32 v95, v46, v47
    v_mfma_f32_32x32x16_bf16 v[32:47], v[108:111], v[100:103], 0
    ds_read_b128 v[108:111], v2 offset:27648
    v_exp_f32 v16, v16
    v_exp_f32 v17, v17
    v_exp_f32 v18, v18
    v_exp_f32 v19, v19
    v_cvt_pk_bf16_f32 v80, v16, v17
    v_exp_f32 v20, v20
    v_exp_f32 v21, v21
    v_cvt_pk_bf16_f32 v81, v18, v19
    v_mfma_f32_32x32x16_bf16 v[64:79], v[112:115], v[88:91], v[64:79]
    ds_read_b128 v[112:115], v3 offset:27456
    v_exp_f32 v22, v22
    v_exp_f32 v23, v23
    v_cvt_pk_bf16_f32 v82, v20, v21
    v_exp_f32 v24, v24
    v_exp_f32 v25, v25
    v_cvt_pk_bf16_f32 v83, v22, v23
    v_exp_f32 v26, v26
    v_exp_f32 v27, v27
    v_mfma_f32_32x32x16_bf16 v[64:79], v[116:119], v[92:95], v[64:79]
    ds_read_b128 v[116:119], v4 offset:27456
    v_cvt_pk_bf16_f32 v84, v24, v25
    v_exp_f32 v28, v28
    v_exp_f32 v29, v29
    v_cvt_pk_bf16_f32 v85, v26, v27
    v_exp_f32 v30, v30
    v_exp_f32 v31, v31
    v_cvt_pk_bf16_f32 v86, v28, v29
    v_cvt_pk_bf16_f32 v87, v30, v31
    v_mfma_f32_32x32x16_bf16 v[16:31], v[104:107], v[96:99], 0
    buffer_load_dwordx4 a[20:23], v1, s[8:11], s58 offen offset:1024 sc1
    v_exp_f32 v32, v32
    v_exp_f32 v33, v33
    v_exp_f32 v34, v34
    v_exp_f32 v35, v35
    v_cvt_pk_bf16_f32 v88, v32, v33
    v_exp_f32 v36, v36
    v_exp_f32 v37, v37
    v_cvt_pk_bf16_f32 v89, v34, v35
    v_mfma_f32_32x32x16_bf16 v[48:63], v[120:123], v[80:83], v[48:63]
    buffer_load_dwordx4 a[24:27], v1, s[8:11], s58 offen offset:2048 sc1
    v_exp_f32 v38, v38
    v_exp_f32 v39, v39
    v_cvt_pk_bf16_f32 v90, v36, v37
    v_exp_f32 v40, v40
    v_exp_f32 v41, v41
    v_cvt_pk_bf16_f32 v91, v38, v39
    v_exp_f32 v42, v42
    v_exp_f32 v43, v43
    v_mfma_f32_32x32x16_bf16 v[48:63], v[124:127], v[84:87], v[48:63]
    s_waitcnt lgkmcnt(0)
    v_cvt_pk_bf16_f32 v92, v40, v41
    v_exp_f32 v44, v44
    v_exp_f32 v45, v45
    v_cvt_pk_bf16_f32 v93, v42, v43
    v_exp_f32 v46, v46
    v_exp_f32 v47, v47
    v_cvt_pk_bf16_f32 v94, v44, v45
    v_cvt_pk_bf16_f32 v95, v46, v47
    v_mfma_f32_32x32x16_bf16 v[32:47], v[104:107], v[100:103], 0
    ds_read_b128 v[104:107], v2 offset:28672
    v_exp_f32 v16, v16
    v_exp_f32 v17, v17
    v_exp_f32 v18, v18
    v_exp_f32 v19, v19
    v_cvt_pk_bf16_f32 v80, v16, v17
    v_exp_f32 v20, v20
    v_exp_f32 v21, v21
    v_cvt_pk_bf16_f32 v81, v18, v19
    v_mfma_f32_32x32x16_bf16 v[64:79], v[120:123], v[88:91], v[64:79]
    ds_read_b128 v[120:123], v3 offset:28512
    v_exp_f32 v22, v22
    v_exp_f32 v23, v23
    v_cvt_pk_bf16_f32 v82, v20, v21
    v_exp_f32 v24, v24
    v_exp_f32 v25, v25
    v_cvt_pk_bf16_f32 v83, v22, v23
    v_exp_f32 v26, v26
    v_exp_f32 v27, v27
    v_mfma_f32_32x32x16_bf16 v[64:79], v[124:127], v[92:95], v[64:79]
    ds_read_b128 v[124:127], v4 offset:28512
    v_cvt_pk_bf16_f32 v84, v24, v25
    v_exp_f32 v28, v28
    v_exp_f32 v29, v29
    v_cvt_pk_bf16_f32 v85, v26, v27
    v_exp_f32 v30, v30
    v_exp_f32 v31, v31
    v_cvt_pk_bf16_f32 v86, v28, v29
    v_cvt_pk_bf16_f32 v87, v30, v31
    v_mfma_f32_32x32x16_bf16 v[16:31], v[108:111], v[96:99], 0
    buffer_load_dwordx4 a[28:31], v1, s[8:11], s58 offen offset:3072 sc1
    v_exp_f32 v32, v32
    v_exp_f32 v33, v33
    v_exp_f32 v34, v34
    v_exp_f32 v35, v35
    v_cvt_pk_bf16_f32 v88, v32, v33
    v_exp_f32 v36, v36
    v_exp_f32 v37, v37
    v_cvt_pk_bf16_f32 v89, v34, v35
    v_mfma_f32_32x32x16_bf16 v[48:63], v[112:115], v[80:83], v[48:63]
    s_add_u32 s58, s57, s18
    s_add_u32 s58, s58, 1572864
    buffer_load_dwordx4 a[32:35], v1, s[8:11], s58 offen offset:0 sc1
    v_exp_f32 v38, v38
    v_exp_f32 v39, v39
    v_cvt_pk_bf16_f32 v90, v36, v37
    v_exp_f32 v40, v40
    v_exp_f32 v41, v41
    v_cvt_pk_bf16_f32 v91, v38, v39
    v_exp_f32 v42, v42
    v_exp_f32 v43, v43
    v_mfma_f32_32x32x16_bf16 v[48:63], v[116:119], v[84:87], v[48:63]
    s_waitcnt lgkmcnt(0)
    v_cvt_pk_bf16_f32 v92, v40, v41
    v_exp_f32 v44, v44
    v_exp_f32 v45, v45
    v_cvt_pk_bf16_f32 v93, v42, v43
    v_exp_f32 v46, v46
    v_exp_f32 v47, v47
    v_cvt_pk_bf16_f32 v94, v44, v45
    v_cvt_pk_bf16_f32 v95, v46, v47
    v_mfma_f32_32x32x16_bf16 v[32:47], v[108:111], v[100:103], 0
    ds_read_b128 v[108:111], v2 offset:29696
    v_exp_f32 v16, v16
    v_exp_f32 v17, v17
    v_exp_f32 v18, v18
    v_exp_f32 v19, v19
    v_cvt_pk_bf16_f32 v80, v16, v17
    v_exp_f32 v20, v20
    v_exp_f32 v21, v21
    v_cvt_pk_bf16_f32 v81, v18, v19
    v_mfma_f32_32x32x16_bf16 v[64:79], v[112:115], v[88:91], v[64:79]
    ds_read_b128 v[112:115], v3 offset:29568
    v_exp_f32 v22, v22
    v_exp_f32 v23, v23
    v_cvt_pk_bf16_f32 v82, v20, v21
    v_exp_f32 v24, v24
    v_exp_f32 v25, v25
    v_cvt_pk_bf16_f32 v83, v22, v23
    v_exp_f32 v26, v26
    v_exp_f32 v27, v27
    v_mfma_f32_32x32x16_bf16 v[64:79], v[116:119], v[92:95], v[64:79]
    ds_read_b128 v[116:119], v4 offset:29568
    v_cvt_pk_bf16_f32 v84, v24, v25
    v_exp_f32 v28, v28
    v_exp_f32 v29, v29
    v_cvt_pk_bf16_f32 v85, v26, v27
    v_exp_f32 v30, v30
    v_exp_f32 v31, v31
    v_cvt_pk_bf16_f32 v86, v28, v29
    v_cvt_pk_bf16_f32 v87, v30, v31
    v_mfma_f32_32x32x16_bf16 v[16:31], v[104:107], v[96:99], 0
    buffer_load_dwordx4 a[36:39], v1, s[8:11], s58 offen offset:1024 sc1
    v_exp_f32 v32, v32
    v_exp_f32 v33, v33
    v_exp_f32 v34, v34
    v_exp_f32 v35, v35
    v_cvt_pk_bf16_f32 v88, v32, v33
    v_exp_f32 v36, v36
    v_exp_f32 v37, v37
    v_cvt_pk_bf16_f32 v89, v34, v35
    v_mfma_f32_32x32x16_bf16 v[48:63], v[120:123], v[80:83], v[48:63]
    buffer_load_dwordx4 a[40:43], v1, s[8:11], s58 offen offset:2048 sc1
    v_exp_f32 v38, v38
    v_exp_f32 v39, v39
    v_cvt_pk_bf16_f32 v90, v36, v37
    v_exp_f32 v40, v40
    v_exp_f32 v41, v41
    v_cvt_pk_bf16_f32 v91, v38, v39
    v_exp_f32 v42, v42
    v_exp_f32 v43, v43
    v_mfma_f32_32x32x16_bf16 v[48:63], v[124:127], v[84:87], v[48:63]
    s_waitcnt lgkmcnt(0)
    v_cvt_pk_bf16_f32 v92, v40, v41
    v_exp_f32 v44, v44
    v_exp_f32 v45, v45
    v_cvt_pk_bf16_f32 v93, v42, v43
    v_exp_f32 v46, v46
    v_exp_f32 v47, v47
    v_cvt_pk_bf16_f32 v94, v44, v45
    v_cvt_pk_bf16_f32 v95, v46, v47
    v_mfma_f32_32x32x16_bf16 v[32:47], v[104:107], v[100:103], 0
    ds_read_b128 v[104:107], v2 offset:30720
    v_exp_f32 v16, v16
    v_exp_f32 v17, v17
    v_exp_f32 v18, v18
    v_exp_f32 v19, v19
    v_cvt_pk_bf16_f32 v80, v16, v17
    v_exp_f32 v20, v20
    v_exp_f32 v21, v21
    v_cvt_pk_bf16_f32 v81, v18, v19
    v_mfma_f32_32x32x16_bf16 v[64:79], v[120:123], v[88:91], v[64:79]
    ds_read_b128 v[120:123], v3 offset:30624
    v_exp_f32 v22, v22
    v_exp_f32 v23, v23
    v_cvt_pk_bf16_f32 v82, v20, v21
    v_exp_f32 v24, v24
    v_exp_f32 v25, v25
    v_cvt_pk_bf16_f32 v83, v22, v23
    v_exp_f32 v26, v26
    v_exp_f32 v27, v27
    v_mfma_f32_32x32x16_bf16 v[64:79], v[124:127], v[92:95], v[64:79]
    ds_read_b128 v[124:127], v4 offset:30624
    v_cvt_pk_bf16_f32 v84, v24, v25
    v_exp_f32 v28, v28
    v_exp_f32 v29, v29
    v_cvt_pk_bf16_f32 v85, v26, v27
    v_exp_f32 v30, v30
    v_exp_f32 v31, v31
    v_cvt_pk_bf16_f32 v86, v28, v29
    v_cvt_pk_bf16_f32 v87, v30, v31
    v_mfma_f32_32x32x16_bf16 v[16:31], v[108:111], v[96:99], 0
    buffer_load_dwordx4 a[44:47], v1, s[8:11], s58 offen offset:3072 sc1
    v_exp_f32 v32, v32
    v_exp_f32 v33, v33
    v_exp_f32 v34, v34
    v_exp_f32 v35, v35
    v_cvt_pk_bf16_f32 v88, v32, v33
    v_exp_f32 v36, v36
    v_exp_f32 v37, v37
    v_cvt_pk_bf16_f32 v89, v34, v35
    v_mfma_f32_32x32x16_bf16 v[48:63], v[112:115], v[80:83], v[48:63]
    s_add_u32 s58, s57, s19
    s_add_u32 s58, s58, 1572864
    buffer_load_dwordx4 a[48:51], v1, s[8:11], s58 offen offset:0 sc1
    v_exp_f32 v38, v38
    v_exp_f32 v39, v39
    v_cvt_pk_bf16_f32 v90, v36, v37
    v_exp_f32 v40, v40
    v_exp_f32 v41, v41
    v_cvt_pk_bf16_f32 v91, v38, v39
    v_exp_f32 v42, v42
    v_exp_f32 v43, v43
    v_mfma_f32_32x32x16_bf16 v[48:63], v[116:119], v[84:87], v[48:63]
    s_waitcnt lgkmcnt(0)
    v_cvt_pk_bf16_f32 v92, v40, v41
    v_exp_f32 v44, v44
    v_exp_f32 v45, v45
    v_cvt_pk_bf16_f32 v93, v42, v43
    v_exp_f32 v46, v46
    v_exp_f32 v47, v47
    v_cvt_pk_bf16_f32 v94, v44, v45
    v_cvt_pk_bf16_f32 v95, v46, v47
    v_mfma_f32_32x32x16_bf16 v[32:47], v[108:111], v[100:103], 0
    ds_read_b128 v[108:111], v2 offset:31744
    v_exp_f32 v16, v16
    v_exp_f32 v17, v17
    v_exp_f32 v18, v18
    v_exp_f32 v19, v19
    v_cvt_pk_bf16_f32 v80, v16, v17
    v_exp_f32 v20, v20
    v_exp_f32 v21, v21
    v_cvt_pk_bf16_f32 v81, v18, v19
    v_mfma_f32_32x32x16_bf16 v[64:79], v[112:115], v[88:91], v[64:79]
    ds_read_b128 v[112:115], v3 offset:31680
    v_exp_f32 v22, v22
    v_exp_f32 v23, v23
    v_cvt_pk_bf16_f32 v82, v20, v21
    v_exp_f32 v24, v24
    v_exp_f32 v25, v25
    v_cvt_pk_bf16_f32 v83, v22, v23
    v_exp_f32 v26, v26
    v_exp_f32 v27, v27
    v_mfma_f32_32x32x16_bf16 v[64:79], v[116:119], v[92:95], v[64:79]
    ds_read_b128 v[116:119], v4 offset:31680
    v_cvt_pk_bf16_f32 v84, v24, v25
    v_exp_f32 v28, v28
    v_exp_f32 v29, v29
    v_cvt_pk_bf16_f32 v85, v26, v27
    v_exp_f32 v30, v30
    v_exp_f32 v31, v31
    v_cvt_pk_bf16_f32 v86, v28, v29
    v_cvt_pk_bf16_f32 v87, v30, v31
    v_mfma_f32_32x32x16_bf16 v[16:31], v[104:107], v[96:99], 0
    buffer_load_dwordx4 a[52:55], v1, s[8:11], s58 offen offset:1024 sc1
    v_exp_f32 v32, v32
    v_exp_f32 v33, v33
    v_exp_f32 v34, v34
    v_exp_f32 v35, v35
    v_cvt_pk_bf16_f32 v88, v32, v33
    v_exp_f32 v36, v36
    v_exp_f32 v37, v37
    v_cvt_pk_bf16_f32 v89, v34, v35
    v_mfma_f32_32x32x16_bf16 v[48:63], v[120:123], v[80:83], v[48:63]
    buffer_load_dwordx4 a[56:59], v1, s[8:11], s58 offen offset:2048 sc1
    v_exp_f32 v38, v38
    v_exp_f32 v39, v39
    v_cvt_pk_bf16_f32 v90, v36, v37
    v_exp_f32 v40, v40
    v_exp_f32 v41, v41
    v_cvt_pk_bf16_f32 v91, v38, v39
    v_exp_f32 v42, v42
    v_exp_f32 v43, v43
    v_mfma_f32_32x32x16_bf16 v[48:63], v[124:127], v[84:87], v[48:63]
    s_waitcnt lgkmcnt(0)
    v_cvt_pk_bf16_f32 v92, v40, v41
    v_exp_f32 v44, v44
    v_exp_f32 v45, v45
    v_cvt_pk_bf16_f32 v93, v42, v43
    v_exp_f32 v46, v46
    v_exp_f32 v47, v47
    v_cvt_pk_bf16_f32 v94, v44, v45
    v_cvt_pk_bf16_f32 v95, v46, v47
    v_mfma_f32_32x32x16_bf16 v[32:47], v[104:107], v[100:103], 0
    ds_read_b128 v[104:107], v2 offset:32768
    v_exp_f32 v16, v16
    v_exp_f32 v17, v17
    v_exp_f32 v18, v18
    v_exp_f32 v19, v19
    v_cvt_pk_bf16_f32 v80, v16, v17
    v_exp_f32 v20, v20
    v_exp_f32 v21, v21
    v_cvt_pk_bf16_f32 v81, v18, v19
    v_mfma_f32_32x32x16_bf16 v[64:79], v[120:123], v[88:91], v[64:79]
    ds_read_b128 v[120:123], v3 offset:32736
    v_exp_f32 v22, v22
    v_exp_f32 v23, v23
    v_cvt_pk_bf16_f32 v82, v20, v21
    v_exp_f32 v24, v24
    v_exp_f32 v25, v25
    v_cvt_pk_bf16_f32 v83, v22, v23
    v_exp_f32 v26, v26
    v_exp_f32 v27, v27
    v_mfma_f32_32x32x16_bf16 v[64:79], v[124:127], v[92:95], v[64:79]
    ds_read_b128 v[124:127], v4 offset:32736
    v_cvt_pk_bf16_f32 v84, v24, v25
    v_exp_f32 v28, v28
    v_exp_f32 v29, v29
    v_cvt_pk_bf16_f32 v85, v26, v27
    v_exp_f32 v30, v30
    v_exp_f32 v31, v31
    v_cvt_pk_bf16_f32 v86, v28, v29
    v_cvt_pk_bf16_f32 v87, v30, v31
    v_mfma_f32_32x32x16_bf16 v[16:31], v[108:111], v[96:99], 0
    buffer_load_dwordx4 a[60:63], v1, s[8:11], s58 offen offset:3072 sc1
    v_exp_f32 v32, v32
    v_exp_f32 v33, v33
    v_exp_f32 v34, v34
    v_exp_f32 v35, v35
    v_cvt_pk_bf16_f32 v88, v32, v33
    v_exp_f32 v36, v36
    v_exp_f32 v37, v37
    v_cvt_pk_bf16_f32 v89, v34, v35
    v_mfma_f32_32x32x16_bf16 v[48:63], v[112:115], v[80:83], v[48:63]
    s_add_u32 s58, s57, s16
    s_add_u32 s58, s58, 2097152
    buffer_load_dwordx4 a[64:67], v1, s[8:11], s58 offen offset:0 sc1
    v_exp_f32 v38, v38
    v_exp_f32 v39, v39
    v_cvt_pk_bf16_f32 v90, v36, v37
    v_exp_f32 v40, v40
    v_exp_f32 v41, v41
    v_cvt_pk_bf16_f32 v91, v38, v39
    v_exp_f32 v42, v42
    v_exp_f32 v43, v43
    v_mfma_f32_32x32x16_bf16 v[48:63], v[116:119], v[84:87], v[48:63]
    s_waitcnt lgkmcnt(0)
    v_cvt_pk_bf16_f32 v92, v40, v41
    v_exp_f32 v44, v44
    v_exp_f32 v45, v45
    v_cvt_pk_bf16_f32 v93, v42, v43
    v_exp_f32 v46, v46
    v_exp_f32 v47, v47
    v_cvt_pk_bf16_f32 v94, v44, v45
    v_cvt_pk_bf16_f32 v95, v46, v47
    v_mfma_f32_32x32x16_bf16 v[32:47], v[108:111], v[100:103], 0
    ds_read_b128 v[108:111], v2 offset:33792
    v_exp_f32 v16, v16
    v_exp_f32 v17, v17
    v_exp_f32 v18, v18
    v_exp_f32 v19, v19
    v_cvt_pk_bf16_f32 v80, v16, v17
    v_exp_f32 v20, v20
    v_exp_f32 v21, v21
    v_cvt_pk_bf16_f32 v81, v18, v19
    v_mfma_f32_32x32x16_bf16 v[64:79], v[112:115], v[88:91], v[64:79]
    ds_read_b128 v[112:115], v3 offset:33792
    v_exp_f32 v22, v22
    v_exp_f32 v23, v23
    v_cvt_pk_bf16_f32 v82, v20, v21
    v_exp_f32 v24, v24
    v_exp_f32 v25, v25
    v_cvt_pk_bf16_f32 v83, v22, v23
    v_exp_f32 v26, v26
    v_exp_f32 v27, v27
    v_mfma_f32_32x32x16_bf16 v[64:79], v[116:119], v[92:95], v[64:79]
    ds_read_b128 v[116:119], v4 offset:33792
    v_cvt_pk_bf16_f32 v84, v24, v25
    v_exp_f32 v28, v28
    v_exp_f32 v29, v29
    v_cvt_pk_bf16_f32 v85, v26, v27
    v_exp_f32 v30, v30
    v_exp_f32 v31, v31
    v_cvt_pk_bf16_f32 v86, v28, v29
    v_cvt_pk_bf16_f32 v87, v30, v31
    v_mfma_f32_32x32x16_bf16 v[16:31], v[104:107], v[96:99], 0
    buffer_load_dwordx4 a[68:71], v1, s[8:11], s58 offen offset:1024 sc1
    v_exp_f32 v32, v32
    v_exp_f32 v33, v33
    v_exp_f32 v34, v34
    v_exp_f32 v35, v35
    v_cvt_pk_bf16_f32 v88, v32, v33
    v_exp_f32 v36, v36
    v_exp_f32 v37, v37
    v_cvt_pk_bf16_f32 v89, v34, v35
    v_mfma_f32_32x32x16_bf16 v[48:63], v[120:123], v[80:83], v[48:63]
    buffer_load_dwordx4 a[72:75], v1, s[8:11], s58 offen offset:2048 sc1
    v_exp_f32 v38, v38
    v_exp_f32 v39, v39
    v_cvt_pk_bf16_f32 v90, v36, v37
    v_exp_f32 v40, v40
    v_exp_f32 v41, v41
    v_cvt_pk_bf16_f32 v91, v38, v39
    v_exp_f32 v42, v42
    v_exp_f32 v43, v43
    v_mfma_f32_32x32x16_bf16 v[48:63], v[124:127], v[84:87], v[48:63]
    s_waitcnt lgkmcnt(0)
    v_cvt_pk_bf16_f32 v92, v40, v41
    v_exp_f32 v44, v44
    v_exp_f32 v45, v45
    v_cvt_pk_bf16_f32 v93, v42, v43
    v_exp_f32 v46, v46
    v_exp_f32 v47, v47
    v_cvt_pk_bf16_f32 v94, v44, v45
    v_cvt_pk_bf16_f32 v95, v46, v47
    v_add_u32 v2, 32768, v2
    v_add_u32 v3, 33792, v3
    v_add_u32 v4, 33792, v4
    v_mfma_f32_32x32x16_bf16 v[32:47], v[104:107], v[100:103], 0
    ds_read_b128 v[104:107], v2 offset:2048
    v_exp_f32 v16, v16
    v_exp_f32 v17, v17
    v_exp_f32 v18, v18
    v_exp_f32 v19, v19
    v_cvt_pk_bf16_f32 v80, v16, v17
    v_exp_f32 v20, v20
    v_exp_f32 v21, v21
    v_cvt_pk_bf16_f32 v81, v18, v19
    v_mfma_f32_32x32x16_bf16 v[64:79], v[120:123], v[88:91], v[64:79]
    ds_read_b128 v[120:123], v3 offset:1056
    v_exp_f32 v22, v22
    v_exp_f32 v23, v23
    v_cvt_pk_bf16_f32 v82, v20, v21
    v_exp_f32 v24, v24
    v_exp_f32 v25, v25
    v_cvt_pk_bf16_f32 v83, v22, v23
    v_exp_f32 v26, v26
    v_exp_f32 v27, v27
    v_mfma_f32_32x32x16_bf16 v[64:79], v[124:127], v[92:95], v[64:79]
    ds_read_b128 v[124:127], v4 offset:1056
    v_cvt_pk_bf16_f32 v84, v24, v25
    v_exp_f32 v28, v28
    v_exp_f32 v29, v29
    v_cvt_pk_bf16_f32 v85, v26, v27
    v_exp_f32 v30, v30
    v_exp_f32 v31, v31
    v_cvt_pk_bf16_f32 v86, v28, v29
    v_cvt_pk_bf16_f32 v87, v30, v31
    v_mfma_f32_32x32x16_bf16 v[16:31], v[108:111], v[96:99], 0
    buffer_load_dwordx4 a[76:79], v1, s[8:11], s58 offen offset:3072 sc1
    v_exp_f32 v32, v32
    v_exp_f32 v33, v33
    v_exp_f32 v34, v34
    v_exp_f32 v35, v35
    v_cvt_pk_bf16_f32 v88, v32, v33
    v_exp_f32 v36, v36
    v_exp_f32 v37, v37
    v_cvt_pk_bf16_f32 v89, v34, v35
    v_mfma_f32_32x32x16_bf16 v[48:63], v[112:115], v[80:83], v[48:63]
    s_add_u32 s58, s57, s17
    s_add_u32 s58, s58, 2097152
    buffer_load_dwordx4 a[80:83], v1, s[8:11], s58 offen offset:0 sc1
    v_exp_f32 v38, v38
    v_exp_f32 v39, v39
    v_cvt_pk_bf16_f32 v90, v36, v37
    v_exp_f32 v40, v40
    v_exp_f32 v41, v41
    v_cvt_pk_bf16_f32 v91, v38, v39
    v_exp_f32 v42, v42
    v_exp_f32 v43, v43
    v_mfma_f32_32x32x16_bf16 v[48:63], v[116:119], v[84:87], v[48:63]
    s_waitcnt lgkmcnt(0)
    v_cvt_pk_bf16_f32 v92, v40, v41
    v_exp_f32 v44, v44
    v_exp_f32 v45, v45
    v_cvt_pk_bf16_f32 v93, v42, v43
    v_exp_f32 v46, v46
    v_exp_f32 v47, v47
    v_cvt_pk_bf16_f32 v94, v44, v45
    v_cvt_pk_bf16_f32 v95, v46, v47
    v_mfma_f32_32x32x16_bf16 v[32:47], v[108:111], v[100:103], 0
    ds_read_b128 v[108:111], v2 offset:3072
    v_exp_f32 v16, v16
    v_exp_f32 v17, v17
    v_exp_f32 v18, v18
    v_exp_f32 v19, v19
    v_cvt_pk_bf16_f32 v80, v16, v17
    v_exp_f32 v20, v20
    v_exp_f32 v21, v21
    v_cvt_pk_bf16_f32 v81, v18, v19
    v_mfma_f32_32x32x16_bf16 v[64:79], v[112:115], v[88:91], v[64:79]
    ds_read_b128 v[112:115], v3 offset:2112
    v_exp_f32 v22, v22
    v_exp_f32 v23, v23
    v_cvt_pk_bf16_f32 v82, v20, v21
    v_exp_f32 v24, v24
    v_exp_f32 v25, v25
    v_cvt_pk_bf16_f32 v83, v22, v23
    v_exp_f32 v26, v26
    v_exp_f32 v27, v27
    v_mfma_f32_32x32x16_bf16 v[64:79], v[116:119], v[92:95], v[64:79]
    ds_read_b128 v[116:119], v4 offset:2112
    v_cvt_pk_bf16_f32 v84, v24, v25
    v_exp_f32 v28, v28
    v_exp_f32 v29, v29
    v_cvt_pk_bf16_f32 v85, v26, v27
    v_exp_f32 v30, v30
    v_exp_f32 v31, v31
    v_cvt_pk_bf16_f32 v86, v28, v29
    v_cvt_pk_bf16_f32 v87, v30, v31
    v_mfma_f32_32x32x16_bf16 v[16:31], v[104:107], v[96:99], 0
    buffer_load_dwordx4 a[84:87], v1, s[8:11], s58 offen offset:1024 sc1
    v_exp_f32 v32, v32
    v_exp_f32 v33, v33
    v_exp_f32 v34, v34
    v_exp_f32 v35, v35
    v_cvt_pk_bf16_f32 v88, v32, v33
    v_exp_f32 v36, v36
    v_exp_f32 v37, v37
    v_cvt_pk_bf16_f32 v89, v34, v35
    v_mfma_f32_32x32x16_bf16 v[48:63], v[120:123], v[80:83], v[48:63]
    buffer_load_dwordx4 a[88:91], v1, s[8:11], s58 offen offset:2048 sc1
    v_exp_f32 v38, v38
    v_exp_f32 v39, v39
    v_cvt_pk_bf16_f32 v90, v36, v37
    v_exp_f32 v40, v40
    v_exp_f32 v41, v41
    v_cvt_pk_bf16_f32 v91, v38, v39
    v_exp_f32 v42, v42
    v_exp_f32 v43, v43
    v_mfma_f32_32x32x16_bf16 v[48:63], v[124:127], v[84:87], v[48:63]
    s_waitcnt lgkmcnt(0)
    v_cvt_pk_bf16_f32 v92, v40, v41
    v_exp_f32 v44, v44
    v_exp_f32 v45, v45
    v_cvt_pk_bf16_f32 v93, v42, v43
    v_exp_f32 v46, v46
    v_exp_f32 v47, v47
    v_cvt_pk_bf16_f32 v94, v44, v45
    v_cvt_pk_bf16_f32 v95, v46, v47
    v_mfma_f32_32x32x16_bf16 v[32:47], v[104:107], v[100:103], 0
    ds_read_b128 v[104:107], v2 offset:4096
    v_exp_f32 v16, v16
    v_exp_f32 v17, v17
    v_exp_f32 v18, v18
    v_exp_f32 v19, v19
    v_cvt_pk_bf16_f32 v80, v16, v17
    v_exp_f32 v20, v20
    v_exp_f32 v21, v21
    v_cvt_pk_bf16_f32 v81, v18, v19
    v_mfma_f32_32x32x16_bf16 v[64:79], v[120:123], v[88:91], v[64:79]
    ds_read_b128 v[120:123], v3 offset:3168
    v_exp_f32 v22, v22
    v_exp_f32 v23, v23
    v_cvt_pk_bf16_f32 v82, v20, v21
    v_exp_f32 v24, v24
    v_exp_f32 v25, v25
    v_cvt_pk_bf16_f32 v83, v22, v23
    v_exp_f32 v26, v26
    v_exp_f32 v27, v27
    v_mfma_f32_32x32x16_bf16 v[64:79], v[124:127], v[92:95], v[64:79]
    ds_read_b128 v[124:127], v4 offset:3168
    v_cvt_pk_bf16_f32 v84, v24, v25
    v_exp_f32 v28, v28
    v_exp_f32 v29, v29
    v_cvt_pk_bf16_f32 v85, v26, v27
    v_exp_f32 v30, v30
    v_exp_f32 v31, v31
    v_cvt_pk_bf16_f32 v86, v28, v29
    v_cvt_pk_bf16_f32 v87, v30, v31
    v_mfma_f32_32x32x16_bf16 v[16:31], v[108:111], v[96:99], 0
    buffer_load_dwordx4 a[92:95], v1, s[8:11], s58 offen offset:3072 sc1
    v_exp_f32 v32, v32
    v_exp_f32 v33, v33
    v_exp_f32 v34, v34
    v_exp_f32 v35, v35
    v_cvt_pk_bf16_f32 v88, v32, v33
    v_exp_f32 v36, v36
    v_exp_f32 v37, v37
    v_cvt_pk_bf16_f32 v89, v34, v35
    v_mfma_f32_32x32x16_bf16 v[48:63], v[112:115], v[80:83], v[48:63]
    s_add_u32 s58, s57, s18
    s_add_u32 s58, s58, 2097152
    buffer_load_dwordx4 a[96:99], v1, s[8:11], s58 offen offset:0 sc1
    v_exp_f32 v38, v38
    v_exp_f32 v39, v39
    v_cvt_pk_bf16_f32 v90, v36, v37
    v_exp_f32 v40, v40
    v_exp_f32 v41, v41
    v_cvt_pk_bf16_f32 v91, v38, v39
    v_exp_f32 v42, v42
    v_exp_f32 v43, v43
    v_mfma_f32_32x32x16_bf16 v[48:63], v[116:119], v[84:87], v[48:63]
    s_waitcnt lgkmcnt(0)
    v_cvt_pk_bf16_f32 v92, v40, v41
    v_exp_f32 v44, v44
    v_exp_f32 v45, v45
    v_cvt_pk_bf16_f32 v93, v42, v43
    v_exp_f32 v46, v46
    v_exp_f32 v47, v47
    v_cvt_pk_bf16_f32 v94, v44, v45
    v_cvt_pk_bf16_f32 v95, v46, v47
    v_mfma_f32_32x32x16_bf16 v[32:47], v[108:111], v[100:103], 0
    ds_read_b128 v[108:111], v2 offset:5120
    v_exp_f32 v16, v16
    v_exp_f32 v17, v17
    v_exp_f32 v18, v18
    v_exp_f32 v19, v19
    v_cvt_pk_bf16_f32 v80, v16, v17
    v_exp_f32 v20, v20
    v_exp_f32 v21, v21
    v_cvt_pk_bf16_f32 v81, v18, v19
    v_mfma_f32_32x32x16_bf16 v[64:79], v[112:115], v[88:91], v[64:79]
    ds_read_b128 v[112:115], v3 offset:4224
    v_exp_f32 v22, v22
    v_exp_f32 v23, v23
    v_cvt_pk_bf16_f32 v82, v20, v21
    v_exp_f32 v24, v24
    v_exp_f32 v25, v25
    v_cvt_pk_bf16_f32 v83, v22, v23
    v_exp_f32 v26, v26
    v_exp_f32 v27, v27
    v_mfma_f32_32x32x16_bf16 v[64:79], v[116:119], v[92:95], v[64:79]
    ds_read_b128 v[116:119], v4 offset:4224
    v_cvt_pk_bf16_f32 v84, v24, v25
    v_exp_f32 v28, v28
    v_exp_f32 v29, v29
    v_cvt_pk_bf16_f32 v85, v26, v27
    v_exp_f32 v30, v30
    v_exp_f32 v31, v31
    v_cvt_pk_bf16_f32 v86, v28, v29
    v_cvt_pk_bf16_f32 v87, v30, v31
    v_mfma_f32_32x32x16_bf16 v[16:31], v[104:107], v[96:99], 0
    buffer_load_dwordx4 a[100:103], v1, s[8:11], s58 offen offset:1024 sc1
    v_exp_f32 v32, v32
    v_exp_f32 v33, v33
    v_exp_f32 v34, v34
    v_exp_f32 v35, v35
    v_cvt_pk_bf16_f32 v88, v32, v33
    v_exp_f32 v36, v36
    v_exp_f32 v37, v37
    v_cvt_pk_bf16_f32 v89, v34, v35
    v_mfma_f32_32x32x16_bf16 v[48:63], v[120:123], v[80:83], v[48:63]
    buffer_load_dwordx4 a[104:107], v1, s[8:11], s58 offen offset:2048 sc1
    v_exp_f32 v38, v38
    v_exp_f32 v39, v39
    v_cvt_pk_bf16_f32 v90, v36, v37
    v_exp_f32 v40, v40
    v_exp_f32 v41, v41
    v_cvt_pk_bf16_f32 v91, v38, v39
    v_exp_f32 v42, v42
    v_exp_f32 v43, v43
    v_mfma_f32_32x32x16_bf16 v[48:63], v[124:127], v[84:87], v[48:63]
    s_waitcnt lgkmcnt(0)
    v_cvt_pk_bf16_f32 v92, v40, v41
    v_exp_f32 v44, v44
    v_exp_f32 v45, v45
    v_cvt_pk_bf16_f32 v93, v42, v43
    v_exp_f32 v46, v46
    v_exp_f32 v47, v47
    v_cvt_pk_bf16_f32 v94, v44, v45
    v_cvt_pk_bf16_f32 v95, v46, v47
    v_mfma_f32_32x32x16_bf16 v[32:47], v[104:107], v[100:103], 0
    ds_read_b128 v[104:107], v2 offset:6144
    v_exp_f32 v16, v16
    v_exp_f32 v17, v17
    v_exp_f32 v18, v18
    v_exp_f32 v19, v19
    v_cvt_pk_bf16_f32 v80, v16, v17
    v_exp_f32 v20, v20
    v_exp_f32 v21, v21
    v_cvt_pk_bf16_f32 v81, v18, v19
    v_mfma_f32_32x32x16_bf16 v[64:79], v[120:123], v[88:91], v[64:79]
    ds_read_b128 v[120:123], v3 offset:5280
    v_exp_f32 v22, v22
    v_exp_f32 v23, v23
    v_cvt_pk_bf16_f32 v82, v20, v21
    v_exp_f32 v24, v24
    v_exp_f32 v25, v25
    v_cvt_pk_bf16_f32 v83, v22, v23
    v_exp_f32 v26, v26
    v_exp_f32 v27, v27
    v_mfma_f32_32x32x16_bf16 v[64:79], v[124:127], v[92:95], v[64:79]
    ds_read_b128 v[124:127], v4 offset:5280
    v_cvt_pk_bf16_f32 v84, v24, v25
    v_exp_f32 v28, v28
    v_exp_f32 v29, v29
    v_cvt_pk_bf16_f32 v85, v26, v27
    v_exp_f32 v30, v30
    v_exp_f32 v31, v31
    v_cvt_pk_bf16_f32 v86, v28, v29
    v_cvt_pk_bf16_f32 v87, v30, v31
    v_mfma_f32_32x32x16_bf16 v[16:31], v[108:111], v[96:99], 0
    buffer_load_dwordx4 a[108:111], v1, s[8:11], s58 offen offset:3072 sc1
    v_exp_f32 v32, v32
    v_exp_f32 v33, v33
    v_exp_f32 v34, v34
    v_exp_f32 v35, v35
    v_cvt_pk_bf16_f32 v88, v32, v33
    v_exp_f32 v36, v36
    v_exp_f32 v37, v37
    v_cvt_pk_bf16_f32 v89, v34, v35
    v_mfma_f32_32x32x16_bf16 v[48:63], v[112:115], v[80:83], v[48:63]
    s_add_u32 s58, s57, s19
    s_add_u32 s58, s58, 2097152
    buffer_load_dwordx4 a[112:115], v1, s[8:11], s58 offen offset:0 sc1
    v_exp_f32 v38, v38
    v_exp_f32 v39, v39
    v_cvt_pk_bf16_f32 v90, v36, v37
    v_exp_f32 v40, v40
    v_exp_f32 v41, v41
    v_cvt_pk_bf16_f32 v91, v38, v39
    v_exp_f32 v42, v42
    v_exp_f32 v43, v43
    v_mfma_f32_32x32x16_bf16 v[48:63], v[116:119], v[84:87], v[48:63]
    s_waitcnt lgkmcnt(0)
    v_cvt_pk_bf16_f32 v92, v40, v41
    v_exp_f32 v44, v44
    v_exp_f32 v45, v45
    v_cvt_pk_bf16_f32 v93, v42, v43
    v_exp_f32 v46, v46
    v_exp_f32 v47, v47
    v_cvt_pk_bf16_f32 v94, v44, v45
    v_cvt_pk_bf16_f32 v95, v46, v47
    v_mfma_f32_32x32x16_bf16 v[32:47], v[108:111], v[100:103], 0
    ds_read_b128 v[108:111], v2 offset:7168
    v_exp_f32 v16, v16
    v_exp_f32 v17, v17
    v_exp_f32 v18, v18
    v_exp_f32 v19, v19
    v_cvt_pk_bf16_f32 v80, v16, v17
    v_exp_f32 v20, v20
    v_exp_f32 v21, v21
    v_cvt_pk_bf16_f32 v81, v18, v19
    v_mfma_f32_32x32x16_bf16 v[64:79], v[112:115], v[88:91], v[64:79]
    ds_read_b128 v[112:115], v3 offset:6336
    v_exp_f32 v22, v22
    v_exp_f32 v23, v23
    v_cvt_pk_bf16_f32 v82, v20, v21
    v_exp_f32 v24, v24
    v_exp_f32 v25, v25
    v_cvt_pk_bf16_f32 v83, v22, v23
    v_exp_f32 v26, v26
    v_exp_f32 v27, v27
    v_mfma_f32_32x32x16_bf16 v[64:79], v[116:119], v[92:95], v[64:79]
    ds_read_b128 v[116:119], v4 offset:6336
    v_cvt_pk_bf16_f32 v84, v24, v25
    v_exp_f32 v28, v28
    v_exp_f32 v29, v29
    v_cvt_pk_bf16_f32 v85, v26, v27
    v_exp_f32 v30, v30
    v_exp_f32 v31, v31
    v_cvt_pk_bf16_f32 v86, v28, v29
    v_cvt_pk_bf16_f32 v87, v30, v31
    v_mfma_f32_32x32x16_bf16 v[16:31], v[104:107], v[96:99], 0
    buffer_load_dwordx4 a[116:119], v1, s[8:11], s58 offen offset:1024 sc1
    v_exp_f32 v32, v32
    v_exp_f32 v33, v33
    v_exp_f32 v34, v34
    v_exp_f32 v35, v35
    v_cvt_pk_bf16_f32 v88, v32, v33
    v_exp_f32 v36, v36
    v_exp_f32 v37, v37
    v_cvt_pk_bf16_f32 v89, v34, v35
    v_mfma_f32_32x32x16_bf16 v[48:63], v[120:123], v[80:83], v[48:63]
    buffer_load_dwordx4 a[120:123], v1, s[8:11], s58 offen offset:2048 sc1
    v_exp_f32 v38, v38
    v_exp_f32 v39, v39
    v_cvt_pk_bf16_f32 v90, v36, v37
    v_exp_f32 v40, v40
    v_exp_f32 v41, v41
    v_cvt_pk_bf16_f32 v91, v38, v39
    v_exp_f32 v42, v42
    v_exp_f32 v43, v43
    v_mfma_f32_32x32x16_bf16 v[48:63], v[124:127], v[84:87], v[48:63]
    s_waitcnt lgkmcnt(0)
    v_cvt_pk_bf16_f32 v92, v40, v41
    v_exp_f32 v44, v44
    v_exp_f32 v45, v45
    v_cvt_pk_bf16_f32 v93, v42, v43
    v_exp_f32 v46, v46
    v_exp_f32 v47, v47
    v_cvt_pk_bf16_f32 v94, v44, v45
    v_cvt_pk_bf16_f32 v95, v46, v47
    v_mfma_f32_32x32x16_bf16 v[32:47], v[104:107], v[100:103], 0
    ds_read_b128 v[104:107], v2 offset:8192
    v_exp_f32 v16, v16
    v_exp_f32 v17, v17
    v_exp_f32 v18, v18
    v_exp_f32 v19, v19
    v_cvt_pk_bf16_f32 v80, v16, v17
    v_exp_f32 v20, v20
    v_exp_f32 v21, v21
    v_cvt_pk_bf16_f32 v81, v18, v19
    v_mfma_f32_32x32x16_bf16 v[64:79], v[120:123], v[88:91], v[64:79]
    ds_read_b128 v[120:123], v3 offset:7392
    v_exp_f32 v22, v22
    v_exp_f32 v23, v23
    v_cvt_pk_bf16_f32 v82, v20, v21
    v_exp_f32 v24, v24
    v_exp_f32 v25, v25
    v_cvt_pk_bf16_f32 v83, v22, v23
    v_exp_f32 v26, v26
    v_exp_f32 v27, v27
    v_mfma_f32_32x32x16_bf16 v[64:79], v[124:127], v[92:95], v[64:79]
    ds_read_b128 v[124:127], v4 offset:7392
    v_cvt_pk_bf16_f32 v84, v24, v25
    v_exp_f32 v28, v28
    v_exp_f32 v29, v29
    v_cvt_pk_bf16_f32 v85, v26, v27
    v_exp_f32 v30, v30
    v_exp_f32 v31, v31
    v_cvt_pk_bf16_f32 v86, v28, v29
    v_cvt_pk_bf16_f32 v87, v30, v31
    v_mfma_f32_32x32x16_bf16 v[16:31], v[108:111], v[96:99], 0
    buffer_load_dwordx4 a[124:127], v1, s[8:11], s58 offen offset:3072 sc1
    v_exp_f32 v32, v32
    v_exp_f32 v33, v33
    v_exp_f32 v34, v34
    v_exp_f32 v35, v35
    v_cvt_pk_bf16_f32 v88, v32, v33
    v_exp_f32 v36, v36
    v_exp_f32 v37, v37
    v_cvt_pk_bf16_f32 v89, v34, v35
    v_mfma_f32_32x32x16_bf16 v[48:63], v[112:115], v[80:83], v[48:63]
    s_add_u32 s58, s57, s16
    s_add_u32 s58, s58, 2621440
    buffer_load_dwordx4 a[128:131], v1, s[8:11], s58 offen offset:0 sc1
    v_exp_f32 v38, v38
    v_exp_f32 v39, v39
    v_cvt_pk_bf16_f32 v90, v36, v37
    v_exp_f32 v40, v40
    v_exp_f32 v41, v41
    v_cvt_pk_bf16_f32 v91, v38, v39
    v_exp_f32 v42, v42
    v_exp_f32 v43, v43
    v_mfma_f32_32x32x16_bf16 v[48:63], v[116:119], v[84:87], v[48:63]
    s_waitcnt lgkmcnt(0)
    v_cvt_pk_bf16_f32 v92, v40, v41
    v_exp_f32 v44, v44
    v_exp_f32 v45, v45
    v_cvt_pk_bf16_f32 v93, v42, v43
    v_exp_f32 v46, v46
    v_exp_f32 v47, v47
    v_cvt_pk_bf16_f32 v94, v44, v45
    v_cvt_pk_bf16_f32 v95, v46, v47
    v_mfma_f32_32x32x16_bf16 v[32:47], v[108:111], v[100:103], 0
    ds_read_b128 v[108:111], v2 offset:9216
    v_exp_f32 v16, v16
    v_exp_f32 v17, v17
    v_exp_f32 v18, v18
    v_exp_f32 v19, v19
    v_cvt_pk_bf16_f32 v80, v16, v17
    v_exp_f32 v20, v20
    v_exp_f32 v21, v21
    v_cvt_pk_bf16_f32 v81, v18, v19
    v_mfma_f32_32x32x16_bf16 v[64:79], v[112:115], v[88:91], v[64:79]
    ds_read_b128 v[112:115], v3 offset:8448
    v_exp_f32 v22, v22
    v_exp_f32 v23, v23
    v_cvt_pk_bf16_f32 v82, v20, v21
    v_exp_f32 v24, v24
    v_exp_f32 v25, v25
    v_cvt_pk_bf16_f32 v83, v22, v23
    v_exp_f32 v26, v26
    v_exp_f32 v27, v27
    v_mfma_f32_32x32x16_bf16 v[64:79], v[116:119], v[92:95], v[64:79]
    ds_read_b128 v[116:119], v4 offset:8448
    v_cvt_pk_bf16_f32 v84, v24, v25
    v_exp_f32 v28, v28
    v_exp_f32 v29, v29
    v_cvt_pk_bf16_f32 v85, v26, v27
    v_exp_f32 v30, v30
    v_exp_f32 v31, v31
    v_cvt_pk_bf16_f32 v86, v28, v29
    v_cvt_pk_bf16_f32 v87, v30, v31
    v_mfma_f32_32x32x16_bf16 v[16:31], v[104:107], v[96:99], 0
    buffer_load_dwordx4 a[132:135], v1, s[8:11], s58 offen offset:1024 sc1
    v_exp_f32 v32, v32
    v_exp_f32 v33, v33
    v_exp_f32 v34, v34
    v_exp_f32 v35, v35
    v_cvt_pk_bf16_f32 v88, v32, v33
    v_exp_f32 v36, v36
    v_exp_f32 v37, v37
    v_cvt_pk_bf16_f32 v89, v34, v35
    v_mfma_f32_32x32x16_bf16 v[48:63], v[120:123], v[80:83], v[48:63]
    buffer_load_dwordx4 a[136:139], v1, s[8:11], s58 offen offset:2048 sc1
    v_exp_f32 v38, v38
    v_exp_f32 v39, v39
    v_cvt_pk_bf16_f32 v90, v36, v37
    v_exp_f32 v40, v40
    v_exp_f32 v41, v41
    v_cvt_pk_bf16_f32 v91, v38, v39
    v_exp_f32 v42, v42
    v_exp_f32 v43, v43
    v_mfma_f32_32x32x16_bf16 v[48:63], v[124:127], v[84:87], v[48:63]
    s_waitcnt lgkmcnt(0)
    v_cvt_pk_bf16_f32 v92, v40, v41
    v_exp_f32 v44, v44
    v_exp_f32 v45, v45
    v_cvt_pk_bf16_f32 v93, v42, v43
    v_exp_f32 v46, v46
    v_exp_f32 v47, v47
    v_cvt_pk_bf16_f32 v94, v44, v45
    v_cvt_pk_bf16_f32 v95, v46, v47
    v_mfma_f32_32x32x16_bf16 v[32:47], v[104:107], v[100:103], 0
    ds_read_b128 v[104:107], v2 offset:10240
    v_exp_f32 v16, v16
    v_exp_f32 v17, v17
    v_exp_f32 v18, v18
    v_exp_f32 v19, v19
    v_cvt_pk_bf16_f32 v80, v16, v17
    v_exp_f32 v20, v20
    v_exp_f32 v21, v21
    v_cvt_pk_bf16_f32 v81, v18, v19
    v_mfma_f32_32x32x16_bf16 v[64:79], v[120:123], v[88:91], v[64:79]
    ds_read_b128 v[120:123], v3 offset:9504
    v_exp_f32 v22, v22
    v_exp_f32 v23, v23
    v_cvt_pk_bf16_f32 v82, v20, v21
    v_exp_f32 v24, v24
    v_exp_f32 v25, v25
    v_cvt_pk_bf16_f32 v83, v22, v23
    v_exp_f32 v26, v26
    v_exp_f32 v27, v27
    v_mfma_f32_32x32x16_bf16 v[64:79], v[124:127], v[92:95], v[64:79]
    ds_read_b128 v[124:127], v4 offset:9504
    v_cvt_pk_bf16_f32 v84, v24, v25
    v_exp_f32 v28, v28
    v_exp_f32 v29, v29
    v_cvt_pk_bf16_f32 v85, v26, v27
    v_exp_f32 v30, v30
    v_exp_f32 v31, v31
    v_cvt_pk_bf16_f32 v86, v28, v29
    v_cvt_pk_bf16_f32 v87, v30, v31
    v_mfma_f32_32x32x16_bf16 v[16:31], v[108:111], v[96:99], 0
    buffer_load_dwordx4 a[140:143], v1, s[8:11], s58 offen offset:3072 sc1
    v_exp_f32 v32, v32
    v_exp_f32 v33, v33
    v_exp_f32 v34, v34
    v_exp_f32 v35, v35
    v_cvt_pk_bf16_f32 v88, v32, v33
    v_exp_f32 v36, v36
    v_exp_f32 v37, v37
    v_cvt_pk_bf16_f32 v89, v34, v35
    v_mfma_f32_32x32x16_bf16 v[48:63], v[112:115], v[80:83], v[48:63]
    s_add_u32 s58, s57, s17
    s_add_u32 s58, s58, 2621440
    buffer_load_dwordx4 a[144:147], v1, s[8:11], s58 offen offset:0 sc1
    v_exp_f32 v38, v38
    v_exp_f32 v39, v39
    v_cvt_pk_bf16_f32 v90, v36, v37
    v_exp_f32 v40, v40
    v_exp_f32 v41, v41
    v_cvt_pk_bf16_f32 v91, v38, v39
    v_exp_f32 v42, v42
    v_exp_f32 v43, v43
    v_mfma_f32_32x32x16_bf16 v[48:63], v[116:119], v[84:87], v[48:63]
    s_waitcnt lgkmcnt(0)
    v_cvt_pk_bf16_f32 v92, v40, v41
    v_exp_f32 v44, v44
    v_exp_f32 v45, v45
    v_cvt_pk_bf16_f32 v93, v42, v43
    v_exp_f32 v46, v46
    v_exp_f32 v47, v47
    v_cvt_pk_bf16_f32 v94, v44, v45
    v_cvt_pk_bf16_f32 v95, v46, v47
    v_mfma_f32_32x32x16_bf16 v[32:47], v[108:111], v[100:103], 0
    ds_read_b128 v[108:111], v2 offset:11264
    v_exp_f32 v16, v16
    v_exp_f32 v17, v17
    v_exp_f32 v18, v18
    v_exp_f32 v19, v19
    v_cvt_pk_bf16_f32 v80, v16, v17
    v_exp_f32 v20, v20
    v_exp_f32 v21, v21
    v_cvt_pk_bf16_f32 v81, v18, v19
    v_mfma_f32_32x32x16_bf16 v[64:79], v[112:115], v[88:91], v[64:79]
    ds_read_b128 v[112:115], v3 offset:10560
    v_exp_f32 v22, v22
    v_exp_f32 v23, v23
    v_cvt_pk_bf16_f32 v82, v20, v21
    v_exp_f32 v24, v24
    v_exp_f32 v25, v25
    v_cvt_pk_bf16_f32 v83, v22, v23
    v_exp_f32 v26, v26
    v_exp_f32 v27, v27
    v_mfma_f32_32x32x16_bf16 v[64:79], v[116:119], v[92:95], v[64:79]
    ds_read_b128 v[116:119], v4 offset:10560
    v_cvt_pk_bf16_f32 v84, v24, v25
    v_exp_f32 v28, v28
    v_exp_f32 v29, v29
    v_cvt_pk_bf16_f32 v85, v26, v27
    v_exp_f32 v30, v30
    v_exp_f32 v31, v31
    v_cvt_pk_bf16_f32 v86, v28, v29
    v_cvt_pk_bf16_f32 v87, v30, v31
    v_mfma_f32_32x32x16_bf16 v[16:31], v[104:107], v[96:99], 0
    buffer_load_dwordx4 a[148:151], v1, s[8:11], s58 offen offset:1024 sc1
    v_exp_f32 v32, v32
    v_exp_f32 v33, v33
    v_exp_f32 v34, v34
    v_exp_f32 v35, v35
    v_cvt_pk_bf16_f32 v88, v32, v33
    v_exp_f32 v36, v36
    v_exp_f32 v37, v37
    v_cvt_pk_bf16_f32 v89, v34, v35
    v_mfma_f32_32x32x16_bf16 v[48:63], v[120:123], v[80:83], v[48:63]
    buffer_load_dwordx4 a[152:155], v1, s[8:11], s58 offen offset:2048 sc1
    v_exp_f32 v38, v38
    v_exp_f32 v39, v39
    v_cvt_pk_bf16_f32 v90, v36, v37
    v_exp_f32 v40, v40
    v_exp_f32 v41, v41
    v_cvt_pk_bf16_f32 v91, v38, v39
    v_exp_f32 v42, v42
    v_exp_f32 v43, v43
    v_mfma_f32_32x32x16_bf16 v[48:63], v[124:127], v[84:87], v[48:63]
    s_waitcnt lgkmcnt(0)
    v_cvt_pk_bf16_f32 v92, v40, v41
    v_exp_f32 v44, v44
    v_exp_f32 v45, v45
    v_cvt_pk_bf16_f32 v93, v42, v43
    v_exp_f32 v46, v46
    v_exp_f32 v47, v47
    v_cvt_pk_bf16_f32 v94, v44, v45
    v_cvt_pk_bf16_f32 v95, v46, v47
    v_mfma_f32_32x32x16_bf16 v[32:47], v[104:107], v[100:103], 0
    ds_read_b128 v[104:107], v2 offset:12288
    v_exp_f32 v16, v16
    v_exp_f32 v17, v17
    v_exp_f32 v18, v18
    v_exp_f32 v19, v19
    v_cvt_pk_bf16_f32 v80, v16, v17
    v_exp_f32 v20, v20
    v_exp_f32 v21, v21
    v_cvt_pk_bf16_f32 v81, v18, v19
    v_mfma_f32_32x32x16_bf16 v[64:79], v[120:123], v[88:91], v[64:79]
    ds_read_b128 v[120:123], v3 offset:11616
    v_exp_f32 v22, v22
    v_exp_f32 v23, v23
    v_cvt_pk_bf16_f32 v82, v20, v21
    v_exp_f32 v24, v24
    v_exp_f32 v25, v25
    v_cvt_pk_bf16_f32 v83, v22, v23
    v_exp_f32 v26, v26
    v_exp_f32 v27, v27
    v_mfma_f32_32x32x16_bf16 v[64:79], v[124:127], v[92:95], v[64:79]
    ds_read_b128 v[124:127], v4 offset:11616
    v_cvt_pk_bf16_f32 v84, v24, v25
    v_exp_f32 v28, v28
    v_exp_f32 v29, v29
    v_cvt_pk_bf16_f32 v85, v26, v27
    v_exp_f32 v30, v30
    v_exp_f32 v31, v31
    v_cvt_pk_bf16_f32 v86, v28, v29
    v_cvt_pk_bf16_f32 v87, v30, v31
    v_mfma_f32_32x32x16_bf16 v[16:31], v[108:111], v[96:99], 0
    buffer_load_dwordx4 a[156:159], v1, s[8:11], s58 offen offset:3072 sc1
    v_exp_f32 v32, v32
    v_exp_f32 v33, v33
    v_exp_f32 v34, v34
    v_exp_f32 v35, v35
    v_cvt_pk_bf16_f32 v88, v32, v33
    v_exp_f32 v36, v36
    v_exp_f32 v37, v37
    v_cvt_pk_bf16_f32 v89, v34, v35
    v_mfma_f32_32x32x16_bf16 v[48:63], v[112:115], v[80:83], v[48:63]
    s_add_u32 s58, s57, s18
    s_add_u32 s58, s58, 2621440
    buffer_load_dwordx4 a[160:163], v1, s[8:11], s58 offen offset:0 sc1
    v_exp_f32 v38, v38
    v_exp_f32 v39, v39
    v_cvt_pk_bf16_f32 v90, v36, v37
    v_exp_f32 v40, v40
    v_exp_f32 v41, v41
    v_cvt_pk_bf16_f32 v91, v38, v39
    v_exp_f32 v42, v42
    v_exp_f32 v43, v43
    v_mfma_f32_32x32x16_bf16 v[48:63], v[116:119], v[84:87], v[48:63]
    s_waitcnt lgkmcnt(0)
    v_cvt_pk_bf16_f32 v92, v40, v41
    v_exp_f32 v44, v44
    v_exp_f32 v45, v45
    v_cvt_pk_bf16_f32 v93, v42, v43
    v_exp_f32 v46, v46
    v_exp_f32 v47, v47
    v_cvt_pk_bf16_f32 v94, v44, v45
    v_cvt_pk_bf16_f32 v95, v46, v47
    v_mfma_f32_32x32x16_bf16 v[32:47], v[108:111], v[100:103], 0
    ds_read_b128 v[108:111], v2 offset:13312
    v_exp_f32 v16, v16
    v_exp_f32 v17, v17
    v_exp_f32 v18, v18
    v_exp_f32 v19, v19
    v_cvt_pk_bf16_f32 v80, v16, v17
    v_exp_f32 v20, v20
    v_exp_f32 v21, v21
    v_cvt_pk_bf16_f32 v81, v18, v19
    v_mfma_f32_32x32x16_bf16 v[64:79], v[112:115], v[88:91], v[64:79]
    ds_read_b128 v[112:115], v3 offset:12672
    v_exp_f32 v22, v22
    v_exp_f32 v23, v23
    v_cvt_pk_bf16_f32 v82, v20, v21
    v_exp_f32 v24, v24
    v_exp_f32 v25, v25
    v_cvt_pk_bf16_f32 v83, v22, v23
    v_exp_f32 v26, v26
    v_exp_f32 v27, v27
    v_mfma_f32_32x32x16_bf16 v[64:79], v[116:119], v[92:95], v[64:79]
    ds_read_b128 v[116:119], v4 offset:12672
    v_cvt_pk_bf16_f32 v84, v24, v25
    v_exp_f32 v28, v28
    v_exp_f32 v29, v29
    v_cvt_pk_bf16_f32 v85, v26, v27
    v_exp_f32 v30, v30
    v_exp_f32 v31, v31
    v_cvt_pk_bf16_f32 v86, v28, v29
    v_cvt_pk_bf16_f32 v87, v30, v31
    v_mfma_f32_32x32x16_bf16 v[16:31], v[104:107], v[96:99], 0
    buffer_load_dwordx4 a[164:167], v1, s[8:11], s58 offen offset:1024 sc1
    v_exp_f32 v32, v32
    v_exp_f32 v33, v33
    v_exp_f32 v34, v34
    v_exp_f32 v35, v35
    v_cvt_pk_bf16_f32 v88, v32, v33
    v_exp_f32 v36, v36
    v_exp_f32 v37, v37
    v_cvt_pk_bf16_f32 v89, v34, v35
    v_mfma_f32_32x32x16_bf16 v[48:63], v[120:123], v[80:83], v[48:63]
    buffer_load_dwordx4 a[168:171], v1, s[8:11], s58 offen offset:2048 sc1
    v_exp_f32 v38, v38
    v_exp_f32 v39, v39
    v_cvt_pk_bf16_f32 v90, v36, v37
    v_exp_f32 v40, v40
    v_exp_f32 v41, v41
    v_cvt_pk_bf16_f32 v91, v38, v39
    v_exp_f32 v42, v42
    v_exp_f32 v43, v43
    v_mfma_f32_32x32x16_bf16 v[48:63], v[124:127], v[84:87], v[48:63]
    s_waitcnt lgkmcnt(0)
    v_cvt_pk_bf16_f32 v92, v40, v41
    v_exp_f32 v44, v44
    v_exp_f32 v45, v45
    v_cvt_pk_bf16_f32 v93, v42, v43
    v_exp_f32 v46, v46
    v_exp_f32 v47, v47
    v_cvt_pk_bf16_f32 v94, v44, v45
    v_cvt_pk_bf16_f32 v95, v46, v47
    v_mfma_f32_32x32x16_bf16 v[32:47], v[104:107], v[100:103], 0
    ds_read_b128 v[104:107], v2 offset:14336
    v_exp_f32 v16, v16
    v_exp_f32 v17, v17
    v_exp_f32 v18, v18
    v_exp_f32 v19, v19
    v_cvt_pk_bf16_f32 v80, v16, v17
    v_exp_f32 v20, v20
    v_exp_f32 v21, v21
    v_cvt_pk_bf16_f32 v81, v18, v19
    v_mfma_f32_32x32x16_bf16 v[64:79], v[120:123], v[88:91], v[64:79]
    ds_read_b128 v[120:123], v3 offset:13728
    v_exp_f32 v22, v22
    v_exp_f32 v23, v23
    v_cvt_pk_bf16_f32 v82, v20, v21
    v_exp_f32 v24, v24
    v_exp_f32 v25, v25
    v_cvt_pk_bf16_f32 v83, v22, v23
    v_exp_f32 v26, v26
    v_exp_f32 v27, v27
    v_mfma_f32_32x32x16_bf16 v[64:79], v[124:127], v[92:95], v[64:79]
    ds_read_b128 v[124:127], v4 offset:13728
    v_cvt_pk_bf16_f32 v84, v24, v25
    v_exp_f32 v28, v28
    v_exp_f32 v29, v29
    v_cvt_pk_bf16_f32 v85, v26, v27
    v_exp_f32 v30, v30
    v_exp_f32 v31, v31
    v_cvt_pk_bf16_f32 v86, v28, v29
    v_cvt_pk_bf16_f32 v87, v30, v31
    v_mfma_f32_32x32x16_bf16 v[16:31], v[108:111], v[96:99], 0
    buffer_load_dwordx4 a[172:175], v1, s[8:11], s58 offen offset:3072 sc1
    v_exp_f32 v32, v32
    v_exp_f32 v33, v33
    v_exp_f32 v34, v34
    v_exp_f32 v35, v35
    v_cvt_pk_bf16_f32 v88, v32, v33
    v_exp_f32 v36, v36
    v_exp_f32 v37, v37
    v_cvt_pk_bf16_f32 v89, v34, v35
    v_mfma_f32_32x32x16_bf16 v[48:63], v[112:115], v[80:83], v[48:63]
    s_add_u32 s58, s57, s19
    s_add_u32 s58, s58, 2621440
    buffer_load_dwordx4 a[176:179], v1, s[8:11], s58 offen offset:0 sc1
    v_exp_f32 v38, v38
    v_exp_f32 v39, v39
    v_cvt_pk_bf16_f32 v90, v36, v37
    v_exp_f32 v40, v40
    v_exp_f32 v41, v41
    v_cvt_pk_bf16_f32 v91, v38, v39
    v_exp_f32 v42, v42
    v_exp_f32 v43, v43
    v_mfma_f32_32x32x16_bf16 v[48:63], v[116:119], v[84:87], v[48:63]
    s_waitcnt lgkmcnt(0)
    v_cvt_pk_bf16_f32 v92, v40, v41
    v_exp_f32 v44, v44
    v_exp_f32 v45, v45
    v_cvt_pk_bf16_f32 v93, v42, v43
    v_exp_f32 v46, v46
    v_exp_f32 v47, v47
    v_cvt_pk_bf16_f32 v94, v44, v45
    v_cvt_pk_bf16_f32 v95, v46, v47
    v_mfma_f32_32x32x16_bf16 v[32:47], v[108:111], v[100:103], 0
    ds_read_b128 v[108:111], v2 offset:15360
    v_exp_f32 v16, v16
    v_exp_f32 v17, v17
    v_exp_f32 v18, v18
    v_exp_f32 v19, v19
    v_cvt_pk_bf16_f32 v80, v16, v17
    v_exp_f32 v20, v20
    v_exp_f32 v21, v21
    v_cvt_pk_bf16_f32 v81, v18, v19
    v_mfma_f32_32x32x16_bf16 v[64:79], v[112:115], v[88:91], v[64:79]
    ds_read_b128 v[112:115], v3 offset:14784
    v_exp_f32 v22, v22
    v_exp_f32 v23, v23
    v_cvt_pk_bf16_f32 v82, v20, v21
    v_exp_f32 v24, v24
    v_exp_f32 v25, v25
    v_cvt_pk_bf16_f32 v83, v22, v23
    v_exp_f32 v26, v26
    v_exp_f32 v27, v27
    v_mfma_f32_32x32x16_bf16 v[64:79], v[116:119], v[92:95], v[64:79]
    ds_read_b128 v[116:119], v4 offset:14784
    v_cvt_pk_bf16_f32 v84, v24, v25
    v_exp_f32 v28, v28
    v_exp_f32 v29, v29
    v_cvt_pk_bf16_f32 v85, v26, v27
    v_exp_f32 v30, v30
    v_exp_f32 v31, v31
    v_cvt_pk_bf16_f32 v86, v28, v29
    v_cvt_pk_bf16_f32 v87, v30, v31
    v_mfma_f32_32x32x16_bf16 v[16:31], v[104:107], v[96:99], 0
    buffer_load_dwordx4 a[180:183], v1, s[8:11], s58 offen offset:1024 sc1
    v_exp_f32 v32, v32
    v_exp_f32 v33, v33
    v_exp_f32 v34, v34
    v_exp_f32 v35, v35
    v_cvt_pk_bf16_f32 v88, v32, v33
    v_exp_f32 v36, v36
    v_exp_f32 v37, v37
    v_cvt_pk_bf16_f32 v89, v34, v35
    v_mfma_f32_32x32x16_bf16 v[48:63], v[120:123], v[80:83], v[48:63]
    buffer_load_dwordx4 a[184:187], v1, s[8:11], s58 offen offset:2048 sc1
    v_exp_f32 v38, v38
    v_exp_f32 v39, v39
    v_cvt_pk_bf16_f32 v90, v36, v37
    v_exp_f32 v40, v40
    v_exp_f32 v41, v41
    v_cvt_pk_bf16_f32 v91, v38, v39
    v_exp_f32 v42, v42
    v_exp_f32 v43, v43
    v_mfma_f32_32x32x16_bf16 v[48:63], v[124:127], v[84:87], v[48:63]
    s_waitcnt lgkmcnt(0)
    v_cvt_pk_bf16_f32 v92, v40, v41
    v_exp_f32 v44, v44
    v_exp_f32 v45, v45
    v_cvt_pk_bf16_f32 v93, v42, v43
    v_exp_f32 v46, v46
    v_exp_f32 v47, v47
    v_cvt_pk_bf16_f32 v94, v44, v45
    v_cvt_pk_bf16_f32 v95, v46, v47
    v_mfma_f32_32x32x16_bf16 v[32:47], v[104:107], v[100:103], 0
    ds_read_b128 v[104:107], v2 offset:16384
    v_exp_f32 v16, v16
    v_exp_f32 v17, v17
    v_exp_f32 v18, v18
    v_exp_f32 v19, v19
    v_cvt_pk_bf16_f32 v80, v16, v17
    v_exp_f32 v20, v20
    v_exp_f32 v21, v21
    v_cvt_pk_bf16_f32 v81, v18, v19
    v_mfma_f32_32x32x16_bf16 v[64:79], v[120:123], v[88:91], v[64:79]
    ds_read_b128 v[120:123], v3 offset:15840
    v_exp_f32 v22, v22
    v_exp_f32 v23, v23
    v_cvt_pk_bf16_f32 v82, v20, v21
    v_exp_f32 v24, v24
    v_exp_f32 v25, v25
    v_cvt_pk_bf16_f32 v83, v22, v23
    v_exp_f32 v26, v26
    v_exp_f32 v27, v27
    v_mfma_f32_32x32x16_bf16 v[64:79], v[124:127], v[92:95], v[64:79]
    ds_read_b128 v[124:127], v4 offset:15840
    v_cvt_pk_bf16_f32 v84, v24, v25
    v_exp_f32 v28, v28
    v_exp_f32 v29, v29
    v_cvt_pk_bf16_f32 v85, v26, v27
    v_exp_f32 v30, v30
    v_exp_f32 v31, v31
    v_cvt_pk_bf16_f32 v86, v28, v29
    v_cvt_pk_bf16_f32 v87, v30, v31
    v_mfma_f32_32x32x16_bf16 v[16:31], v[108:111], v[96:99], 0
    buffer_load_dwordx4 a[188:191], v1, s[8:11], s58 offen offset:3072 sc1
    v_exp_f32 v32, v32
    v_exp_f32 v33, v33
    v_exp_f32 v34, v34
    v_exp_f32 v35, v35
    v_cvt_pk_bf16_f32 v88, v32, v33
    v_exp_f32 v36, v36
    v_exp_f32 v37, v37
    v_cvt_pk_bf16_f32 v89, v34, v35
    v_mfma_f32_32x32x16_bf16 v[48:63], v[112:115], v[80:83], v[48:63]
    v_and_b32 v13, 7, v0
    s_add_u32 s28, s20, 1
    s_min_u32 s28, s28, 31
    s_sub_u32 s28, s28, s20
    s_lshl_b32 s28, s28, 3
    v_bfe_u32 v14, v0, 3, 1
    v_mul_lo_u32 v14, v14, s28
    v_add_u32 v13, v13, v14
    s_lshl_b32 s28, s20, 3
    v_add_u32 v13, s28, v13
    v_lshlrev_b32 v13, 3, v13
    s_mov_b32 s38, 26312704
    v_exp_f32 v38, v38
    v_exp_f32 v39, v39
    v_cvt_pk_bf16_f32 v90, v36, v37
    v_exp_f32 v40, v40
    v_exp_f32 v41, v41
    v_cvt_pk_bf16_f32 v91, v38, v39
    v_exp_f32 v42, v42
    v_exp_f32 v43, v43
    v_mfma_f32_32x32x16_bf16 v[48:63], v[116:119], v[84:87], v[48:63]
    s_waitcnt lgkmcnt(0)
    v_cvt_pk_bf16_f32 v92, v40, v41
    v_exp_f32 v44, v44
    v_exp_f32 v45, v45
    v_cvt_pk_bf16_f32 v93, v42, v43
    v_exp_f32 v46, v46
    v_exp_f32 v47, v47
    v_cvt_pk_bf16_f32 v94, v44, v45
    v_cvt_pk_bf16_f32 v95, v46, v47
    v_mfma_f32_32x32x16_bf16 v[32:47], v[108:111], v[100:103], 0
    ds_read_b128 v[108:111], v2 offset:17408
    v_exp_f32 v16, v16
    v_exp_f32 v17, v17
    v_exp_f32 v18, v18
    v_exp_f32 v19, v19
    v_cvt_pk_bf16_f32 v80, v16, v17
    v_exp_f32 v20, v20
    v_exp_f32 v21, v21
    v_cvt_pk_bf16_f32 v81, v18, v19
    v_mfma_f32_32x32x16_bf16 v[64:79], v[112:115], v[88:91], v[64:79]
    ds_read_b128 v[112:115], v3 offset:16896
    v_exp_f32 v22, v22
    v_exp_f32 v23, v23
    v_cvt_pk_bf16_f32 v82, v20, v21
    v_exp_f32 v24, v24
    v_exp_f32 v25, v25
    v_cvt_pk_bf16_f32 v83, v22, v23
    v_exp_f32 v26, v26
    v_exp_f32 v27, v27
    v_mfma_f32_32x32x16_bf16 v[64:79], v[116:119], v[92:95], v[64:79]
    ds_read_b128 v[116:119], v4 offset:16896
    v_cvt_pk_bf16_f32 v84, v24, v25
    v_exp_f32 v28, v28
    v_exp_f32 v29, v29
    v_cvt_pk_bf16_f32 v85, v26, v27
    v_exp_f32 v30, v30
    v_exp_f32 v31, v31
    v_cvt_pk_bf16_f32 v86, v28, v29
    v_cvt_pk_bf16_f32 v87, v30, v31
    v_mfma_f32_32x32x16_bf16 v[16:31], v[104:107], v[96:99], 0
    buffer_load_dwordx2 v[14:15], v13, s[8:11], s38 offen sc1
    v_exp_f32 v32, v32
    v_exp_f32 v33, v33
    v_exp_f32 v34, v34
    v_exp_f32 v35, v35
    v_cvt_pk_bf16_f32 v88, v32, v33
    v_exp_f32 v36, v36
    v_exp_f32 v37, v37
    v_cvt_pk_bf16_f32 v89, v34, v35
    v_mfma_f32_32x32x16_bf16 v[48:63], v[120:123], v[80:83], v[48:63]
    v_exp_f32 v38, v38
    v_exp_f32 v39, v39
    v_cvt_pk_bf16_f32 v90, v36, v37
    v_exp_f32 v40, v40
    v_exp_f32 v41, v41
    v_cvt_pk_bf16_f32 v91, v38, v39
    v_exp_f32 v42, v42
    v_exp_f32 v43, v43
    v_mfma_f32_32x32x16_bf16 v[48:63], v[124:127], v[84:87], v[48:63]
    s_waitcnt lgkmcnt(0)
    v_cvt_pk_bf16_f32 v92, v40, v41
    v_exp_f32 v44, v44
    v_exp_f32 v45, v45
    v_cvt_pk_bf16_f32 v93, v42, v43
    v_exp_f32 v46, v46
    v_exp_f32 v47, v47
    v_cvt_pk_bf16_f32 v94, v44, v45
    v_cvt_pk_bf16_f32 v95, v46, v47
    v_mfma_f32_32x32x16_bf16 v[32:47], v[104:107], v[100:103], 0
    ds_read_b128 v[104:107], v2 offset:18432
    v_exp_f32 v16, v16
    v_exp_f32 v17, v17
    v_exp_f32 v18, v18
    v_exp_f32 v19, v19
    v_cvt_pk_bf16_f32 v80, v16, v17
    v_exp_f32 v20, v20
    v_exp_f32 v21, v21
    v_cvt_pk_bf16_f32 v81, v18, v19
    v_mfma_f32_32x32x16_bf16 v[64:79], v[120:123], v[88:91], v[64:79]
    ds_read_b128 v[120:123], v3 offset:17952
    v_exp_f32 v22, v22
    v_exp_f32 v23, v23
    v_cvt_pk_bf16_f32 v82, v20, v21
    v_exp_f32 v24, v24
    v_exp_f32 v25, v25
    v_cvt_pk_bf16_f32 v83, v22, v23
    v_exp_f32 v26, v26
    v_exp_f32 v27, v27
    v_mfma_f32_32x32x16_bf16 v[64:79], v[124:127], v[92:95], v[64:79]
    ds_read_b128 v[124:127], v4 offset:17952
    v_cvt_pk_bf16_f32 v84, v24, v25
    v_exp_f32 v28, v28
    v_exp_f32 v29, v29
    v_cvt_pk_bf16_f32 v85, v26, v27
    v_exp_f32 v30, v30
    v_exp_f32 v31, v31
    v_cvt_pk_bf16_f32 v86, v28, v29
    v_cvt_pk_bf16_f32 v87, v30, v31
    v_mfma_f32_32x32x16_bf16 v[16:31], v[108:111], v[96:99], 0
    v_lshrrev_b32 v9, 4, v0
    v_bfe_u32 v10, v0, 2, 2
    v_and_b32 v11, 3, v0
    v_lshlrev_b32 v10, 14, v10
    v_lshl_add_u32 v10, v11, 7, v10
    s_lshl_b32 s28, s21, 11
    s_lshl_b32 s29, s22, 9
    s_add_u32 s28, s28, s29
    s_lshl_b32 s29, s20, 16
    s_add_u32 s28, s28, s29
    v_add_u32 v10, s28, v10
    v_add_u32 v9, 1, v9
    v_lshlrev_b32 v9, 21, v9
    v_add_u32 v10, v10, v9
    s_mov_b32 s28, 8388608
    buffer_load_dword v137, v10, s[8:11], s28 offen
    v_exp_f32 v32, v32
    v_exp_f32 v33, v33
    v_exp_f32 v34, v34
    v_exp_f32 v35, v35
    v_cvt_pk_bf16_f32 v88, v32, v33
    v_exp_f32 v36, v36
    v_exp_f32 v37, v37
    v_cvt_pk_bf16_f32 v89, v34, v35
    v_mfma_f32_32x32x16_bf16 v[48:63], v[112:115], v[80:83], v[48:63]
    v_exp_f32 v38, v38
    v_exp_f32 v39, v39
    v_cvt_pk_bf16_f32 v90, v36, v37
    v_exp_f32 v40, v40
    v_exp_f32 v41, v41
    v_cvt_pk_bf16_f32 v91, v38, v39
    v_exp_f32 v42, v42
    v_exp_f32 v43, v43
    v_mfma_f32_32x32x16_bf16 v[48:63], v[116:119], v[84:87], v[48:63]
    s_waitcnt lgkmcnt(0)
    v_cvt_pk_bf16_f32 v92, v40, v41
    v_exp_f32 v44, v44
    v_exp_f32 v45, v45
    v_cvt_pk_bf16_f32 v93, v42, v43
    v_exp_f32 v46, v46
    v_exp_f32 v47, v47
    v_cvt_pk_bf16_f32 v94, v44, v45
    v_cvt_pk_bf16_f32 v95, v46, v47
    v_mfma_f32_32x32x16_bf16 v[32:47], v[108:111], v[100:103], 0
    ds_read_b128 v[108:111], v2 offset:19456
    v_exp_f32 v16, v16
    v_exp_f32 v17, v17
    v_exp_f32 v18, v18
    v_exp_f32 v19, v19
    v_cvt_pk_bf16_f32 v80, v16, v17
    v_exp_f32 v20, v20
    v_exp_f32 v21, v21
    v_cvt_pk_bf16_f32 v81, v18, v19
    v_mfma_f32_32x32x16_bf16 v[64:79], v[112:115], v[88:91], v[64:79]
    ds_read_b128 v[112:115], v3 offset:19008
    v_exp_f32 v22, v22
    v_exp_f32 v23, v23
    v_cvt_pk_bf16_f32 v82, v20, v21
    v_exp_f32 v24, v24
    v_exp_f32 v25, v25
    v_cvt_pk_bf16_f32 v83, v22, v23
    v_exp_f32 v26, v26
    v_exp_f32 v27, v27
    v_mfma_f32_32x32x16_bf16 v[64:79], v[116:119], v[92:95], v[64:79]
    ds_read_b128 v[116:119], v4 offset:19008
    v_cvt_pk_bf16_f32 v84, v24, v25
    v_exp_f32 v28, v28
    v_exp_f32 v29, v29
    v_cvt_pk_bf16_f32 v85, v26, v27
    v_exp_f32 v30, v30
    v_exp_f32 v31, v31
    v_cvt_pk_bf16_f32 v86, v28, v29
    v_cvt_pk_bf16_f32 v87, v30, v31
    v_mfma_f32_32x32x16_bf16 v[16:31], v[104:107], v[96:99], 0
    v_exp_f32 v32, v32
    v_exp_f32 v33, v33
    v_exp_f32 v34, v34
    v_exp_f32 v35, v35
    v_cvt_pk_bf16_f32 v88, v32, v33
    v_exp_f32 v36, v36
    v_exp_f32 v37, v37
    v_cvt_pk_bf16_f32 v89, v34, v35
    v_mfma_f32_32x32x16_bf16 v[48:63], v[120:123], v[80:83], v[48:63]
    v_exp_f32 v38, v38
    v_exp_f32 v39, v39
    v_cvt_pk_bf16_f32 v90, v36, v37
    v_exp_f32 v40, v40
    v_exp_f32 v41, v41
    v_cvt_pk_bf16_f32 v91, v38, v39
    v_exp_f32 v42, v42
    v_exp_f32 v43, v43
    v_mfma_f32_32x32x16_bf16 v[48:63], v[124:127], v[84:87], v[48:63]
    s_waitcnt lgkmcnt(0)
    v_cvt_pk_bf16_f32 v92, v40, v41
    v_exp_f32 v44, v44
    v_exp_f32 v45, v45
    v_cvt_pk_bf16_f32 v93, v42, v43
    v_exp_f32 v46, v46
    v_exp_f32 v47, v47
    v_cvt_pk_bf16_f32 v94, v44, v45
    v_cvt_pk_bf16_f32 v95, v46, v47
    v_mfma_f32_32x32x16_bf16 v[32:47], v[104:107], v[100:103], 0
    ds_read_b128 v[104:107], v2 offset:20480
    v_exp_f32 v16, v16
    v_exp_f32 v17, v17
    v_exp_f32 v18, v18
    v_exp_f32 v19, v19
    v_cvt_pk_bf16_f32 v80, v16, v17
    v_exp_f32 v20, v20
    v_exp_f32 v21, v21
    v_cvt_pk_bf16_f32 v81, v18, v19
    v_mfma_f32_32x32x16_bf16 v[64:79], v[120:123], v[88:91], v[64:79]
    ds_read_b128 v[120:123], v3 offset:20064
    v_exp_f32 v22, v22
    v_exp_f32 v23, v23
    v_cvt_pk_bf16_f32 v82, v20, v21
    v_exp_f32 v24, v24
    v_exp_f32 v25, v25
    v_cvt_pk_bf16_f32 v83, v22, v23
    v_exp_f32 v26, v26
    v_exp_f32 v27, v27
    v_mfma_f32_32x32x16_bf16 v[64:79], v[124:127], v[92:95], v[64:79]
    ds_read_b128 v[124:127], v4 offset:20064
    v_cvt_pk_bf16_f32 v84, v24, v25
    v_exp_f32 v28, v28
    v_exp_f32 v29, v29
    v_cvt_pk_bf16_f32 v85, v26, v27
    v_exp_f32 v30, v30
    v_exp_f32 v31, v31
    v_cvt_pk_bf16_f32 v86, v28, v29
    v_cvt_pk_bf16_f32 v87, v30, v31
    v_mfma_f32_32x32x16_bf16 v[16:31], v[108:111], v[96:99], 0
    v_exp_f32 v32, v32
    v_exp_f32 v33, v33
    v_exp_f32 v34, v34
    v_exp_f32 v35, v35
    v_cvt_pk_bf16_f32 v88, v32, v33
    v_exp_f32 v36, v36
    v_exp_f32 v37, v37
    v_cvt_pk_bf16_f32 v89, v34, v35
    v_mfma_f32_32x32x16_bf16 v[48:63], v[112:115], v[80:83], v[48:63]
    v_exp_f32 v38, v38
    v_exp_f32 v39, v39
    v_cvt_pk_bf16_f32 v90, v36, v37
    v_exp_f32 v40, v40
    v_exp_f32 v41, v41
    v_cvt_pk_bf16_f32 v91, v38, v39
    v_exp_f32 v42, v42
    v_exp_f32 v43, v43
    v_mfma_f32_32x32x16_bf16 v[48:63], v[116:119], v[84:87], v[48:63]
    s_waitcnt lgkmcnt(0)
    v_cvt_pk_bf16_f32 v92, v40, v41
    v_exp_f32 v44, v44
    v_exp_f32 v45, v45
    v_cvt_pk_bf16_f32 v93, v42, v43
    v_exp_f32 v46, v46
    v_exp_f32 v47, v47
    v_cvt_pk_bf16_f32 v94, v44, v45
    v_cvt_pk_bf16_f32 v95, v46, v47
    v_mfma_f32_32x32x16_bf16 v[32:47], v[108:111], v[100:103], 0
    ds_read_b128 v[108:111], v2 offset:21504
    v_exp_f32 v16, v16
    v_exp_f32 v17, v17
    v_exp_f32 v18, v18
    v_exp_f32 v19, v19
    v_cvt_pk_bf16_f32 v80, v16, v17
    v_exp_f32 v20, v20
    v_exp_f32 v21, v21
    v_cvt_pk_bf16_f32 v81, v18, v19
    v_mfma_f32_32x32x16_bf16 v[64:79], v[112:115], v[88:91], v[64:79]
    ds_read_b128 v[112:115], v3 offset:21120
    v_exp_f32 v22, v22
    v_exp_f32 v23, v23
    v_cvt_pk_bf16_f32 v82, v20, v21
    v_exp_f32 v24, v24
    v_exp_f32 v25, v25
    v_cvt_pk_bf16_f32 v83, v22, v23
    v_exp_f32 v26, v26
    v_exp_f32 v27, v27
    v_mfma_f32_32x32x16_bf16 v[64:79], v[116:119], v[92:95], v[64:79]
    ds_read_b128 v[116:119], v4 offset:21120
    v_cvt_pk_bf16_f32 v84, v24, v25
    v_exp_f32 v28, v28
    v_exp_f32 v29, v29
    v_cvt_pk_bf16_f32 v85, v26, v27
    v_exp_f32 v30, v30
    v_exp_f32 v31, v31
    v_cvt_pk_bf16_f32 v86, v28, v29
    v_cvt_pk_bf16_f32 v87, v30, v31
    v_mfma_f32_32x32x16_bf16 v[16:31], v[104:107], v[96:99], 0
    v_exp_f32 v32, v32
    v_exp_f32 v33, v33
    v_exp_f32 v34, v34
    v_exp_f32 v35, v35
    v_cvt_pk_bf16_f32 v88, v32, v33
    v_exp_f32 v36, v36
    v_exp_f32 v37, v37
    v_cvt_pk_bf16_f32 v89, v34, v35
    v_mfma_f32_32x32x16_bf16 v[48:63], v[120:123], v[80:83], v[48:63]
    v_exp_f32 v38, v38
    v_exp_f32 v39, v39
    v_cvt_pk_bf16_f32 v90, v36, v37
    v_exp_f32 v40, v40
    v_exp_f32 v41, v41
    v_cvt_pk_bf16_f32 v91, v38, v39
    v_exp_f32 v42, v42
    v_exp_f32 v43, v43
    v_mfma_f32_32x32x16_bf16 v[48:63], v[124:127], v[84:87], v[48:63]
    s_waitcnt lgkmcnt(0)
    v_cvt_pk_bf16_f32 v92, v40, v41
    v_exp_f32 v44, v44
    v_exp_f32 v45, v45
    v_cvt_pk_bf16_f32 v93, v42, v43
    v_exp_f32 v46, v46
    v_exp_f32 v47, v47
    v_cvt_pk_bf16_f32 v94, v44, v45
    v_cvt_pk_bf16_f32 v95, v46, v47
    v_mfma_f32_32x32x16_bf16 v[32:47], v[104:107], v[100:103], 0
    ds_read_b128 v[104:107], v2 offset:22528
    v_exp_f32 v16, v16
    v_exp_f32 v17, v17
    v_exp_f32 v18, v18
    v_exp_f32 v19, v19
    v_cvt_pk_bf16_f32 v80, v16, v17
    v_exp_f32 v20, v20
    v_exp_f32 v21, v21
    v_cvt_pk_bf16_f32 v81, v18, v19
    v_mfma_f32_32x32x16_bf16 v[64:79], v[120:123], v[88:91], v[64:79]
    ds_read_b128 v[120:123], v3 offset:22176
    v_exp_f32 v22, v22
    v_exp_f32 v23, v23
    v_cvt_pk_bf16_f32 v82, v20, v21
    v_exp_f32 v24, v24
    v_exp_f32 v25, v25
    v_cvt_pk_bf16_f32 v83, v22, v23
    v_exp_f32 v26, v26
    v_exp_f32 v27, v27
    v_mfma_f32_32x32x16_bf16 v[64:79], v[124:127], v[92:95], v[64:79]
    ds_read_b128 v[124:127], v4 offset:22176
    v_cvt_pk_bf16_f32 v84, v24, v25
    v_exp_f32 v28, v28
    v_exp_f32 v29, v29
    v_cvt_pk_bf16_f32 v85, v26, v27
    v_exp_f32 v30, v30
    v_exp_f32 v31, v31
    v_cvt_pk_bf16_f32 v86, v28, v29
    v_cvt_pk_bf16_f32 v87, v30, v31
    v_mfma_f32_32x32x16_bf16 v[16:31], v[108:111], v[96:99], 0
    v_exp_f32 v32, v32
    v_exp_f32 v33, v33
    v_exp_f32 v34, v34
    v_exp_f32 v35, v35
    v_cvt_pk_bf16_f32 v88, v32, v33
    v_exp_f32 v36, v36
    v_exp_f32 v37, v37
    v_cvt_pk_bf16_f32 v89, v34, v35
    v_mfma_f32_32x32x16_bf16 v[48:63], v[112:115], v[80:83], v[48:63]
    v_exp_f32 v38, v38
    v_exp_f32 v39, v39
    v_cvt_pk_bf16_f32 v90, v36, v37
    v_exp_f32 v40, v40
    v_exp_f32 v41, v41
    v_cvt_pk_bf16_f32 v91, v38, v39
    v_exp_f32 v42, v42
    v_exp_f32 v43, v43
    v_mfma_f32_32x32x16_bf16 v[48:63], v[116:119], v[84:87], v[48:63]
    s_waitcnt lgkmcnt(0)
    v_cvt_pk_bf16_f32 v92, v40, v41
    v_exp_f32 v44, v44
    v_exp_f32 v45, v45
    v_cvt_pk_bf16_f32 v93, v42, v43
    v_exp_f32 v46, v46
    v_exp_f32 v47, v47
    v_cvt_pk_bf16_f32 v94, v44, v45
    v_cvt_pk_bf16_f32 v95, v46, v47
    v_mfma_f32_32x32x16_bf16 v[32:47], v[108:111], v[100:103], 0
    ds_read_b128 v[108:111], v2 offset:23552
    v_exp_f32 v16, v16
    v_exp_f32 v17, v17
    v_exp_f32 v18, v18
    v_exp_f32 v19, v19
    v_cvt_pk_bf16_f32 v80, v16, v17
    v_exp_f32 v20, v20
    v_exp_f32 v21, v21
    v_cvt_pk_bf16_f32 v81, v18, v19
    v_mfma_f32_32x32x16_bf16 v[64:79], v[112:115], v[88:91], v[64:79]
    ds_read_b128 v[112:115], v3 offset:23232
    v_exp_f32 v22, v22
    v_exp_f32 v23, v23
    v_cvt_pk_bf16_f32 v82, v20, v21
    v_exp_f32 v24, v24
    v_exp_f32 v25, v25
    v_cvt_pk_bf16_f32 v83, v22, v23
    v_exp_f32 v26, v26
    v_exp_f32 v27, v27
    v_mfma_f32_32x32x16_bf16 v[64:79], v[116:119], v[92:95], v[64:79]
    ds_read_b128 v[116:119], v4 offset:23232
    v_cvt_pk_bf16_f32 v84, v24, v25
    v_exp_f32 v28, v28
    v_exp_f32 v29, v29
    v_cvt_pk_bf16_f32 v85, v26, v27
    v_exp_f32 v30, v30
    v_exp_f32 v31, v31
    v_cvt_pk_bf16_f32 v86, v28, v29
    v_cvt_pk_bf16_f32 v87, v30, v31
    v_mfma_f32_32x32x16_bf16 v[16:31], v[104:107], v[96:99], 0
    v_exp_f32 v32, v32
    v_exp_f32 v33, v33
    v_exp_f32 v34, v34
    v_exp_f32 v35, v35
    v_cvt_pk_bf16_f32 v88, v32, v33
    v_exp_f32 v36, v36
    v_exp_f32 v37, v37
    v_cvt_pk_bf16_f32 v89, v34, v35
    v_mfma_f32_32x32x16_bf16 v[48:63], v[120:123], v[80:83], v[48:63]
    v_exp_f32 v38, v38
    v_exp_f32 v39, v39
    v_cvt_pk_bf16_f32 v90, v36, v37
    v_exp_f32 v40, v40
    v_exp_f32 v41, v41
    v_cvt_pk_bf16_f32 v91, v38, v39
    v_exp_f32 v42, v42
    v_exp_f32 v43, v43
    v_mfma_f32_32x32x16_bf16 v[48:63], v[124:127], v[84:87], v[48:63]
    s_waitcnt lgkmcnt(0)
    v_cvt_pk_bf16_f32 v92, v40, v41
    v_exp_f32 v44, v44
    v_exp_f32 v45, v45
    v_cvt_pk_bf16_f32 v93, v42, v43
    v_exp_f32 v46, v46
    v_exp_f32 v47, v47
    v_cvt_pk_bf16_f32 v94, v44, v45
    v_cvt_pk_bf16_f32 v95, v46, v47
    v_mfma_f32_32x32x16_bf16 v[32:47], v[104:107], v[100:103], 0
    ds_read_b128 v[104:107], v2 offset:24576
    v_exp_f32 v16, v16
    v_exp_f32 v17, v17
    v_exp_f32 v18, v18
    v_exp_f32 v19, v19
    v_cvt_pk_bf16_f32 v80, v16, v17
    v_exp_f32 v20, v20
    v_exp_f32 v21, v21
    v_cvt_pk_bf16_f32 v81, v18, v19
    v_mfma_f32_32x32x16_bf16 v[64:79], v[120:123], v[88:91], v[64:79]
    ds_read_b128 v[120:123], v3 offset:24288
    v_exp_f32 v22, v22
    v_exp_f32 v23, v23
    v_cvt_pk_bf16_f32 v82, v20, v21
    v_exp_f32 v24, v24
    v_exp_f32 v25, v25
    v_cvt_pk_bf16_f32 v83, v22, v23
    v_exp_f32 v26, v26
    v_exp_f32 v27, v27
    v_mfma_f32_32x32x16_bf16 v[64:79], v[124:127], v[92:95], v[64:79]
    ds_read_b128 v[124:127], v4 offset:24288
    v_cvt_pk_bf16_f32 v84, v24, v25
    v_exp_f32 v28, v28
    v_exp_f32 v29, v29
    v_cvt_pk_bf16_f32 v85, v26, v27
    v_exp_f32 v30, v30
    v_exp_f32 v31, v31
    v_cvt_pk_bf16_f32 v86, v28, v29
    v_cvt_pk_bf16_f32 v87, v30, v31
    v_mfma_f32_32x32x16_bf16 v[16:31], v[108:111], v[96:99], 0
    v_exp_f32 v32, v32
    v_exp_f32 v33, v33
    v_exp_f32 v34, v34
    v_exp_f32 v35, v35
    v_cvt_pk_bf16_f32 v88, v32, v33
    v_exp_f32 v36, v36
    v_exp_f32 v37, v37
    v_cvt_pk_bf16_f32 v89, v34, v35
    v_mfma_f32_32x32x16_bf16 v[48:63], v[112:115], v[80:83], v[48:63]
    v_exp_f32 v38, v38
    v_exp_f32 v39, v39
    v_cvt_pk_bf16_f32 v90, v36, v37
    v_exp_f32 v40, v40
    v_exp_f32 v41, v41
    v_cvt_pk_bf16_f32 v91, v38, v39
    v_exp_f32 v42, v42
    v_exp_f32 v43, v43
    v_mfma_f32_32x32x16_bf16 v[48:63], v[116:119], v[84:87], v[48:63]
    s_waitcnt lgkmcnt(0)
    v_cvt_pk_bf16_f32 v92, v40, v41
    v_exp_f32 v44, v44
    v_exp_f32 v45, v45
    v_cvt_pk_bf16_f32 v93, v42, v43
    v_exp_f32 v46, v46
    v_exp_f32 v47, v47
    v_cvt_pk_bf16_f32 v94, v44, v45
    v_cvt_pk_bf16_f32 v95, v46, v47
    v_mfma_f32_32x32x16_bf16 v[32:47], v[108:111], v[100:103], 0
    ds_read_b128 v[108:111], v2 offset:25600
    v_exp_f32 v16, v16
    v_exp_f32 v17, v17
    v_exp_f32 v18, v18
    v_exp_f32 v19, v19
    v_cvt_pk_bf16_f32 v80, v16, v17
    v_exp_f32 v20, v20
    v_exp_f32 v21, v21
    v_cvt_pk_bf16_f32 v81, v18, v19
    v_mfma_f32_32x32x16_bf16 v[64:79], v[112:115], v[88:91], v[64:79]
    ds_read_b128 v[112:115], v3 offset:25344
    v_exp_f32 v22, v22
    v_exp_f32 v23, v23
    v_cvt_pk_bf16_f32 v82, v20, v21
    v_exp_f32 v24, v24
    v_exp_f32 v25, v25
    v_cvt_pk_bf16_f32 v83, v22, v23
    v_exp_f32 v26, v26
    v_exp_f32 v27, v27
    v_mfma_f32_32x32x16_bf16 v[64:79], v[116:119], v[92:95], v[64:79]
    ds_read_b128 v[116:119], v4 offset:25344
    v_cvt_pk_bf16_f32 v84, v24, v25
    v_exp_f32 v28, v28
    v_exp_f32 v29, v29
    v_cvt_pk_bf16_f32 v85, v26, v27
    v_exp_f32 v30, v30
    v_exp_f32 v31, v31
    v_cvt_pk_bf16_f32 v86, v28, v29
    v_cvt_pk_bf16_f32 v87, v30, v31
    v_mfma_f32_32x32x16_bf16 v[16:31], v[104:107], v[96:99], 0
    v_exp_f32 v32, v32
    v_exp_f32 v33, v33
    v_exp_f32 v34, v34
    v_exp_f32 v35, v35
    v_cvt_pk_bf16_f32 v88, v32, v33
    v_exp_f32 v36, v36
    v_exp_f32 v37, v37
    v_cvt_pk_bf16_f32 v89, v34, v35
    v_mfma_f32_32x32x16_bf16 v[48:63], v[120:123], v[80:83], v[48:63]
    v_exp_f32 v38, v38
    v_exp_f32 v39, v39
    v_cvt_pk_bf16_f32 v90, v36, v37
    v_exp_f32 v40, v40
    v_exp_f32 v41, v41
    v_cvt_pk_bf16_f32 v91, v38, v39
    v_exp_f32 v42, v42
    v_exp_f32 v43, v43
    v_mfma_f32_32x32x16_bf16 v[48:63], v[124:127], v[84:87], v[48:63]
    s_waitcnt lgkmcnt(0)
    v_cvt_pk_bf16_f32 v92, v40, v41
    v_exp_f32 v44, v44
    v_exp_f32 v45, v45
    v_cvt_pk_bf16_f32 v93, v42, v43
    v_exp_f32 v46, v46
    v_exp_f32 v47, v47
    v_cvt_pk_bf16_f32 v94, v44, v45
    v_cvt_pk_bf16_f32 v95, v46, v47
    v_mfma_f32_32x32x16_bf16 v[32:47], v[104:107], v[100:103], 0
    ds_read_b128 v[104:107], v2 offset:26624
    v_exp_f32 v16, v16
    v_exp_f32 v17, v17
    v_exp_f32 v18, v18
    v_exp_f32 v19, v19
    v_cvt_pk_bf16_f32 v80, v16, v17
    v_exp_f32 v20, v20
    v_exp_f32 v21, v21
    v_cvt_pk_bf16_f32 v81, v18, v19
    v_mfma_f32_32x32x16_bf16 v[64:79], v[120:123], v[88:91], v[64:79]
    ds_read_b128 v[120:123], v3 offset:26400
    v_exp_f32 v22, v22
    v_exp_f32 v23, v23
    v_cvt_pk_bf16_f32 v82, v20, v21
    v_exp_f32 v24, v24
    v_exp_f32 v25, v25
    v_cvt_pk_bf16_f32 v83, v22, v23
    v_exp_f32 v26, v26
    v_exp_f32 v27, v27
    v_mfma_f32_32x32x16_bf16 v[64:79], v[124:127], v[92:95], v[64:79]
    ds_read_b128 v[124:127], v4 offset:26400
    v_cvt_pk_bf16_f32 v84, v24, v25
    v_exp_f32 v28, v28
    v_exp_f32 v29, v29
    v_cvt_pk_bf16_f32 v85, v26, v27
    v_exp_f32 v30, v30
    v_exp_f32 v31, v31
    v_cvt_pk_bf16_f32 v86, v28, v29
    v_cvt_pk_bf16_f32 v87, v30, v31
    v_mfma_f32_32x32x16_bf16 v[16:31], v[108:111], v[96:99], 0
    v_exp_f32 v32, v32
    v_exp_f32 v33, v33
    v_exp_f32 v34, v34
    v_exp_f32 v35, v35
    v_cvt_pk_bf16_f32 v88, v32, v33
    v_exp_f32 v36, v36
    v_exp_f32 v37, v37
    v_cvt_pk_bf16_f32 v89, v34, v35
    v_mfma_f32_32x32x16_bf16 v[48:63], v[112:115], v[80:83], v[48:63]
    v_exp_f32 v38, v38
    v_exp_f32 v39, v39
    v_cvt_pk_bf16_f32 v90, v36, v37
    v_exp_f32 v40, v40
    v_exp_f32 v41, v41
    v_cvt_pk_bf16_f32 v91, v38, v39
    v_exp_f32 v42, v42
    v_exp_f32 v43, v43
    v_mfma_f32_32x32x16_bf16 v[48:63], v[116:119], v[84:87], v[48:63]
    s_waitcnt lgkmcnt(0)
    v_cvt_pk_bf16_f32 v92, v40, v41
    v_exp_f32 v44, v44
    v_exp_f32 v45, v45
    v_cvt_pk_bf16_f32 v93, v42, v43
    v_exp_f32 v46, v46
    v_exp_f32 v47, v47
    v_cvt_pk_bf16_f32 v94, v44, v45
    v_cvt_pk_bf16_f32 v95, v46, v47
    v_mfma_f32_32x32x16_bf16 v[32:47], v[108:111], v[100:103], 0
    ds_read_b128 v[108:111], v2 offset:27648
    v_exp_f32 v16, v16
    v_exp_f32 v17, v17
    v_exp_f32 v18, v18
    v_exp_f32 v19, v19
    v_cvt_pk_bf16_f32 v80, v16, v17
    v_exp_f32 v20, v20
    v_exp_f32 v21, v21
    v_cvt_pk_bf16_f32 v81, v18, v19
    v_mfma_f32_32x32x16_bf16 v[64:79], v[112:115], v[88:91], v[64:79]
    ds_read_b128 v[112:115], v3 offset:27456
    v_exp_f32 v22, v22
    v_exp_f32 v23, v23
    v_cvt_pk_bf16_f32 v82, v20, v21
    v_exp_f32 v24, v24
    v_exp_f32 v25, v25
    v_cvt_pk_bf16_f32 v83, v22, v23
    v_exp_f32 v26, v26
    v_exp_f32 v27, v27
    v_mfma_f32_32x32x16_bf16 v[64:79], v[116:119], v[92:95], v[64:79]
    ds_read_b128 v[116:119], v4 offset:27456
    v_cvt_pk_bf16_f32 v84, v24, v25
    v_exp_f32 v28, v28
    v_exp_f32 v29, v29
    v_cvt_pk_bf16_f32 v85, v26, v27
    v_exp_f32 v30, v30
    v_exp_f32 v31, v31
    v_cvt_pk_bf16_f32 v86, v28, v29
    v_cvt_pk_bf16_f32 v87, v30, v31
    v_mfma_f32_32x32x16_bf16 v[16:31], v[104:107], v[96:99], 0
    v_exp_f32 v32, v32
    v_exp_f32 v33, v33
    v_exp_f32 v34, v34
    v_exp_f32 v35, v35
    v_cvt_pk_bf16_f32 v88, v32, v33
    v_exp_f32 v36, v36
    v_exp_f32 v37, v37
    v_cvt_pk_bf16_f32 v89, v34, v35
    v_mfma_f32_32x32x16_bf16 v[48:63], v[120:123], v[80:83], v[48:63]
    v_exp_f32 v38, v38
    v_exp_f32 v39, v39
    v_cvt_pk_bf16_f32 v90, v36, v37
    v_exp_f32 v40, v40
    v_exp_f32 v41, v41
    v_cvt_pk_bf16_f32 v91, v38, v39
    v_exp_f32 v42, v42
    v_exp_f32 v43, v43
    v_mfma_f32_32x32x16_bf16 v[48:63], v[124:127], v[84:87], v[48:63]
    s_waitcnt lgkmcnt(0)
    v_cvt_pk_bf16_f32 v92, v40, v41
    v_exp_f32 v44, v44
    v_exp_f32 v45, v45
    v_cvt_pk_bf16_f32 v93, v42, v43
    v_exp_f32 v46, v46
    v_exp_f32 v47, v47
    v_cvt_pk_bf16_f32 v94, v44, v45
    v_cvt_pk_bf16_f32 v95, v46, v47
    v_mfma_f32_32x32x16_bf16 v[32:47], v[104:107], v[100:103], 0
    ds_read_b128 v[104:107], v2 offset:28672
    v_exp_f32 v16, v16
    v_exp_f32 v17, v17
    v_exp_f32 v18, v18
    v_exp_f32 v19, v19
    v_cvt_pk_bf16_f32 v80, v16, v17
    v_exp_f32 v20, v20
    v_exp_f32 v21, v21
    v_cvt_pk_bf16_f32 v81, v18, v19
    v_mfma_f32_32x32x16_bf16 v[64:79], v[120:123], v[88:91], v[64:79]
    ds_read_b128 v[120:123], v3 offset:28512
    v_exp_f32 v22, v22
    v_exp_f32 v23, v23
    v_cvt_pk_bf16_f32 v82, v20, v21
    v_exp_f32 v24, v24
    v_exp_f32 v25, v25
    v_cvt_pk_bf16_f32 v83, v22, v23
    v_exp_f32 v26, v26
    v_exp_f32 v27, v27
    v_mfma_f32_32x32x16_bf16 v[64:79], v[124:127], v[92:95], v[64:79]
    ds_read_b128 v[124:127], v4 offset:28512
    v_cvt_pk_bf16_f32 v84, v24, v25
    v_exp_f32 v28, v28
    v_exp_f32 v29, v29
    v_cvt_pk_bf16_f32 v85, v26, v27
    v_exp_f32 v30, v30
    v_exp_f32 v31, v31
    v_cvt_pk_bf16_f32 v86, v28, v29
    v_cvt_pk_bf16_f32 v87, v30, v31
    v_mfma_f32_32x32x16_bf16 v[16:31], v[108:111], v[96:99], 0
    v_exp_f32 v32, v32
    v_exp_f32 v33, v33
    v_exp_f32 v34, v34
    v_exp_f32 v35, v35
    v_cvt_pk_bf16_f32 v88, v32, v33
    v_exp_f32 v36, v36
    v_exp_f32 v37, v37
    v_cvt_pk_bf16_f32 v89, v34, v35
    v_mfma_f32_32x32x16_bf16 v[48:63], v[112:115], v[80:83], v[48:63]
    v_exp_f32 v38, v38
    v_exp_f32 v39, v39
    v_cvt_pk_bf16_f32 v90, v36, v37
    v_exp_f32 v40, v40
    v_exp_f32 v41, v41
    v_cvt_pk_bf16_f32 v91, v38, v39
    v_exp_f32 v42, v42
    v_exp_f32 v43, v43
    v_mfma_f32_32x32x16_bf16 v[48:63], v[116:119], v[84:87], v[48:63]
    s_waitcnt lgkmcnt(0)
    v_cvt_pk_bf16_f32 v92, v40, v41
    v_exp_f32 v44, v44
    v_exp_f32 v45, v45
    v_cvt_pk_bf16_f32 v93, v42, v43
    v_exp_f32 v46, v46
    v_exp_f32 v47, v47
    v_cvt_pk_bf16_f32 v94, v44, v45
    v_cvt_pk_bf16_f32 v95, v46, v47
    v_mfma_f32_32x32x16_bf16 v[32:47], v[108:111], v[100:103], 0
    ds_read_b128 v[108:111], v2 offset:29696
    v_exp_f32 v16, v16
    v_exp_f32 v17, v17
    v_exp_f32 v18, v18
    v_exp_f32 v19, v19
    v_cvt_pk_bf16_f32 v80, v16, v17
    v_exp_f32 v20, v20
    v_exp_f32 v21, v21
    v_cvt_pk_bf16_f32 v81, v18, v19
    v_mfma_f32_32x32x16_bf16 v[64:79], v[112:115], v[88:91], v[64:79]
    ds_read_b128 v[112:115], v3 offset:29568
    v_exp_f32 v22, v22
    v_exp_f32 v23, v23
    v_cvt_pk_bf16_f32 v82, v20, v21
    v_exp_f32 v24, v24
    v_exp_f32 v25, v25
    v_cvt_pk_bf16_f32 v83, v22, v23
    v_exp_f32 v26, v26
    v_exp_f32 v27, v27
    v_mfma_f32_32x32x16_bf16 v[64:79], v[116:119], v[92:95], v[64:79]
    ds_read_b128 v[116:119], v4 offset:29568
    v_cvt_pk_bf16_f32 v84, v24, v25
    v_exp_f32 v28, v28
    v_exp_f32 v29, v29
    v_cvt_pk_bf16_f32 v85, v26, v27
    v_exp_f32 v30, v30
    v_exp_f32 v31, v31
    v_cvt_pk_bf16_f32 v86, v28, v29
    v_cvt_pk_bf16_f32 v87, v30, v31
    v_mfma_f32_32x32x16_bf16 v[16:31], v[104:107], v[96:99], 0
    v_exp_f32 v32, v32
    v_exp_f32 v33, v33
    v_exp_f32 v34, v34
    v_exp_f32 v35, v35
    v_cvt_pk_bf16_f32 v88, v32, v33
    v_exp_f32 v36, v36
    v_exp_f32 v37, v37
    v_cvt_pk_bf16_f32 v89, v34, v35
    v_mfma_f32_32x32x16_bf16 v[48:63], v[120:123], v[80:83], v[48:63]
    v_exp_f32 v38, v38
    v_exp_f32 v39, v39
    v_cvt_pk_bf16_f32 v90, v36, v37
    v_exp_f32 v40, v40
    v_exp_f32 v41, v41
    v_cvt_pk_bf16_f32 v91, v38, v39
    v_exp_f32 v42, v42
    v_exp_f32 v43, v43
    v_mfma_f32_32x32x16_bf16 v[48:63], v[124:127], v[84:87], v[48:63]
    s_waitcnt lgkmcnt(0)
    v_cvt_pk_bf16_f32 v92, v40, v41
    v_exp_f32 v44, v44
    v_exp_f32 v45, v45
    v_cvt_pk_bf16_f32 v93, v42, v43
    v_exp_f32 v46, v46
    v_exp_f32 v47, v47
    v_cvt_pk_bf16_f32 v94, v44, v45
    v_cvt_pk_bf16_f32 v95, v46, v47
    v_mfma_f32_32x32x16_bf16 v[32:47], v[104:107], v[100:103], 0
    ds_read_b128 v[104:107], v2 offset:30720
    v_exp_f32 v16, v16
    v_exp_f32 v17, v17
    v_exp_f32 v18, v18
    v_exp_f32 v19, v19
    v_cvt_pk_bf16_f32 v80, v16, v17
    v_exp_f32 v20, v20
    v_exp_f32 v21, v21
    v_cvt_pk_bf16_f32 v81, v18, v19
    v_mfma_f32_32x32x16_bf16 v[64:79], v[120:123], v[88:91], v[64:79]
    ds_read_b128 v[120:123], v3 offset:30624
    v_exp_f32 v22, v22
    v_exp_f32 v23, v23
    v_cvt_pk_bf16_f32 v82, v20, v21
    v_exp_f32 v24, v24
    v_exp_f32 v25, v25
    v_cvt_pk_bf16_f32 v83, v22, v23
    v_exp_f32 v26, v26
    v_exp_f32 v27, v27
    v_mfma_f32_32x32x16_bf16 v[64:79], v[124:127], v[92:95], v[64:79]
    ds_read_b128 v[124:127], v4 offset:30624
    v_cvt_pk_bf16_f32 v84, v24, v25
    v_exp_f32 v28, v28
    v_exp_f32 v29, v29
    v_cvt_pk_bf16_f32 v85, v26, v27
    v_exp_f32 v30, v30
    v_exp_f32 v31, v31
    v_cvt_pk_bf16_f32 v86, v28, v29
    v_cvt_pk_bf16_f32 v87, v30, v31
    v_mfma_f32_32x32x16_bf16 v[16:31], v[108:111], v[96:99], 0
    v_exp_f32 v32, v32
    v_exp_f32 v33, v33
    v_exp_f32 v34, v34
    v_exp_f32 v35, v35
    v_cvt_pk_bf16_f32 v88, v32, v33
    v_exp_f32 v36, v36
    v_exp_f32 v37, v37
    v_cvt_pk_bf16_f32 v89, v34, v35
    v_mfma_f32_32x32x16_bf16 v[48:63], v[112:115], v[80:83], v[48:63]
    v_exp_f32 v38, v38
    v_exp_f32 v39, v39
    v_cvt_pk_bf16_f32 v90, v36, v37
    v_exp_f32 v40, v40
    v_exp_f32 v41, v41
    v_cvt_pk_bf16_f32 v91, v38, v39
    v_exp_f32 v42, v42
    v_exp_f32 v43, v43
    v_mfma_f32_32x32x16_bf16 v[48:63], v[116:119], v[84:87], v[48:63]
    s_waitcnt lgkmcnt(0)
    v_cvt_pk_bf16_f32 v92, v40, v41
    v_exp_f32 v44, v44
    v_exp_f32 v45, v45
    v_cvt_pk_bf16_f32 v93, v42, v43
    v_exp_f32 v46, v46
    v_exp_f32 v47, v47
    v_cvt_pk_bf16_f32 v94, v44, v45
    v_cvt_pk_bf16_f32 v95, v46, v47
    v_mfma_f32_32x32x16_bf16 v[32:47], v[108:111], v[100:103], 0
    ds_read_b128 v[108:111], v2 offset:31744
    v_exp_f32 v16, v16
    v_exp_f32 v17, v17
    v_exp_f32 v18, v18
    v_exp_f32 v19, v19
    v_cvt_pk_bf16_f32 v80, v16, v17
    v_exp_f32 v20, v20
    v_exp_f32 v21, v21
    v_cvt_pk_bf16_f32 v81, v18, v19
    v_mfma_f32_32x32x16_bf16 v[64:79], v[112:115], v[88:91], v[64:79]
    ds_read_b128 v[112:115], v3 offset:31680
    v_exp_f32 v22, v22
    v_exp_f32 v23, v23
    v_cvt_pk_bf16_f32 v82, v20, v21
    v_exp_f32 v24, v24
    v_exp_f32 v25, v25
    v_cvt_pk_bf16_f32 v83, v22, v23
    v_exp_f32 v26, v26
    v_exp_f32 v27, v27
    v_mfma_f32_32x32x16_bf16 v[64:79], v[116:119], v[92:95], v[64:79]
    ds_read_b128 v[116:119], v4 offset:31680
    v_cvt_pk_bf16_f32 v84, v24, v25
    v_exp_f32 v28, v28
    v_exp_f32 v29, v29
    v_cvt_pk_bf16_f32 v85, v26, v27
    v_exp_f32 v30, v30
    v_exp_f32 v31, v31
    v_cvt_pk_bf16_f32 v86, v28, v29
    v_cvt_pk_bf16_f32 v87, v30, v31
    v_mfma_f32_32x32x16_bf16 v[16:31], v[104:107], v[96:99], 0
    v_exp_f32 v32, v32
    v_exp_f32 v33, v33
    v_exp_f32 v34, v34
    v_exp_f32 v35, v35
    v_cvt_pk_bf16_f32 v88, v32, v33
    v_exp_f32 v36, v36
    v_exp_f32 v37, v37
    v_cvt_pk_bf16_f32 v89, v34, v35
    v_mfma_f32_32x32x16_bf16 v[48:63], v[120:123], v[80:83], v[48:63]
    v_exp_f32 v38, v38
    v_exp_f32 v39, v39
    v_cvt_pk_bf16_f32 v90, v36, v37
    v_exp_f32 v40, v40
    v_exp_f32 v41, v41
    v_cvt_pk_bf16_f32 v91, v38, v39
    v_exp_f32 v42, v42
    v_exp_f32 v43, v43
    v_mfma_f32_32x32x16_bf16 v[48:63], v[124:127], v[84:87], v[48:63]
    s_waitcnt lgkmcnt(0)
    v_cvt_pk_bf16_f32 v92, v40, v41
    v_exp_f32 v44, v44
    v_exp_f32 v45, v45
    v_cvt_pk_bf16_f32 v93, v42, v43
    v_exp_f32 v46, v46
    v_exp_f32 v47, v47
    v_cvt_pk_bf16_f32 v94, v44, v45
    v_cvt_pk_bf16_f32 v95, v46, v47
    v_mfma_f32_32x32x16_bf16 v[32:47], v[104:107], v[100:103], 0
    v_exp_f32 v16, v16
    v_exp_f32 v17, v17
    v_exp_f32 v18, v18
    v_exp_f32 v19, v19
    v_cvt_pk_bf16_f32 v80, v16, v17
    v_exp_f32 v20, v20
    v_exp_f32 v21, v21
    v_cvt_pk_bf16_f32 v81, v18, v19
    v_mfma_f32_32x32x16_bf16 v[64:79], v[120:123], v[88:91], v[64:79]
    ds_read_b128 v[120:123], v3 offset:32736
    v_exp_f32 v22, v22
    v_exp_f32 v23, v23
    v_cvt_pk_bf16_f32 v82, v20, v21
    v_exp_f32 v24, v24
    v_exp_f32 v25, v25
    v_cvt_pk_bf16_f32 v83, v22, v23
    v_exp_f32 v26, v26
    v_exp_f32 v27, v27
    v_mfma_f32_32x32x16_bf16 v[64:79], v[124:127], v[92:95], v[64:79]
    ds_read_b128 v[124:127], v4 offset:32736
    v_cvt_pk_bf16_f32 v84, v24, v25
    v_exp_f32 v28, v28
    v_exp_f32 v29, v29
    v_cvt_pk_bf16_f32 v85, v26, v27
    v_exp_f32 v30, v30
    v_exp_f32 v31, v31
    v_cvt_pk_bf16_f32 v86, v28, v29
    v_cvt_pk_bf16_f32 v87, v30, v31
    v_mfma_f32_32x32x16_bf16 v[16:31], v[108:111], v[96:99], 0
    v_exp_f32 v32, v32
    v_exp_f32 v33, v33
    v_exp_f32 v34, v34
    v_exp_f32 v35, v35
    v_cvt_pk_bf16_f32 v88, v32, v33
    v_exp_f32 v36, v36
    v_exp_f32 v37, v37
    v_cvt_pk_bf16_f32 v89, v34, v35
    v_mfma_f32_32x32x16_bf16 v[48:63], v[112:115], v[80:83], v[48:63]
    v_exp_f32 v38, v38
    v_exp_f32 v39, v39
    v_cvt_pk_bf16_f32 v90, v36, v37
    v_exp_f32 v40, v40
    v_exp_f32 v41, v41
    v_cvt_pk_bf16_f32 v91, v38, v39
    v_exp_f32 v42, v42
    v_exp_f32 v43, v43
    v_mfma_f32_32x32x16_bf16 v[48:63], v[116:119], v[84:87], v[48:63]
    s_waitcnt lgkmcnt(0)
    v_cvt_pk_bf16_f32 v92, v40, v41
    v_exp_f32 v44, v44
    v_exp_f32 v45, v45
    v_cvt_pk_bf16_f32 v93, v42, v43
    v_exp_f32 v46, v46
    v_exp_f32 v47, v47
    v_cvt_pk_bf16_f32 v94, v44, v45
    v_cvt_pk_bf16_f32 v95, v46, v47
    v_mfma_f32_32x32x16_bf16 v[32:47], v[108:111], v[100:103], 0
    v_exp_f32 v16, v16
    v_exp_f32 v17, v17
    v_exp_f32 v18, v18
    v_exp_f32 v19, v19
    v_cvt_pk_bf16_f32 v80, v16, v17
    v_exp_f32 v20, v20
    v_exp_f32 v21, v21
    v_cvt_pk_bf16_f32 v81, v18, v19
    v_mfma_f32_32x32x16_bf16 v[64:79], v[112:115], v[88:91], v[64:79]
    v_exp_f32 v22, v22
    v_exp_f32 v23, v23
    v_cvt_pk_bf16_f32 v82, v20, v21
    v_exp_f32 v24, v24
    v_exp_f32 v25, v25
    v_cvt_pk_bf16_f32 v83, v22, v23
    v_exp_f32 v26, v26
    v_exp_f32 v27, v27
    v_mfma_f32_32x32x16_bf16 v[64:79], v[116:119], v[92:95], v[64:79]
    v_cvt_pk_bf16_f32 v84, v24, v25
    v_exp_f32 v28, v28
    v_exp_f32 v29, v29
    v_cvt_pk_bf16_f32 v85, v26, v27
    v_exp_f32 v30, v30
    v_exp_f32 v31, v31
    v_cvt_pk_bf16_f32 v86, v28, v29
    v_cvt_pk_bf16_f32 v87, v30, v31
    v_exp_f32 v32, v32
    v_exp_f32 v33, v33
    v_exp_f32 v34, v34
    v_exp_f32 v35, v35
    v_cvt_pk_bf16_f32 v88, v32, v33
    v_exp_f32 v36, v36
    v_exp_f32 v37, v37
    v_cvt_pk_bf16_f32 v89, v34, v35
    v_mfma_f32_32x32x16_bf16 v[48:63], v[120:123], v[80:83], v[48:63]
    v_exp_f32 v38, v38
    v_exp_f32 v39, v39
    v_cvt_pk_bf16_f32 v90, v36, v37
    v_exp_f32 v40, v40
    v_exp_f32 v41, v41
    v_cvt_pk_bf16_f32 v91, v38, v39
    v_exp_f32 v42, v42
    v_exp_f32 v43, v43
    v_mfma_f32_32x32x16_bf16 v[48:63], v[124:127], v[84:87], v[48:63]
    s_waitcnt lgkmcnt(0)
    v_cvt_pk_bf16_f32 v92, v40, v41
    v_exp_f32 v44, v44
    v_exp_f32 v45, v45
    v_cvt_pk_bf16_f32 v93, v42, v43
    v_exp_f32 v46, v46
    v_exp_f32 v47, v47
    v_cvt_pk_bf16_f32 v94, v44, v45
    v_cvt_pk_bf16_f32 v95, v46, v47
    v_mfma_f32_32x32x16_bf16 v[64:79], v[120:123], v[88:91], v[64:79]
    s_nop 0
    v_mfma_f32_32x32x16_bf16 v[64:79], v[124:127], v[92:95], v[64:79]
    s_waitcnt vmcnt(1)
    v_subrev_u32 v9, s50, v14
    v_subrev_u32 v9, 16, v9
    v_cmp_le_u32 vcc, 8, v9
    v_cmp_ne_u32 s[28:29], s3, v15
    s_nop 0
    s_or_b64 vcc, vcc, s[28:29]
    s_mov_b32 s45, 0x10000
    s_cbranch_vccz L_xd_interleave_layers__grouped_kv_mqa__sliding_local_dilated__prompt_kernel
L_xp_interleave_layers__grouped_kv_mqa__sliding_local_dilated__prompt_kernel:
    buffer_load_dwordx2 v[14:15], v13, s[8:11], s38 offen sc1
    s_waitcnt vmcnt(0)
    v_subrev_u32 v9, s50, v14
    v_subrev_u32 v9, 16, v9
    v_cmp_le_u32 vcc, 8, v9
    v_cmp_ne_u32 s[28:29], s3, v15
    s_nop 0
    s_or_b64 vcc, vcc, s[28:29]
    s_sub_u32 s45, s45, 1
    s_cmp_eq_u32 s45, 0
    s_cbranch_scc1 L_xd_interleave_layers__grouped_kv_mqa__sliding_local_dilated__prompt_kernel
    s_cbranch_vccnz L_xp_interleave_layers__grouped_kv_mqa__sliding_local_dilated__prompt_kernel
L_xd_interleave_layers__grouped_kv_mqa__sliding_local_dilated__prompt_kernel:
    v_cmp_ne_u32 s[42:43], s95, v14
    s_nop 1
    s_and_b32 s40, s42, 0xff
    s_mov_b32 s41, 0
    v_pk_mul_f32 v[10:11], v[48:49], 0 op_sel_hi:[1,0]
    v_pk_fma_f32 v[10:11], v[50:51], 0, v[10:11] op_sel_hi:[1,0,1]
    v_pk_fma_f32 v[10:11], v[52:53], 0, v[10:11] op_sel_hi:[1,0,1]
    v_pk_fma_f32 v[10:11], v[54:55], 0, v[10:11] op_sel_hi:[1,0,1]
    v_pk_fma_f32 v[10:11], v[64:65], 0, v[10:11] op_sel_hi:[1,0,1]
    v_pk_fma_f32 v[10:11], v[66:67], 0, v[10:11] op_sel_hi:[1,0,1]
    v_pk_fma_f32 v[10:11], v[68:69], 0, v[10:11] op_sel_hi:[1,0,1]
    v_pk_fma_f32 v[10:11], v[70:71], 0, v[10:11] op_sel_hi:[1,0,1]
    v_mov_b32 v9, v11
    v_add_f32 v9, v9, v10
    v_min_f32 v10, v56, v72
    v_max_f32 v11, v56, v72
    v_add_f32 v10, v10, v9
    v_add_f32 v11, v11, v9
    v_cmp_u_f32 s[28:29], v56, v72
    v_mov_b32 v20, 0x2b800000
    v_cmp_nge_f32 vcc, v10, v20
    s_nop 0
    s_or_b64 s[28:29], s[28:29], vcc
    v_mov_b32 v20, 0x71800000
    v_cmp_nle_f32 vcc, v11, v20
    s_nop 0
    s_or_b64 s[28:29], s[28:29], vcc
    s_cmp_eq_u64 s[28:29], 0
    s_cbranch_scc1 L_attok_interleave_layers__grouped_kv_mqa__sliding_local_dilated__prompt_kernel
    v_subrev_u32 v2, 32768, v2
    v_subrev_u32 v3, 33792, v3
    v_subrev_u32 v4, 33792, v4
    v_mov_b32 v9, 0xff61b1e6
    v_mov_b32 v10, 0xff61b1e6
    v_mov_b32 v11, v2
    s_mov_b32 s44, 0
L_max_interleave_layers__grouped_kv_mqa__sliding_local_dilated__prompt_kernel:
    ds_read_b128 v[104:107], v11
    s_waitcnt lgkmcnt(0)
    v_mfma_f32_32x32x16_bf16 v[16:31], v[104:107], v[96:99], 0
    v_mfma_f32_32x32x16_bf16 v[32:47], v[104:107], v[100:103], 0
    v_add_u32 v11, 1024, v11
    s_nop 9
    v_max3_f32 v9, v9, v16, v17
    v_max3_f32 v9, v9, v18, v19
    v_max3_f32 v9, v9, v20, v21
    v_max3_f32 v9, v9, v22, v23
    v_max3_f32 v9, v9, v24, v25
    v_max3_f32 v9, v9, v26, v27
    v_max3_f32 v9, v9, v28, v29
    v_max3_f32 v9, v9, v30, v31
    v_max3_f32 v10, v10, v32, v33
    v_max3_f32 v10, v10, v34, v35
    v_max3_f32 v10, v10, v36, v37
    v_max3_f32 v10, v10, v38, v39
    v_max3_f32 v10, v10, v40, v41
    v_max3_f32 v10, v10, v42, v43
    v_max3_f32 v10, v10, v44, v45
    v_max3_f32 v10, v10, v46, v47
    s_add_u32 s44, s44, 1
    s_cmp_lt_u32 s44, 64
    s_cbranch_scc1 L_max_interleave_layers__grouped_kv_mqa__sliding_local_dilated__prompt_kernel
    v_mov_b32 v11, v9
    s_nop 1
    v_permlane32_swap_b32 v11, v9
    v_max_f32 v9, v9, v11
    v_mov_b32 v11, v10
    s_nop 1
    v_permlane32_swap_b32 v11, v10
    v_max_f32 v10, v10, v11
    v_mov_b32 v48, 0
    v_mov_b32 v64, 0
    v_mov_b32 v49, 0
    v_mov_b32 v65, 0
    v_mov_b32 v50, 0
    v_mov_b32 v66, 0
    v_mov_b32 v51, 0
    v_mov_b32 v67, 0
    v_mov_b32 v52, 0
    v_mov_b32 v68, 0
    v_mov_b32 v53, 0
    v_mov_b32 v69, 0
    v_mov_b32 v54, 0
    v_mov_b32 v70, 0
    v_mov_b32 v55, 0
    v_mov_b32 v71, 0
    v_mov_b32 v56, 0
    v_mov_b32 v72, 0
    v_mov_b32 v57, 0
    v_mov_b32 v73, 0
    v_mov_b32 v58, 0
    v_mov_b32 v74, 0
    v_mov_b32 v59, 0
    v_mov_b32 v75, 0
    v_mov_b32 v60, 0
    v_mov_b32 v76, 0
    v_mov_b32 v61, 0
    v_mov_b32 v77, 0
    v_mov_b32 v62, 0
    v_mov_b32 v78, 0
    v_mov_b32 v63, 0
    v_mov_b32 v79, 0
    v_mov_b32 v88, 0
    v_mov_b32 v120, 0
    v_mov_b32 v89, 0
    v_mov_b32 v121, 0
    v_mov_b32 v90, 0
    v_mov_b32 v122, 0
    v_mov_b32 v91, 0
    v_mov_b32 v123, 0
    v_mov_b32 v92, 0
    v_mov_b32 v124, 0
    v_mov_b32 v93, 0
    v_mov_b32 v125, 0
    v_mov_b32 v94, 0
    v_mov_b32 v126, 0
    v_mov_b32 v95, 0
    v_mov_b32 v127, 0
    ds_read_b128 v[104:107], v2 offset:0
    ds_read_b128 v[108:111], v2 offset:1024
    ds_read_b128 v[112:115], v3 offset:0
    ds_read_b128 v[116:119], v4 offset:0
    s_waitcnt lgkmcnt(0)
    v_mfma_f32_32x32x16_bf16 v[16:31], v[104:107], v[96:99], 0
    s_mov_b32 s44, 0
L_att2_interleave_layers__grouped_kv_mqa__sliding_local_dilated__prompt_kernel:
    v_mfma_f32_32x32x16_bf16 v[32:47], v[104:107], v[100:103], 0
    ds_read_b128 v[104:107], v2 offset:2048
    s_nop 8
    v_sub_f32 v16, v16, v9
    v_sub_f32 v17, v17, v9
    v_sub_f32 v18, v18, v9
    v_sub_f32 v19, v19, v9
    v_sub_f32 v20, v20, v9
    v_sub_f32 v21, v21, v9
    v_sub_f32 v22, v22, v9
    v_sub_f32 v23, v23, v9
    v_sub_f32 v24, v24, v9
    v_sub_f32 v25, v25, v9
    v_sub_f32 v26, v26, v9
    v_sub_f32 v27, v27, v9
    v_sub_f32 v28, v28, v9
    v_mfma_f32_32x32x16_bf16 v[64:79], v[120:123], v[88:91], v[64:79]
    ds_read_b128 v[120:123], v3 offset:1056
    v_sub_f32 v29, v29, v9
    v_sub_f32 v30, v30, v9
    v_sub_f32 v31, v31, v9
    v_exp_f32 v16, v16
    v_exp_f32 v17, v17
    v_exp_f32 v18, v18
    v_exp_f32 v19, v19
    v_cvt_pk_bf16_f32 v80, v16, v17
    v_exp_f32 v20, v20
    v_exp_f32 v21, v21
    v_cvt_pk_bf16_f32 v81, v18, v19
    v_exp_f32 v22, v22
    v_exp_f32 v23, v23
    v_mfma_f32_32x32x16_bf16 v[64:79], v[124:127], v[92:95], v[64:79]
    ds_read_b128 v[124:127], v4 offset:1056
    v_cvt_pk_bf16_f32 v82, v20, v21
    v_exp_f32 v24, v24
    v_exp_f32 v25, v25
    v_cvt_pk_bf16_f32 v83, v22, v23
    v_exp_f32 v26, v26
    v_exp_f32 v27, v27
    v_cvt_pk_bf16_f32 v84, v24, v25
    v_exp_f32 v28, v28
    v_exp_f32 v29, v29
    v_cvt_pk_bf16_f32 v85, v26, v27
    v_exp_f32 v30, v30
    v_exp_f32 v31, v31
    v_cvt_pk_bf16_f32 v86, v28, v29
    v_cvt_pk_bf16_f32 v87, v30, v31
    v_mfma_f32_32x32x16_bf16 v[16:31], v[108:111], v[96:99], 0
    v_sub_f32 v32, v32, v10
    v_sub_f32 v33, v33, v10
    v_sub_f32 v34, v34, v10
    v_sub_f32 v35, v35, v10
    v_sub_f32 v36, v36, v10
    v_sub_f32 v37, v37, v10
    v_sub_f32 v38, v38, v10
    v_sub_f32 v39, v39, v10
    v_sub_f32 v40, v40, v10
    v_sub_f32 v41, v41, v10
    v_sub_f32 v42, v42, v10
    v_sub_f32 v43, v43, v10
    v_sub_f32 v44, v44, v10
    v_mfma_f32_32x32x16_bf16 v[48:63], v[112:115], v[80:83], v[48:63]
    v_sub_f32 v45, v45, v10
    v_sub_f32 v46, v46, v10
    v_sub_f32 v47, v47, v10
    v_exp_f32 v32, v32
    v_exp_f32 v33, v33
    v_exp_f32 v34, v34
    v_exp_f32 v35, v35
    v_cvt_pk_bf16_f32 v88, v32, v33
    v_exp_f32 v36, v36
    v_exp_f32 v37, v37
    v_cvt_pk_bf16_f32 v89, v34, v35
    v_exp_f32 v38, v38
    v_exp_f32 v39, v39
    v_mfma_f32_32x32x16_bf16 v[48:63], v[116:119], v[84:87], v[48:63]
    s_waitcnt lgkmcnt(0)
    v_cvt_pk_bf16_f32 v90, v36, v37
    v_exp_f32 v40, v40
    v_exp_f32 v41, v41
    v_cvt_pk_bf16_f32 v91, v38, v39
    v_exp_f32 v42, v42
    v_exp_f32 v43, v43
    v_cvt_pk_bf16_f32 v92, v40, v41
    v_exp_f32 v44, v44
    v_exp_f32 v45, v45
    v_cvt_pk_bf16_f32 v93, v42, v43
    v_exp_f32 v46, v46
    v_exp_f32 v47, v47
    v_cvt_pk_bf16_f32 v94, v44, v45
    v_cvt_pk_bf16_f32 v95, v46, v47
    v_mfma_f32_32x32x16_bf16 v[32:47], v[108:111], v[100:103], 0
    ds_read_b128 v[108:111], v2 offset:3072
    v_sub_f32 v16, v16, v9
    v_sub_f32 v17, v17, v9
    v_sub_f32 v18, v18, v9
    v_sub_f32 v19, v19, v9
    v_sub_f32 v20, v20, v9
    v_sub_f32 v21, v21, v9
    v_sub_f32 v22, v22, v9
    v_sub_f32 v23, v23, v9
    v_sub_f32 v24, v24, v9
    v_sub_f32 v25, v25, v9
    v_sub_f32 v26, v26, v9
    v_sub_f32 v27, v27, v9
    v_sub_f32 v28, v28, v9
    v_mfma_f32_32x32x16_bf16 v[64:79], v[112:115], v[88:91], v[64:79]
    ds_read_b128 v[112:115], v3 offset:2112
    v_sub_f32 v29, v29, v9
    v_sub_f32 v30, v30, v9
    v_sub_f32 v31, v31, v9
    v_exp_f32 v16, v16
    v_exp_f32 v17, v17
    v_exp_f32 v18, v18
    v_exp_f32 v19, v19
    v_cvt_pk_bf16_f32 v80, v16, v17
    v_exp_f32 v20, v20
    v_exp_f32 v21, v21
    v_cvt_pk_bf16_f32 v81, v18, v19
    v_exp_f32 v22, v22
    v_exp_f32 v23, v23
    v_mfma_f32_32x32x16_bf16 v[64:79], v[116:119], v[92:95], v[64:79]
    ds_read_b128 v[116:119], v4 offset:2112
    v_cvt_pk_bf16_f32 v82, v20, v21
    v_exp_f32 v24, v24
    v_exp_f32 v25, v25
    v_cvt_pk_bf16_f32 v83, v22, v23
    v_exp_f32 v26, v26
    v_exp_f32 v27, v27
    v_cvt_pk_bf16_f32 v84, v24, v25
    v_exp_f32 v28, v28
    v_exp_f32 v29, v29
    v_cvt_pk_bf16_f32 v85, v26, v27
    v_exp_f32 v30, v30
    v_exp_f32 v31, v31
    v_cvt_pk_bf16_f32 v86, v28, v29
    v_cvt_pk_bf16_f32 v87, v30, v31
    v_mfma_f32_32x32x16_bf16 v[16:31], v[104:107], v[96:99], 0
    v_sub_f32 v32, v32, v10
    v_sub_f32 v33, v33, v10
    v_sub_f32 v34, v34, v10
    v_sub_f32 v35, v35, v10
    v_sub_f32 v36, v36, v10
    v_sub_f32 v37, v37, v10
    v_sub_f32 v38, v38, v10
    v_sub_f32 v39, v39, v10
    v_sub_f32 v40, v40, v10
    v_sub_f32 v41, v41, v10
    v_sub_f32 v42, v42, v10
    v_sub_f32 v43, v43, v10
    v_sub_f32 v44, v44, v10
    v_mfma_f32_32x32x16_bf16 v[48:63], v[120:123], v[80:83], v[48:63]
    v_sub_f32 v45, v45, v10
    v_sub_f32 v46, v46, v10
    v_sub_f32 v47, v47, v10
    v_exp_f32 v32, v32
    v_exp_f32 v33, v33
    v_exp_f32 v34, v34
    v_exp_f32 v35, v35
    v_cvt_pk_bf16_f32 v88, v32, v33
    v_exp_f32 v36, v36
    v_exp_f32 v37, v37
    v_cvt_pk_bf16_f32 v89, v34, v35
    v_exp_f32 v38, v38
    v_exp_f32 v39, v39
    v_mfma_f32_32x32x16_bf16 v[48:63], v[124:127], v[84:87], v[48:63]
    s_waitcnt lgkmcnt(0)
    v_cvt_pk_bf16_f32 v90, v36, v37
    v_exp_f32 v40, v40
    v_exp_f32 v41, v41
    v_cvt_pk_bf16_f32 v91, v38, v39
    v_exp_f32 v42, v42
    v_exp_f32 v43, v43
    v_cvt_pk_bf16_f32 v92, v40, v41
    v_exp_f32 v44, v44
    v_exp_f32 v45, v45
    v_cvt_pk_bf16_f32 v93, v42, v43
    v_exp_f32 v46, v46
    v_exp_f32 v47, v47
    v_cvt_pk_bf16_f32 v94, v44, v45
    v_cvt_pk_bf16_f32 v95, v46, v47
    v_add_u32 v2, 2048, v2
    v_add_u32 v3, 2112, v3
    v_add_u32 v4, 2112, v4
    s_add_u32 s44, s44, 1
    s_cmp_lt_u32 s44, 32
    s_cbranch_scc1 L_att2_interleave_layers__grouped_kv_mqa__sliding_local_dilated__prompt_kernel
    v_mfma_f32_32x32x16_bf16 v[64:79], v[120:123], v[88:91], v[64:79]
    v_mfma_f32_32x32x16_bf16 v[64:79], v[124:127], v[92:95], v[64:79]
L_attok_interleave_layers__grouped_kv_mqa__sliding_local_dilated__prompt_kernel:
    s_lshl_b32 s23, s21, 11
    s_lshr_b32 s24, s22, 1
    s_lshl_b32 s24, s24, 10
    s_add_u32 s23, s23, s24
    s_and_b32 s24, s22, 1
    s_lshl_b32 s24, s24, 9
    s_add_u32 s23, s23, s24
    s_lshl_b32 s24, s20, 16
    s_add_u32 s23, s23, s24
    s_add_u32 s23, s23, s52
    v_and_b32 v9, 15, v0
    v_lshlrev_b32 v9, 4, v9
    v_lshrrev_b32 v10, 5, v0
    v_lshl_add_u32 v9, v10, 3, v9
    v_bfe_u32 v10, v0, 4, 1
    v_lshl_add_u32 v9, v10, 14, v9
    v_rcp_f32 v12, v56
    v_rcp_f32 v14, v72
    s_mov_b64 vcc, s[40:41]
    v_pk_mul_f32 v[48:49], v[48:49], v[12:13] op_sel_hi:[1,0]
    v_pk_mul_f32 v[50:51], v[50:51], v[12:13] op_sel_hi:[1,0]
    v_pk_mul_f32 v[52:53], v[52:53], v[12:13] op_sel_hi:[1,0]
    v_pk_mul_f32 v[54:55], v[54:55], v[12:13] op_sel_hi:[1,0]
    v_cvt_pk_bf16_f32 v16, v48, v49
    v_cvt_pk_bf16_f32 v17, v50, v51
    v_cvt_pk_bf16_f32 v18, v52, v53
    v_cvt_pk_bf16_f32 v19, v54, v55
    s_cbranch_vccnz L_slow_1
    buffer_store_dwordx2 v[16:17], v9, s[8:11], s23 offen
L_back_1:
    s_cbranch_vccnz L_slow_2
    buffer_store_dwordx2 v[18:19], v9, s[8:11], s23 offen offset:256
L_back_2:
    s_add_u32 s23, s23, 32768
    v_pk_mul_f32 v[64:65], v[64:65], v[14:15] op_sel_hi:[1,0]
    v_pk_mul_f32 v[66:67], v[66:67], v[14:15] op_sel_hi:[1,0]
    v_pk_mul_f32 v[68:69], v[68:69], v[14:15] op_sel_hi:[1,0]
    v_pk_mul_f32 v[70:71], v[70:71], v[14:15] op_sel_hi:[1,0]
    v_cvt_pk_bf16_f32 v20, v64, v65
    v_cvt_pk_bf16_f32 v21, v66, v67
    v_cvt_pk_bf16_f32 v22, v68, v69
    v_cvt_pk_bf16_f32 v23, v70, v71
    s_cbranch_vccnz L_slow_3
    buffer_store_dwordx2 v[20:21], v9, s[8:11], s23 offen
L_back_3:
    s_cbranch_vccnz L_slow_4
    buffer_store_dwordx2 v[22:23], v9, s[8:11], s23 offen offset:256
L_back_4:
    s_waitcnt vmcnt(0)
    s_barrier
    s_cmp_lg_u32 s22, 0
    s_cbranch_scc1 L_np0_interleave_layers__grouped_kv_mqa__sliding_local_dilated__prompt_kernel
    s_lshl_b32 s23, s20, 7
    s_lshl_b32 s28, s21, 3
    s_add_u32 s23, s23, s28
    s_add_u32 s23, s23, s56
    s_add_u32 s23, s23, 0
    v_mov_b32 v61, 0
    v_mov_b32 v62, s50
    v_mov_b32 v63, s3
    s_mov_b64 vcc, s[40:41]
    s_mov_b64 exec, 1
    s_cbranch_vccnz L_slow_5
    buffer_store_dwordx2 v[62:63], v61, s[8:11], s23 offen
L_back_5:
    s_mov_b64 exec, -1
L_np0_interleave_layers__grouped_kv_mqa__sliding_local_dilated__prompt_kernel:
    v_and_b32 v6, 15, v0
    v_lshrrev_b32 v7, 4, v0
    v_mov_b32 v8, 0x3f803f80
    v_mov_b32 v9, 0x3f803f80
    v_mov_b32 v10, 0x3f803f80
    v_mov_b32 v11, 0x3f803f80
    s_lshl_b32 s23, s21, 11
    s_lshr_b32 s28, s22, 1
    s_lshl_b32 s28, s28, 10
    s_add_u32 s23, s23, s28
    s_and_b32 s28, s22, 1
    s_lshl_b32 s28, s28, 9
    s_add_u32 s23, s23, s28
    v_lshrrev_b32 v48, 1, v7
    v_lshlrev_b32 v48, 8, v48
    v_lshl_add_u32 v48, v6, 4, v48
    v_and_b32 v44, 1, v7
    v_lshl_add_u32 v44, v44, 3, v48
    v_add_u32 v44, s23, v44
    v_mov_b32 v99, v44
    s_lshl_b32 s26, s20, 2
    s_mul_i32 s23, s16, 4
    v_add_u32 v2, s23, v1
    s_mul_i32 s23, s17, 4
    v_add_u32 v3, s23, v1
    s_mul_i32 s23, s18, 4
    v_add_u32 v4, s23, v1
    s_mul_i32 s23, s19, 4
    v_add_u32 v5, s23, v1
    v_lshlrev_b32 v64, 16, v252
    v_and_b32 v65, 0xffff0000, v252
    v_lshlrev_b32 v66, 16, v253
    v_and_b32 v67, 0xffff0000, v253
    v_lshlrev_b32 v68, 16, v246
    v_and_b32 v69, 0xffff0000, v246
    v_lshlrev_b32 v70, 16, v247
    v_and_b32 v71, 0xffff0000, v247
    v_lshlrev_b32 v72, 16, v248
    v_and_b32 v73, 0xffff0000, v248
    v_lshlrev_b32 v74, 16, v249
    v_and_b32 v75, 0xffff0000, v249
    v_lshlrev_b32 v76, 16, v250
    v_and_b32 v77, 0xffff0000, v250
    v_lshlrev_b32 v78, 16, v251
    v_and_b32 v79, 0xffff0000, v251
    v_mfma_f32_16x16x32_bf16 v[112:115], a[0:3], v[8:11], 0
    v_mfma_f32_16x16x32_bf16 v[112:115], a[4:7], v[8:11], v[112:115]
    v_mfma_f32_16x16x32_bf16 v[112:115], a[8:11], v[8:11], v[112:115]
    v_mfma_f32_16x16x32_bf16 v[112:115], a[12:15], v[8:11], v[112:115]
    v_mfma_f32_16x16x32_bf16 v[112:115], a[16:19], v[8:11], v[112:115]
    v_mfma_f32_16x16x32_bf16 v[112:115], a[20:23], v[8:11], v[112:115]
    v_mfma_f32_16x16x32_bf16 v[112:115], a[24:27], v[8:11], v[112:115]
    v_mfma_f32_16x16x32_bf16 v[112:115], a[28:31], v[8:11], v[112:115]
    v_mfma_f32_16x16x32_bf16 v[112:115], a[32:35], v[8:11], v[112:115]
    v_mfma_f32_16x16x32_bf16 v[112:115], a[36:39], v[8:11], v[112:115]
    v_mfma_f32_16x16x32_bf16 v[112:115], a[40:43], v[8:11], v[112:115]
    v_mfma_f32_16x16x32_bf16 v[112:115], a[44:47], v[8:11], v[112:115]
    v_mfma_f32_16x16x32_bf16 v[112:115], a[48:51], v[8:11], v[112:115]
    v_mfma_f32_16x16x32_bf16 v[112:115], a[52:55], v[8:11], v[112:115]
    v_mfma_f32_16x16x32_bf16 v[112:115], a[56:59], v[8:11], v[112:115]
    v_mfma_f32_16x16x32_bf16 v[112:115], a[60:63], v[8:11], v[112:115]
    s_mul_i32 s25, s22, 16384
    s_add_u32 s25, s25, 0
    s_lshl_b32 s24, s22, 12
    s_add_u32 s24, s24, s52
    v_and_b32 v61, 7, v0
    v_lshlrev_b32 v61, 3, v61
    s_lshl_b32 s23, s20, 7
    v_add_u32 v61, s23, v61
    s_add_u32 s45, s56, 0
    v_add_u32 v61, s45, v61
    buffer_load_dwordx2 v[62:63], v61, s[8:11], 0 offen sc1
    v_mov_b32 v50, 0xf149f2ca
    v_lshl_add_u32 v48, v7, 2, 0
    v_sub_u32 v48, v6, v48
    v_and_b32 v49, 0x80000001, v48
    v_cmp_eq_u32 s[28:29], 0, v49
    s_nop 1
    v_cndmask_b32_e64 v100, v50, 0, s[28:29]
    v_cmp_gt_i32 s[38:39], -1, v48
    v_and_b32 v49, 1, v48
    v_cmp_eq_u32 s[28:29], 0, v49
    s_nop 0
    s_and_b64 s[28:29], s[28:29], s[38:39]
    v_cndmask_b32_e64 v104, v50, 0, s[28:29]
    v_lshl_add_u32 v48, v7, 2, 1
    v_sub_u32 v48, v6, v48
    v_and_b32 v49, 0x80000001, v48
    v_cmp_eq_u32 s[28:29], 0, v49
    s_nop 1
    v_cndmask_b32_e64 v101, v50, 0, s[28:29]
    v_cmp_gt_i32 s[38:39], -1, v48
    v_and_b32 v49, 1, v48
    v_cmp_eq_u32 s[28:29], 0, v49
    s_nop 0
    s_and_b64 s[28:29], s[28:29], s[38:39]
    v_cndmask_b32_e64 v105, v50, 0, s[28:29]
    v_lshl_add_u32 v48, v7, 2, 2
    v_sub_u32 v48, v6, v48
    v_and_b32 v49, 0x80000001, v48
    v_cmp_eq_u32 s[28:29], 0, v49
    s_nop 1
    v_cndmask_b32_e64 v102, v50, 0, s[28:29]
    v_cmp_gt_i32 s[38:39], -1, v48
    v_and_b32 v49, 1, v48
    v_cmp_eq_u32 s[28:29], 0, v49
    s_nop 0
    s_and_b64 s[28:29], s[28:29], s[38:39]
    v_cndmask_b32_e64 v106, v50, 0, s[28:29]
    v_lshl_add_u32 v48, v7, 2, 3
    v_sub_u32 v48, v6, v48
    v_and_b32 v49, 0x80000001, v48
    v_cmp_eq_u32 s[28:29], 0, v49
    s_nop 1
    v_cndmask_b32_e64 v103, v50, 0, s[28:29]
    v_cmp_gt_i32 s[38:39], -1, v48
    v_and_b32 v49, 1, v48
    v_cmp_eq_u32 s[28:29], 0, v49
    s_nop 0
    s_and_b64 s[28:29], s[28:29], s[38:39]
    v_cndmask_b32_e64 v107, v50, 0, s[28:29]
    s_cmp_eq_u32 s20, 0
    s_cselect_b64 s[28:29], -1, 0
    v_cndmask_b32_e64 v108, v104, v50, s[28:29]
    v_cndmask_b32_e64 v109, v105, v50, s[28:29]
    v_cndmask_b32_e64 v110, v106, v50, s[28:29]
    v_cndmask_b32_e64 v111, v107, v50, s[28:29]
    v_mfma_f32_16x16x32_bf16 v[116:119], a[64:67], v[8:11], 0
    v_mfma_f32_16x16x32_bf16 v[116:119], a[68:71], v[8:11], v[116:119]
    v_mfma_f32_16x16x32_bf16 v[116:119], a[72:75], v[8:11], v[116:119]
    v_mfma_f32_16x16x32_bf16 v[116:119], a[76:79], v[8:11], v[116:119]
    v_mfma_f32_16x16x32_bf16 v[116:119], a[80:83], v[8:11], v[116:119]
    v_mfma_f32_16x16x32_bf16 v[116:119], a[84:87], v[8:11], v[116:119]
    v_mfma_f32_16x16x32_bf16 v[116:119], a[88:91], v[8:11], v[116:119]
    v_mfma_f32_16x16x32_bf16 v[116:119], a[92:95], v[8:11], v[116:119]
    v_mfma_f32_16x16x32_bf16 v[116:119], a[96:99], v[8:11], v[116:119]
    v_mfma_f32_16x16x32_bf16 v[116:119], a[100:103], v[8:11], v[116:119]
    v_mfma_f32_16x16x32_bf16 v[116:119], a[104:107], v[8:11], v[116:119]
    v_mfma_f32_16x16x32_bf16 v[116:119], a[108:111], v[8:11], v[116:119]
    v_mfma_f32_16x16x32_bf16 v[116:119], a[112:115], v[8:11], v[116:119]
    v_mfma_f32_16x16x32_bf16 v[116:119], a[116:119], v[8:11], v[116:119]
    v_mfma_f32_16x16x32_bf16 v[116:119], a[120:123], v[8:11], v[116:119]
    v_mfma_f32_16x16x32_bf16 v[116:119], a[124:127], v[8:11], v[116:119]
    s_waitcnt vmcnt(0)
    v_cmp_ne_u32 vcc, s50, v62
    v_cmp_ne_u32 s[28:29], s3, v63
    s_nop 0
    s_or_b64 vcc, vcc, s[28:29]
    s_cbranch_vccz L_seen0_interleave_layers__grouped_kv_mqa__sliding_local_dilated__prompt_kernel_1
    s_mov_b32 s45, 0x10000
L_poll0_interleave_layers__grouped_kv_mqa__sliding_local_dilated__prompt_kernel_1:
    buffer_load_dwordx2 v[62:63], v61, s[8:11], 0 offen sc1
    s_waitcnt vmcnt(0)
    v_cmp_ne_u32 vcc, s50, v62
    v_cmp_ne_u32 s[28:29], s3, v63
    s_nop 0
    s_or_b64 vcc, vcc, s[28:29]
    s_sub_u32 s45, s45, 1
    s_cmp_eq_u32 s45, 0
    s_cbranch_scc1 L_poll0_interleave_layers__grouped_kv_mqa__sliding_local_dilated__prompt_kernel_1_d
    s_cbranch_vccnz L_poll0_interleave_layers__grouped_kv_mqa__sliding_local_dilated__prompt_kernel_1
L_poll0_interleave_layers__grouped_kv_mqa__sliding_local_dilated__prompt_kernel_1_d:
L_seen0_interleave_layers__grouped_kv_mqa__sliding_local_dilated__prompt_kernel_1:
    s_mov_b64 vcc, s[40:41]
    s_add_u32 s23, s26, 3
    s_lshl_b32 s23, s23, 14
    s_add_u32 s27, s23, s24
    s_add_u32 m0, s25, 0
    s_nop 0
    buffer_load_dwordx4 v1, s[8:11], s27 offen offset:0 sc1 lds
    buffer_load_dwordx4 v1, s[8:11], s27 offen offset:1024 sc1 lds
    buffer_load_dwordx4 v1, s[8:11], s27 offen offset:2048 sc1 lds
    buffer_load_dwordx4 v1, s[8:11], s27 offen offset:3072 sc1 lds
    s_barrier
    s_add_u32 s23, s26, 0
    s_lshl_b32 s23, s23, 14
    s_add_u32 s27, s23, s24
    s_add_u32 m0, s25, 4096
    s_nop 0
    buffer_load_dwordx4 v1, s[8:11], s27 offen offset:0 sc1 lds
    buffer_load_dwordx4 v1, s[8:11], s27 offen offset:1024 sc1 lds
    buffer_load_dwordx4 v1, s[8:11], s27 offen offset:2048 sc1 lds
    buffer_load_dwordx4 v1, s[8:11], s27 offen offset:3072 sc1 lds
    s_barrier
    s_add_u32 s23, s26, 1
    s_lshl_b32 s23, s23, 14
    s_add_u32 s27, s23, s24
    s_add_u32 m0, s25, 8192
    s_nop 0
    buffer_load_dwordx4 v1, s[8:11], s27 offen offset:0 sc1 lds
    buffer_load_dwordx4 v1, s[8:11], s27 offen offset:1024 sc1 lds
    buffer_load_dwordx4 v1, s[8:11], s27 offen offset:2048 sc1 lds
    buffer_load_dwordx4 v1, s[8:11], s27 offen offset:3072 sc1 lds
    s_waitcnt vmcnt(8)
    s_barrier
    ds_read_b128 v[12:15], v2 offset:0
    ds_read_b128 v[16:19], v2 offset:1024
    ds_read_b128 v[20:23], v2 offset:2048
    ds_read_b128 v[24:27], v2 offset:3072
    ds_read_b128 v[28:31], v3 offset:0
    ds_read_b128 v[32:35], v3 offset:1024
    ds_read_b128 v[36:39], v3 offset:2048
    ds_read_b128 v[40:43], v3 offset:3072
    s_waitcnt lgkmcnt(6)
    v_mfma_f32_16x16x32_bf16 v[64:67], a[192:195], v[12:15], v[64:67]
    ds_read_b128 v[12:15], v4 offset:0
    s_add_u32 s23, s26, 2
    s_lshl_b32 s23, s23, 14
    s_add_u32 s27, s23, s24
    s_add_u32 m0, s25, 12288
    s_nop 0
    buffer_load_dwordx4 v1, s[8:11], s27 offen offset:0 sc1 lds
    v_mfma_f32_16x16x32_bf16 v[64:67], a[196:199], v[16:19], v[64:67]
    ds_read_b128 v[16:19], v4 offset:1024
    buffer_load_dwordx4 v1, s[8:11], s27 offen offset:1024 sc1 lds
    s_waitcnt lgkmcnt(6)
    v_mfma_f32_16x16x32_bf16 v[64:67], a[200:203], v[20:23], v[64:67]
    ds_read_b128 v[20:23], v4 offset:2048
    buffer_load_dwordx4 v1, s[8:11], s27 offen offset:2048 sc1 lds
    v_mfma_f32_16x16x32_bf16 v[64:67], a[204:207], v[24:27], v[64:67]
    ds_read_b128 v[24:27], v4 offset:3072
    buffer_load_dwordx4 v1, s[8:11], s27 offen offset:3072 sc1 lds
    s_waitcnt lgkmcnt(6)
    v_mfma_f32_16x16x32_bf16 v[64:67], a[208:211], v[28:31], v[64:67]
    ds_read_b128 v[28:31], v5 offset:0
    v_mfma_f32_16x16x32_bf16 v[64:67], a[212:215], v[32:35], v[64:67]
    ds_read_b128 v[32:35], v5 offset:1024
    s_waitcnt lgkmcnt(6)
    v_mfma_f32_16x16x32_bf16 v[64:67], a[216:219], v[36:39], v[64:67]
    ds_read_b128 v[36:39], v5 offset:2048
    v_mfma_f32_16x16x32_bf16 v[64:67], a[220:223], v[40:43], v[64:67]
    ds_read_b128 v[40:43], v5 offset:3072
    s_waitcnt lgkmcnt(6)
    v_mfma_f32_16x16x32_bf16 v[64:67], a[224:227], v[12:15], v[64:67]
    s_waitcnt vmcnt(8)
    s_barrier
    ds_read_b128 v[12:15], v2 offset:4096
    v_mfma_f32_16x16x32_bf16 v[64:67], a[228:231], v[16:19], v[64:67]
    ds_read_b128 v[16:19], v2 offset:5120
    s_waitcnt lgkmcnt(6)
    v_mfma_f32_16x16x32_bf16 v[64:67], a[232:235], v[20:23], v[64:67]
    ds_read_b128 v[20:23], v2 offset:6144
    v_mfma_f32_16x16x32_bf16 v[64:67], a[236:239], v[24:27], v[64:67]
    ds_read_b128 v[24:27], v2 offset:7168
    s_waitcnt lgkmcnt(6)
    v_mfma_f32_16x16x32_bf16 v[64:67], a[240:243], v[28:31], v[64:67]
    ds_read_b128 v[28:31], v3 offset:4096
    v_mfma_f32_16x16x32_bf16 v[64:67], a[244:247], v[32:35], v[64:67]
    ds_read_b128 v[32:35], v3 offset:5120
    s_waitcnt lgkmcnt(6)
    v_mfma_f32_16x16x32_bf16 v[64:67], a[248:251], v[36:39], v[64:67]
    ds_read_b128 v[36:39], v3 offset:6144
    v_mfma_f32_16x16x32_bf16 v[64:67], a[252:255], v[40:43], v[64:67]
    ds_read_b128 v[40:43], v3 offset:7168
    s_waitcnt lgkmcnt(6)
    v_mfma_f32_16x16x32_bf16 v[68:71], a[192:195], v[12:15], v[68:71]
    ds_read_b128 v[12:15], v4 offset:4096
    v_mfma_f32_16x16x32_bf16 v[68:71], a[196:199], v[16:19], v[68:71]
    ds_read_b128 v[16:19], v4 offset:5120
    s_waitcnt lgkmcnt(6)
    v_mfma_f32_16x16x32_bf16 v[68:71], a[200:203], v[20:23], v[68:71]
    ds_read_b128 v[20:23], v4 offset:6144
    v_mfma_f32_16x16x32_bf16 v[68:71], a[204:207], v[24:27], v[68:71]
    ds_read_b128 v[24:27], v4 offset:7168
    v_cvt_pk_bf16_f32 v252, v64, v65
    v_cvt_pk_bf16_f32 v253, v66, v67
    s_add_u32 s47, s26, 3
    s_lshl_b32 s47, s47, 14
    s_waitcnt lgkmcnt(6)
    v_mfma_f32_16x16x32_bf16 v[68:71], a[208:211], v[28:31], v[68:71]
    ds_read_b128 v[28:31], v5 offset:4096
    s_add_u32 s47, s47, s53
    s_mov_b64 vcc, s[42:43]
    v_mfma_f32_16x16x32_bf16 v[68:71], a[212:215], v[32:35], v[68:71]
    ds_read_b128 v[32:35], v5 offset:5120
    s_waitcnt lgkmcnt(6)
    v_mfma_f32_16x16x32_bf16 v[68:71], a[216:219], v[36:39], v[68:71]
    ds_read_b128 v[36:39], v5 offset:6144
    v_mfma_f32_16x16x32_bf16 v[68:71], a[220:223], v[40:43], v[68:71]
    ds_read_b128 v[40:43], v5 offset:7168
    s_cbranch_vccnz L_slow_6
    buffer_store_dwordx2 v[252:253], v44, s[8:11], s47 offen
L_back_6:
    s_waitcnt lgkmcnt(6)
    v_mfma_f32_16x16x32_bf16 v[68:71], a[224:227], v[12:15], v[68:71]
    s_mov_b64 vcc, s[40:41]
    s_waitcnt vmcnt(5)
    s_barrier
    ds_read_b128 v[12:15], v2 offset:8192
    v_mfma_f32_16x16x32_bf16 v[68:71], a[228:231], v[16:19], v[68:71]
    ds_read_b128 v[16:19], v2 offset:9216
    s_waitcnt lgkmcnt(6)
    v_mfma_f32_16x16x32_bf16 v[68:71], a[232:235], v[20:23], v[68:71]
    ds_read_b128 v[20:23], v2 offset:10240
    v_mfma_f32_16x16x32_bf16 v[68:71], a[236:239], v[24:27], v[68:71]
    ds_read_b128 v[24:27], v2 offset:11264
    s_waitcnt lgkmcnt(6)
    v_mfma_f32_16x16x32_bf16 v[68:71], a[240:243], v[28:31], v[68:71]
    ds_read_b128 v[28:31], v3 offset:8192
    v_mfma_f32_16x16x32_bf16 v[68:71], a[244:247], v[32:35], v[68:71]
    ds_read_b128 v[32:35], v3 offset:9216
    s_waitcnt lgkmcnt(6)
    v_mfma_f32_16x16x32_bf16 v[68:71], a[248:251], v[36:39], v[68:71]
    ds_read_b128 v[36:39], v3 offset:10240
    v_mfma_f32_16x16x32_bf16 v[68:71], a[252:255], v[40:43], v[68:71]
    ds_read_b128 v[40:43], v3 offset:11264
    s_waitcnt lgkmcnt(6)
    v_mfma_f32_16x16x32_bf16 v[72:75], a[192:195], v[12:15], v[72:75]
    ds_read_b128 v[12:15], v4 offset:8192
    v_mfma_f32_16x16x32_bf16 v[72:75], a[196:199], v[16:19], v[72:75]
    ds_read_b128 v[16:19], v4 offset:9216
    s_waitcnt lgkmcnt(6)
    v_mfma_f32_16x16x32_bf16 v[72:75], a[200:203], v[20:23], v[72:75]
    ds_read_b128 v[20:23], v4 offset:10240
    v_mfma_f32_16x16x32_bf16 v[72:75], a[204:207], v[24:27], v[72:75]
    ds_read_b128 v[24:27], v4 offset:11264
    v_cvt_pk_bf16_f32 v246, v68, v69
    v_cvt_pk_bf16_f32 v247, v70, v71
    s_add_u32 s47, s26, 0
    s_lshl_b32 s47, s47, 14
    s_waitcnt lgkmcnt(6)
    v_mfma_f32_16x16x32_bf16 v[72:75], a[208:211], v[28:31], v[72:75]
    ds_read_b128 v[28:31], v5 offset:8192
    s_add_u32 s47, s47, s53
    v_mfma_f32_16x16x32_bf16 v[72:75], a[212:215], v[32:35], v[72:75]
    ds_read_b128 v[32:35], v5 offset:9216
    s_waitcnt lgkmcnt(6)
    v_mfma_f32_16x16x32_bf16 v[72:75], a[216:219], v[36:39], v[72:75]
    ds_read_b128 v[36:39], v5 offset:10240
    v_mfma_f32_16x16x32_bf16 v[72:75], a[220:223], v[40:43], v[72:75]
    ds_read_b128 v[40:43], v5 offset:11264
    s_cbranch_vccnz L_slow_7
    buffer_store_dwordx2 v[246:247], v44, s[8:11], s47 offen
L_back_7:
    s_waitcnt lgkmcnt(6)
    v_mfma_f32_16x16x32_bf16 v[72:75], a[224:227], v[12:15], v[72:75]
    s_waitcnt vmcnt(2)
    s_barrier
    ds_read_b128 v[12:15], v2 offset:12288
    v_mfma_f32_16x16x32_bf16 v[72:75], a[228:231], v[16:19], v[72:75]
    ds_read_b128 v[16:19], v2 offset:13312
    s_waitcnt lgkmcnt(6)
    v_mfma_f32_16x16x32_bf16 v[72:75], a[232:235], v[20:23], v[72:75]
    ds_read_b128 v[20:23], v2 offset:14336
    v_mfma_f32_16x16x32_bf16 v[72:75], a[236:239], v[24:27], v[72:75]
    ds_read_b128 v[24:27], v2 offset:15360
    s_waitcnt lgkmcnt(6)
    v_mfma_f32_16x16x32_bf16 v[72:75], a[240:243], v[28:31], v[72:75]
    ds_read_b128 v[28:31], v3 offset:12288
    v_mfma_f32_16x16x32_bf16 v[72:75], a[244:247], v[32:35], v[72:75]
    ds_read_b128 v[32:35], v3 offset:13312
    s_waitcnt lgkmcnt(6)
    v_mfma_f32_16x16x32_bf16 v[72:75], a[248:251], v[36:39], v[72:75]
    ds_read_b128 v[36:39], v3 offset:14336
    v_mfma_f32_16x16x32_bf16 v[72:75], a[252:255], v[40:43], v[72:75]
    ds_read_b128 v[40:43], v3 offset:15360
    s_waitcnt lgkmcnt(6)
    v_mfma_f32_16x16x32_bf16 v[76:79], a[192:195], v[12:15], v[76:79]
    ds_read_b128 v[12:15], v4 offset:12288
    v_mfma_f32_16x16x32_bf16 v[76:79], a[196:199], v[16:19], v[76:79]
    ds_read_b128 v[16:19], v4 offset:13312
    s_waitcnt lgkmcnt(6)
    v_mfma_f32_16x16x32_bf16 v[76:79], a[200:203], v[20:23], v[76:79]
    ds_read_b128 v[20:23], v4 offset:14336
    v_mfma_f32_16x16x32_bf16 v[76:79], a[204:207], v[24:27], v[76:79]
    ds_read_b128 v[24:27], v4 offset:15360
    v_cvt_pk_bf16_f32 v248, v72, v73
    v_cvt_pk_bf16_f32 v249, v74, v75
    s_add_u32 s47, s26, 1
    s_lshl_b32 s47, s47, 14
    s_waitcnt lgkmcnt(6)
    v_mfma_f32_16x16x32_bf16 v[76:79], a[208:211], v[28:31], v[76:79]
    ds_read_b128 v[28:31], v5 offset:12288
    s_add_u32 s47, s47, s53
    v_mfma_f32_16x16x32_bf16 v[76:79], a[212:215], v[32:35], v[76:79]
    ds_read_b128 v[32:35], v5 offset:13312
    s_waitcnt lgkmcnt(6)
    v_mfma_f32_16x16x32_bf16 v[76:79], a[216:219], v[36:39], v[76:79]
    ds_read_b128 v[36:39], v5 offset:14336
    v_mfma_f32_16x16x32_bf16 v[76:79], a[220:223], v[40:43], v[76:79]
    ds_read_b128 v[40:43], v5 offset:15360
    s_cbranch_vccnz L_slow_8
    buffer_store_dwordx2 v[248:249], v44, s[8:11], s47 offen
L_back_8:
    s_waitcnt lgkmcnt(6)
    v_mfma_f32_16x16x32_bf16 v[76:79], a[224:227], v[12:15], v[76:79]
    v_mfma_f32_16x16x32_bf16 v[76:79], a[228:231], v[16:19], v[76:79]
    s_waitcnt lgkmcnt(4)
    v_mfma_f32_16x16x32_bf16 v[76:79], a[232:235], v[20:23], v[76:79]
    v_mfma_f32_16x16x32_bf16 v[76:79], a[236:239], v[24:27], v[76:79]
    s_waitcnt lgkmcnt(2)
    v_mfma_f32_16x16x32_bf16 v[76:79], a[240:243], v[28:31], v[76:79]
    v_mfma_f32_16x16x32_bf16 v[76:79], a[244:247], v[32:35], v[76:79]
    s_waitcnt lgkmcnt(0)
    v_mfma_f32_16x16x32_bf16 v[76:79], a[248:251], v[36:39], v[76:79]
    v_mfma_f32_16x16x32_bf16 v[76:79], a[252:255], v[40:43], v[76:79]
    s_nop 7
    v_cvt_pk_bf16_f32 v250, v76, v77
    v_cvt_pk_bf16_f32 v251, v78, v79
    s_add_u32 s47, s26, 2
    s_lshl_b32 s47, s47, 14
    s_add_u32 s47, s47, s53
    s_cbranch_vccnz L_slow_9
    buffer_store_dwordx2 v[250:251], v44, s[8:11], s47 offen
L_back_9:
    s_waitcnt vmcnt(0)
    s_barrier
    s_cmp_lg_u32 s22, 0
    s_cbranch_scc1 L_np1_interleave_layers__grouped_kv_mqa__sliding_local_dilated__prompt_kernel
    s_lshl_b32 s23, s20, 7
    s_lshl_b32 s28, s21, 3
    s_add_u32 s23, s23, s28
    s_add_u32 s23, s23, s56
    s_add_u32 s23, s23, 4096
    v_mov_b32 v61, 0
    v_mov_b32 v62, s50
    v_mov_b32 v63, s3
    s_mov_b64 vcc, s[40:41]
    s_mov_b64 exec, 1
    s_cbranch_vccnz L_slow_10
    buffer_store_dwordx2 v[62:63], v61, s[8:11], s23 offen
L_back_10:
    s_lshl_b32 s23, s20, 7
    s_lshl_b32 s28, s21, 3
    s_add_u32 s23, s23, s28
    s_lshl_b32 s28, s55, 13
    s_add_u32 s23, s23, s28
    s_add_u32 s23, s23, 26320896
    s_mov_b64 vcc, s[42:43]
    s_cbranch_vccnz L_slow_11
    buffer_store_dwordx2 v[62:63], v61, s[8:11], s23 offen
L_back_11:
    s_mov_b64 exec, -1
L_np1_interleave_layers__grouped_kv_mqa__sliding_local_dilated__prompt_kernel:
    s_lshl_b32 s26, s20, 2
    s_sub_u32 s26, s26, 1
    v_mov_b32 v96, v99
    s_mul_i32 s23, s16, 5
    v_add_u32 v2, s23, v1
    s_mul_i32 s23, s17, 5
    v_add_u32 v3, s23, v1
    s_mul_i32 s23, s18, 5
    v_add_u32 v4, s23, v1
    s_mul_i32 s23, s19, 5
    v_add_u32 v5, s23, v1
    v_lshrrev_b32 v48, 2, v6
    v_cmp_eq_u32 s[30:31], v48, v7
    v_lshlrev_b32 v45, 5, v6
    s_lshl_b32 s23, s22, 2
    s_add_u32 s23, s23, 81920
    v_add_u32 v45, s23, v45
    v_mov_b32 v48, 84992
    v_cndmask_b32_e64 v45, v48, v45, s[30:31]
    v_lshlrev_b32 v46, 5, v6
    v_add_u32 v46, 81920, v46
    s_lshl_b32 s23, s22, 7
    s_add_u32 s23, s23, 84480
    v_lshlrev_b32 v44, 2, v6
    v_add_u32 v44, s23, v44
    v_lshlrev_b32 v47, 4, v7
    v_add_u32 v47, s23, v47
    v_mfma_f32_16x16x32_bf16 v[120:123], v[8:11], a[128:131], 0
    v_mfma_f32_16x16x32_bf16 v[120:123], v[8:11], a[132:135], v[120:123]
    v_mfma_f32_16x16x32_bf16 v[120:123], v[8:11], a[136:139], v[120:123]
    v_mfma_f32_16x16x32_bf16 v[120:123], v[8:11], a[140:143], v[120:123]
    v_mfma_f32_16x16x32_bf16 v[120:123], v[8:11], a[144:147], v[120:123]
    v_mfma_f32_16x16x32_bf16 v[120:123], v[8:11], a[148:151], v[120:123]
    v_mfma_f32_16x16x32_bf16 v[120:123], v[8:11], a[152:155], v[120:123]
    v_mfma_f32_16x16x32_bf16 v[120:123], v[8:11], a[156:159], v[120:123]
    v_mfma_f32_16x16x32_bf16 v[120:123], v[8:11], a[160:163], v[120:123]
    v_mfma_f32_16x16x32_bf16 v[120:123], v[8:11], a[164:167], v[120:123]
    v_mfma_f32_16x16x32_bf16 v[120:123], v[8:11], a[168:171], v[120:123]
    v_mfma_f32_16x16x32_bf16 v[120:123], v[8:11], a[172:175], v[120:123]
    v_mfma_f32_16x16x32_bf16 v[120:123], v[8:11], a[176:179], v[120:123]
    v_mfma_f32_16x16x32_bf16 v[120:123], v[8:11], a[180:183], v[120:123]
    v_mfma_f32_16x16x32_bf16 v[120:123], v[8:11], a[184:187], v[120:123]
    v_mfma_f32_16x16x32_bf16 v[120:123], v[8:11], a[188:191], v[120:123]
    s_mul_i32 s25, s22, 20480
    s_add_u32 s25, s25, 0
    s_lshl_b32 s24, s22, 12
    s_add_u32 s24, s24, s53
    v_and_b32 v61, 7, v0
    v_lshlrev_b32 v61, 3, v61
    s_lshl_b32 s23, s20, 7
    v_add_u32 v61, s23, v61
    s_add_u32 s45, s56, 4096
    v_add_u32 v61, s45, v61
    s_sub_u32 s28, s20, 1
    s_lshl_b32 s28, s28, 7
    s_lshl_b32 s23, s55, 13
    s_add_u32 s28, s28, s23
    s_add_u32 s28, s28, 26320832
    v_lshl_add_u32 v62, v0, 3, s28
    v_subrev_u32 v63, 8, v0
    v_cmp_gt_u32 s[28:29], 8, v63
    s_cmp_eq_u32 s20, 0
    s_cselect_b64 s[28:29], 0, s[28:29]
    v_cndmask_b32_e64 v61, v61, v62, s[28:29]
    buffer_load_dwordx2 v[62:63], v61, s[8:11], 0 offen sc1
    s_waitcnt vmcnt(0)
    v_cmp_ne_u32 vcc, s50, v62
    v_cmp_ne_u32 s[28:29], s3, v63
    s_nop 0
    s_or_b64 vcc, vcc, s[28:29]
    s_cbranch_vccz L_seen1_interleave_layers__grouped_kv_mqa__sliding_local_dilated__prompt_kernel_2
    s_mov_b32 s45, 0x10000
L_poll1_interleave_layers__grouped_kv_mqa__sliding_local_dilated__prompt_kernel_2:
    buffer_load_dwordx2 v[62:63], v61, s[8:11], 0 offen sc1
    s_waitcnt vmcnt(0)
    v_cmp_ne_u32 vcc, s50, v62
    v_cmp_ne_u32 s[28:29], s3, v63
    s_nop 0
    s_or_b64 vcc, vcc, s[28:29]
    s_sub_u32 s45, s45, 1
    s_cmp_eq_u32 s45, 0
    s_cbranch_scc1 L_poll1_interleave_layers__grouped_kv_mqa__sliding_local_dilated__prompt_kernel_2_d
    s_cbranch_vccnz L_poll1_interleave_layers__grouped_kv_mqa__sliding_local_dilated__prompt_kernel_2
L_poll1_interleave_layers__grouped_kv_mqa__sliding_local_dilated__prompt_kernel_2_d:
L_seen1_interleave_layers__grouped_kv_mqa__sliding_local_dilated__prompt_kernel_2:
    s_mov_b64 vcc, s[40:41]
    s_max_i32 s23, s26, 0
    s_lshl_b32 s23, s23, 14
    s_add_u32 s27, s23, s24
    s_add_u32 m0, s25, 0
    s_nop 0
    buffer_load_dwordx4 v1, s[8:11], s27 offen offset:0 sc1 lds
    buffer_load_dwordx4 v1, s[8:11], s27 offen offset:1024 sc1 lds
    buffer_load_dwordx4 v1, s[8:11], s27 offen offset:2048 sc1 lds
    buffer_load_dwordx4 v1, s[8:11], s27 offen offset:3072 sc1 lds
    s_barrier
    s_add_u32 s23, s26, 1
    s_lshl_b32 s23, s23, 14
    s_add_u32 s27, s23, s24
    s_add_u32 m0, s25, 4096
    s_nop 0
    buffer_load_dwordx4 v1, s[8:11], s27 offen offset:0 sc1 lds
    buffer_load_dwordx4 v1, s[8:11], s27 offen offset:1024 sc1 lds
    buffer_load_dwordx4 v1, s[8:11], s27 offen offset:2048 sc1 lds
    buffer_load_dwordx4 v1, s[8:11], s27 offen offset:3072 sc1 lds
    s_waitcnt vmcnt(4)
    s_barrier
    ds_read_b128 v[12:15], v2 offset:0
    ds_read_b128 v[16:19], v2 offset:1024
    ds_read_b128 v[20:23], v2 offset:2048
    ds_read_b128 v[24:27], v2 offset:3072
    ds_read_b128 v[28:31], v3 offset:0
    ds_read_b128 v[32:35], v3 offset:1024
    ds_read_b128 v[36:39], v3 offset:2048
    ds_read_b128 v[40:43], v3 offset:3072
    s_waitcnt lgkmcnt(6)
    v_mfma_f32_16x16x32_bf16 v[68:71], a[64:67], v[12:15], 0
    v_mfma_f32_16x16x32_bf16 v[72:75], v[12:15], a[128:131], 0
    v_mfma_f32_16x16x32_bf16 v[88:91], v[12:15], v[12:15], 0
    v_mfma_f32_16x16x32_bf16 v[92:95], v[8:11], v[12:15], 0
    ds_read_b128 v[12:15], v4 offset:0
    s_add_u32 s23, s26, 2
    s_lshl_b32 s23, s23, 14
    s_add_u32 s27, s23, s24
    s_add_u32 m0, s25, 8192
    s_nop 0
    buffer_load_dwordx4 v1, s[8:11], s27 offen offset:0 sc1 lds
    v_mfma_f32_16x16x32_bf16 v[68:71], a[68:71], v[16:19], v[68:71]
    s_waitcnt lgkmcnt(5)
    v_mfma_f32_16x16x32_bf16 v[72:75], v[16:19], a[132:135], v[72:75]
    v_mfma_f32_16x16x32_bf16 v[88:91], v[16:19], v[16:19], v[88:91]
    v_mfma_f32_16x16x32_bf16 v[92:95], v[8:11], v[16:19], v[92:95]
    ds_read_b128 v[16:19], v4 offset:1024
    buffer_load_dwordx4 v1, s[8:11], s27 offen offset:1024 sc1 lds
    v_mfma_f32_16x16x32_bf16 v[68:71], a[72:75], v[20:23], v[68:71]
    v_mfma_f32_16x16x32_bf16 v[72:75], v[20:23], a[136:139], v[72:75]
    v_mfma_f32_16x16x32_bf16 v[88:91], v[20:23], v[20:23], v[88:91]
    v_mfma_f32_16x16x32_bf16 v[92:95], v[8:11], v[20:23], v[92:95]
    ds_read_b128 v[20:23], v4 offset:2048
    buffer_load_dwordx4 v1, s[8:11], s27 offen offset:2048 sc1 lds
    v_mfma_f32_16x16x32_bf16 v[68:71], a[76:79], v[24:27], v[68:71]
    s_waitcnt lgkmcnt(5)
    v_mfma_f32_16x16x32_bf16 v[72:75], v[24:27], a[140:143], v[72:75]
    v_mfma_f32_16x16x32_bf16 v[88:91], v[24:27], v[24:27], v[88:91]
    v_mfma_f32_16x16x32_bf16 v[92:95], v[8:11], v[24:27], v[92:95]
    ds_read_b128 v[24:27], v4 offset:3072
    buffer_load_dwordx4 v1, s[8:11], s27 offen offset:3072 sc1 lds
    v_mfma_f32_16x16x32_bf16 v[68:71], a[80:83], v[28:31], v[68:71]
    v_mfma_f32_16x16x32_bf16 v[72:75], v[28:31], a[144:147], v[72:75]
    ds_read_b128 v[28:31], v5 offset:0
    v_mfma_f32_16x16x32_bf16 v[68:71], a[84:87], v[32:35], v[68:71]
    s_nop 0
    v_cndmask_b32_e64 v48, v88, v89, s[32:33]
    v_cndmask_b32_e64 v48, v48, v90, s[34:35]
    v_cndmask_b32_e64 v48, v48, v91, s[36:37]
    s_waitcnt lgkmcnt(5)
    v_mfma_f32_16x16x32_bf16 v[72:75], v[32:35], a[148:151], v[72:75]
    ds_read_b128 v[32:35], v5 offset:1024
    ds_write_b32 v45, v92 offset:0
    v_mfma_f32_16x16x32_bf16 v[68:71], a[88:91], v[36:39], v[68:71]
    ds_write_b32 v45, v48 offset:16
    v_mfma_f32_16x16x32_bf16 v[72:75], v[36:39], a[152:155], v[72:75]
    ds_read_b128 v[36:39], v5 offset:2048
    v_mfma_f32_16x16x32_bf16 v[68:71], a[92:95], v[40:43], v[68:71]
    s_waitcnt lgkmcnt(7)
    v_mfma_f32_16x16x32_bf16 v[72:75], v[40:43], a[156:159], v[72:75]
    ds_read_b128 v[40:43], v5 offset:3072
    v_mfma_f32_16x16x32_bf16 v[68:71], a[96:99], v[12:15], v[68:71]
    v_mfma_f32_16x16x32_bf16 v[72:75], v[12:15], a[160:163], v[72:75]
    s_waitcnt lgkmcnt(2)
    s_waitcnt vmcnt(4)
    s_barrier
    ds_read_b128 v[12:15], v2 offset:4096
    v_mfma_f32_16x16x32_bf16 v[68:71], a[100:103], v[16:19], v[68:71]
    ds_read_b128 v[48:51], v46 offset:0
    v_mfma_f32_16x16x32_bf16 v[72:75], v[16:19], a[164:167], v[72:75]
    ds_read_b128 v[16:19], v2 offset:5120
    ds_read_b128 v[52:55], v46 offset:16
    v_mfma_f32_16x16x32_bf16 v[68:71], a[104:107], v[20:23], v[68:71]
    v_mfma_f32_16x16x32_bf16 v[72:75], v[20:23], a[168:171], v[72:75]
    ds_read_b128 v[20:23], v2 offset:6144
    v_mfma_f32_16x16x32_bf16 v[68:71], a[108:111], v[24:27], v[68:71]
    v_mfma_f32_16x16x32_bf16 v[72:75], v[24:27], a[172:175], v[72:75]
    ds_read_b128 v[24:27], v2 offset:7168
    v_mfma_f32_16x16x32_bf16 v[68:71], a[112:115], v[28:31], v[68:71]
    s_waitcnt lgkmcnt(2)
    v_add_f32 v48, v48, v49
    v_add_f32 v52, v52, v53
    v_add_f32 v50, v50, v51
    v_add_f32 v54, v54, v55
    v_mfma_f32_16x16x32_bf16 v[72:75], v[28:31], a[176:179], v[72:75]
    ds_read_b128 v[28:31], v3 offset:4096
    v_add_f32 v48, v48, v50
    v_mfma_f32_16x16x32_bf16 v[68:71], a[116:119], v[32:35], v[68:71]
    v_add_f32 v52, v52, v54
    v_mul_f32 v48, 0x3b000000, v48
    v_mfma_f32_16x16x32_bf16 v[72:75], v[32:35], a[180:183], v[72:75]
    ds_read_b128 v[32:35], v3 offset:5120
    v_mul_f32 v52, 0x3b000000, v52
    v_mfma_f32_16x16x32_bf16 v[68:71], a[120:123], v[36:39], v[68:71]
    v_fma_f32 v52, -v48, v48, v52
    v_max_f32 v52, 0, v52
    v_mfma_f32_16x16x32_bf16 v[72:75], v[36:39], a[184:187], v[72:75]
    ds_read_b128 v[36:39], v3 offset:6144
    v_add_f32 v52, 0x3727c5ac, v52
    v_mfma_f32_16x16x32_bf16 v[68:71], a[124:127], v[40:43], v[68:71]
    v_rsq_f32 v124, v52
    v_mfma_f32_16x16x32_bf16 v[72:75], v[40:43], a[188:191], v[72:75]
    ds_read_b128 v[40:43], v3 offset:7168
    v_sub_f32 v48, 0, v48
    v_mul_f32 v125, v48, v124
    ds_write_b32 v44, v124
    ds_write_b32 v44, v125 offset:64
    v_mfma_f32_16x16x32_bf16 v[76:79], a[0:3], v[12:15], 0
    v_mfma_f32_16x16x32_bf16 v[80:83], a[64:67], v[12:15], 0
    v_mfma_f32_16x16x32_bf16 v[84:87], v[12:15], a[128:131], 0
    v_mfma_f32_16x16x32_bf16 v[88:91], v[12:15], v[12:15], 0
    v_mfma_f32_16x16x32_bf16 v[92:95], v[8:11], v[12:15], 0
    ds_read_b128 v[12:15], v4 offset:4096
    s_add_u32 s23, s26, 3
    s_lshl_b32 s23, s23, 14
    s_add_u32 s27, s23, s24
    s_add_u32 m0, s25, 12288
    s_nop 0
    buffer_load_dwordx4 v1, s[8:11], s27 offen offset:0 sc1 lds
    v_mfma_f32_16x16x32_bf16 v[76:79], a[4:7], v[16:19], v[76:79]
    s_waitcnt lgkmcnt(1)
    ds_read_b128 v[132:135], v47
    ds_read_b128 v[136:139], v47 offset:64
    v_mul_f32 v56, v125, v116
    v_mfma_f32_16x16x32_bf16 v[80:83], a[68:71], v[16:19], v[80:83]
    v_mul_f32 v57, v125, v117
    v_mul_f32 v58, v125, v118
    v_mfma_f32_16x16x32_bf16 v[84:87], v[16:19], a[132:135], v[84:87]
    v_mul_f32 v59, v125, v119
    v_fma_f32 v56, v68, v124, v56
    v_mfma_f32_16x16x32_bf16 v[88:91], v[16:19], v[16:19], v[88:91]
    v_fma_f32 v57, v69, v124, v57
    v_fma_f32 v58, v70, v124, v58
    v_mfma_f32_16x16x32_bf16 v[92:95], v[8:11], v[16:19], v[92:95]
    ds_read_b128 v[16:19], v4 offset:5120
    v_fma_f32 v59, v71, v124, v59
    buffer_load_dwordx4 v1, s[8:11], s27 offen offset:1024 sc1 lds
    v_mfma_f32_16x16x32_bf16 v[76:79], a[8:11], v[20:23], v[76:79]
    v_cvt_pk_bf16_f32 v142, v56, v57
    v_cvt_pk_bf16_f32 v143, v58, v59
    s_waitcnt lgkmcnt(1)
    v_mfma_f32_16x16x32_bf16 v[80:83], a[72:75], v[20:23], v[80:83]
    v_mul_f32 v56, v136, v120
    v_mul_f32 v57, v137, v120
    v_mfma_f32_16x16x32_bf16 v[84:87], v[20:23], a[136:139], v[84:87]
    v_mul_f32 v58, v138, v120
    v_mul_f32 v59, v139, v120
    v_mfma_f32_16x16x32_bf16 v[88:91], v[20:23], v[20:23], v[88:91]
    v_fma_f32 v56, v72, v132, v56
    v_fma_f32 v57, v73, v133, v57
    v_mfma_f32_16x16x32_bf16 v[92:95], v[8:11], v[20:23], v[92:95]
    ds_read_b128 v[20:23], v4 offset:6144
    v_fma_f32 v58, v74, v134, v58
    buffer_load_dwordx4 v1, s[8:11], s27 offen offset:2048 sc1 lds
    v_mfma_f32_16x16x32_bf16 v[76:79], a[12:15], v[24:27], v[76:79]
    v_fma_f32 v59, v75, v135, v59
    v_cvt_pk_bf16_f32 v148, v56, v57
    v_mfma_f32_16x16x32_bf16 v[80:83], a[76:79], v[24:27], v[80:83]
    v_cvt_pk_bf16_f32 v149, v58, v59
    v_mfma_f32_16x16x32_bf16 v[84:87], v[24:27], a[140:143], v[84:87]
    v_mfma_f32_16x16x32_bf16 v[88:91], v[24:27], v[24:27], v[88:91]
    v_mfma_f32_16x16x32_bf16 v[92:95], v[8:11], v[24:27], v[92:95]
    ds_read_b128 v[24:27], v4 offset:7168
    buffer_load_dwordx4 v1, s[8:11], s27 offen offset:3072 sc1 lds
    v_mfma_f32_16x16x32_bf16 v[76:79], a[16:19], v[28:31], v[76:79]
    v_mfma_f32_16x16x32_bf16 v[80:83], a[80:83], v[28:31], v[80:83]
    v_mfma_f32_16x16x32_bf16 v[84:87], v[28:31], a[144:147], v[84:87]
    ds_read_b128 v[28:31], v5 offset:4096
    v_mfma_f32_16x16x32_bf16 v[76:79], a[20:23], v[32:35], v[76:79]
    v_cndmask_b32_e64 v48, v88, v89, s[32:33]
    v_cndmask_b32_e64 v48, v48, v90, s[34:35]
    v_cndmask_b32_e64 v48, v48, v91, s[36:37]
    v_mfma_f32_16x16x32_bf16 v[80:83], a[84:87], v[32:35], v[80:83]
    ds_write_b32 v45, v92 offset:512
    ds_write_b32 v45, v48 offset:528
    v_mfma_f32_16x16x32_bf16 v[84:87], v[32:35], a[148:151], v[84:87]
    ds_read_b128 v[32:35], v5 offset:5120
    v_mfma_f32_16x16x32_bf16 v[76:79], a[24:27], v[36:39], v[76:79]
    v_mfma_f32_16x16x32_bf16 v[80:83], a[88:91], v[36:39], v[80:83]
    v_mfma_f32_16x16x32_bf16 v[84:87], v[36:39], a[152:155], v[84:87]
    ds_read_b128 v[36:39], v5 offset:6144
    v_mfma_f32_16x16x32_bf16 v[76:79], a[28:31], v[40:43], v[76:79]
    s_waitcnt lgkmcnt(7)
    v_mfma_f32_16x16x32_bf16 v[80:83], a[92:95], v[40:43], v[80:83]
    v_mfma_f32_16x16x32_bf16 v[84:87], v[40:43], a[156:159], v[84:87]
    ds_read_b128 v[40:43], v5 offset:7168
    v_mfma_f32_16x16x32_bf16 v[76:79], a[32:35], v[12:15], v[76:79]
    v_mfma_f32_16x16x32_bf16 v[80:83], a[96:99], v[12:15], v[80:83]
    v_mfma_f32_16x16x32_bf16 v[84:87], v[12:15], a[160:163], v[84:87]
    s_waitcnt lgkmcnt(3)
    s_waitcnt vmcnt(4)
    s_barrier
    ds_read_b128 v[12:15], v2 offset:8192
    v_mfma_f32_16x16x32_bf16 v[76:79], a[36:39], v[16:19], v[76:79]
    ds_read_b128 v[48:51], v46 offset:512
    v_mfma_f32_16x16x32_bf16 v[80:83], a[100:103], v[16:19], v[80:83]
    ds_read_b128 v[52:55], v46 offset:528
    v_mfma_f32_16x16x32_bf16 v[84:87], v[16:19], a[164:167], v[84:87]
    ds_read_b128 v[16:19], v2 offset:9216
    v_mfma_f32_16x16x32_bf16 v[76:79], a[40:43], v[20:23], v[76:79]
    v_mfma_f32_16x16x32_bf16 v[80:83], a[104:107], v[20:23], v[80:83]
    v_mfma_f32_16x16x32_bf16 v[84:87], v[20:23], a[168:171], v[84:87]
    ds_read_b128 v[20:23], v2 offset:10240
    v_mfma_f32_16x16x32_bf16 v[76:79], a[44:47], v[24:27], v[76:79]
    s_waitcnt lgkmcnt(7)
    v_mfma_f32_16x16x32_bf16 v[80:83], a[108:111], v[24:27], v[80:83]
    v_mfma_f32_16x16x32_bf16 v[84:87], v[24:27], a[172:175], v[84:87]
    ds_read_b128 v[24:27], v2 offset:11264
    v_mfma_f32_16x16x32_bf16 v[76:79], a[48:51], v[28:31], v[76:79]
    s_waitcnt lgkmcnt(3)
    v_add_f32 v48, v48, v49
    v_add_f32 v52, v52, v53
    v_add_f32 v50, v50, v51
    v_add_f32 v54, v54, v55
    v_mfma_f32_16x16x32_bf16 v[80:83], a[112:115], v[28:31], v[80:83]
    v_add_f32 v48, v48, v50
    v_add_f32 v52, v52, v54
    v_mfma_f32_16x16x32_bf16 v[84:87], v[28:31], a[176:179], v[84:87]
    ds_read_b128 v[28:31], v3 offset:8192
    v_mul_f32 v48, 0x3b000000, v48
    v_mfma_f32_16x16x32_bf16 v[76:79], a[52:55], v[32:35], v[76:79]
    v_mul_f32 v52, 0x3b000000, v52
    v_fma_f32 v52, -v48, v48, v52
    v_mfma_f32_16x16x32_bf16 v[80:83], a[116:119], v[32:35], v[80:83]
    v_max_f32 v52, 0, v52
    v_add_f32 v52, 0x3727c5ac, v52
    v_mfma_f32_16x16x32_bf16 v[84:87], v[32:35], a[180:183], v[84:87]
    ds_read_b128 v[32:35], v3 offset:9216
    v_mfma_f32_16x16x32_bf16 v[76:79], a[56:59], v[36:39], v[76:79]
    v_rsq_f32 v126, v52
    v_sub_f32 v48, 0, v48
    v_mfma_f32_16x16x32_bf16 v[80:83], a[120:123], v[36:39], v[80:83]
    v_mul_f32 v127, v48, v126
    v_mfma_f32_16x16x32_bf16 v[84:87], v[36:39], a[184:187], v[84:87]
    ds_read_b128 v[36:39], v3 offset:10240
    ds_write_b32 v44, v126
    v_mfma_f32_16x16x32_bf16 v[76:79], a[60:63], v[40:43], v[76:79]
    ds_write_b32 v44, v127 offset:64
    s_waitcnt lgkmcnt(7)
    v_mfma_f32_16x16x32_bf16 v[80:83], a[124:127], v[40:43], v[80:83]
    v_mfma_f32_16x16x32_bf16 v[84:87], v[40:43], a[188:191], v[84:87]
    ds_read_b128 v[40:43], v3 offset:11264
    v_mfma_f32_16x16x32_bf16 v[64:67], a[0:3], v[12:15], 0
    v_mfma_f32_16x16x32_bf16 v[68:71], a[64:67], v[12:15], 0
    v_mfma_f32_16x16x32_bf16 v[72:75], v[12:15], a[128:131], 0
    v_mfma_f32_16x16x32_bf16 v[88:91], v[12:15], v[12:15], 0
    v_mfma_f32_16x16x32_bf16 v[92:95], v[8:11], v[12:15], 0
    ds_read_b128 v[12:15], v4 offset:8192
    s_add_u32 s23, s26, 4
    s_lshl_b32 s23, s23, 14
    s_add_u32 s27, s23, s24
    s_add_u32 m0, s25, 16384
    s_nop 0
    buffer_load_dwordx4 v1, s[8:11], s27 offen offset:0 sc1 lds
    v_mfma_f32_16x16x32_bf16 v[64:67], a[4:7], v[16:19], v[64:67]
    s_waitcnt lgkmcnt(2)
    ds_read_b128 v[132:135], v47
    ds_read_b128 v[136:139], v47 offset:64
    v_mul_f32 v56, v127, v116
    v_mfma_f32_16x16x32_bf16 v[68:71], a[68:71], v[16:19], v[68:71]
    v_mul_f32 v57, v127, v117
    v_mul_f32 v58, v127, v118
    v_mfma_f32_16x16x32_bf16 v[72:75], v[16:19], a[132:135], v[72:75]
    v_mul_f32 v59, v127, v119
    v_fma_f32 v56, v80, v126, v56
    v_mfma_f32_16x16x32_bf16 v[88:91], v[16:19], v[16:19], v[88:91]
    v_fma_f32 v57, v81, v126, v57
    v_fma_f32 v58, v82, v126, v58
    v_mfma_f32_16x16x32_bf16 v[92:95], v[8:11], v[16:19], v[92:95]
    ds_read_b128 v[16:19], v4 offset:9216
    v_fma_f32 v59, v83, v126, v59
    buffer_load_dwordx4 v1, s[8:11], s27 offen offset:1024 sc1 lds
    v_mfma_f32_16x16x32_bf16 v[64:67], a[8:11], v[20:23], v[64:67]
    v_cvt_pk_bf16_f32 v144, v56, v57
    v_cvt_pk_bf16_f32 v145, v58, v59
    v_mfma_f32_16x16x32_bf16 v[68:71], a[72:75], v[20:23], v[68:71]
    v_mul_f32 v128, 0x3eb8aa3b, v126
    v_mul_f32 v129, 0x3eb8aa3b, v127
    v_mfma_f32_16x16x32_bf16 v[72:75], v[20:23], a[136:139], v[72:75]
    v_mul_f32 v56, v129, v112
    v_mul_f32 v57, v129, v113
    v_mfma_f32_16x16x32_bf16 v[88:91], v[20:23], v[20:23], v[88:91]
    v_mul_f32 v58, v129, v114
    v_mul_f32 v59, v129, v115
    v_mfma_f32_16x16x32_bf16 v[92:95], v[8:11], v[20:23], v[92:95]
    ds_read_b128 v[20:23], v4 offset:10240
    v_fma_f32 v56, v76, v128, v56
    buffer_load_dwordx4 v1, s[8:11], s27 offen offset:2048 sc1 lds
    v_mfma_f32_16x16x32_bf16 v[64:67], a[12:15], v[24:27], v[64:67]
    v_fma_f32 v57, v77, v128, v57
    v_fma_f32 v58, v78, v128, v58
    v_mfma_f32_16x16x32_bf16 v[68:71], a[76:79], v[24:27], v[68:71]
    v_fma_f32 v59, v79, v128, v59
    v_cvt_pk_bf16_f32 v140, v56, v57
    v_mfma_f32_16x16x32_bf16 v[72:75], v[24:27], a[140:143], v[72:75]
    v_cvt_pk_bf16_f32 v141, v58, v59
    v_mfma_f32_16x16x32_bf16 v[88:91], v[24:27], v[24:27], v[88:91]
    s_nop 0
    v_mfma_f32_16x16x16_bf16 v[158:161], v[142:143], v[140:141], v[108:111]
    v_mfma_f32_16x16x32_bf16 v[92:95], v[8:11], v[24:27], v[92:95]
    ds_read_b128 v[24:27], v4 offset:11264
    v_mfma_f32_16x16x16_bf16 v[162:165], v[144:145], v[140:141], v[100:103]
    s_waitcnt lgkmcnt(3)
    buffer_load_dwordx4 v1, s[8:11], s27 offen offset:3072 sc1 lds
    v_mfma_f32_16x16x32_bf16 v[64:67], a[16:19], v[28:31], v[64:67]
    v_mul_f32 v56, v136, v120
    v_mul_f32 v57, v137, v120
    v_mfma_f32_16x16x32_bf16 v[68:71], a[80:83], v[28:31], v[68:71]
    v_mul_f32 v58, v138, v120
    v_mul_f32 v59, v139, v120
    v_mfma_f32_16x16x32_bf16 v[72:75], v[28:31], a[144:147], v[72:75]
    ds_read_b128 v[28:31], v5 offset:8192
    v_fma_f32 v56, v84, v132, v56
    v_mfma_f32_16x16x32_bf16 v[64:67], a[20:23], v[32:35], v[64:67]
    v_cndmask_b32_e64 v48, v88, v89, s[32:33]
    v_cndmask_b32_e64 v48, v48, v90, s[34:35]
    v_mfma_f32_16x16x32_bf16 v[68:71], a[84:87], v[32:35], v[68:71]
    v_cndmask_b32_e64 v48, v48, v91, s[36:37]
    v_fma_f32 v57, v85, v133, v57
    v_mfma_f32_16x16x32_bf16 v[72:75], v[32:35], a[148:151], v[72:75]
    ds_read_b128 v[32:35], v5 offset:9216
    v_fma_f32 v58, v86, v134, v58
    v_mfma_f32_16x16x32_bf16 v[64:67], a[24:27], v[36:39], v[64:67]
    ds_write_b32 v45, v92 offset:1024
    v_mfma_f32_16x16x32_bf16 v[68:71], a[88:91], v[36:39], v[68:71]
    ds_write_b32 v45, v48 offset:1040
    v_fma_f32 v59, v87, v135, v59
    v_mfma_f32_16x16x32_bf16 v[72:75], v[36:39], a[152:155], v[72:75]
    ds_read_b128 v[36:39], v5 offset:10240
    v_cvt_pk_bf16_f32 v150, v56, v57
    v_mfma_f32_16x16x32_bf16 v[64:67], a[28:31], v[40:43], v[64:67]
    v_cvt_pk_bf16_f32 v151, v58, v59
    v_max3_f32 v98, v158, v159, v160
    s_waitcnt lgkmcnt(7)
    v_mfma_f32_16x16x32_bf16 v[68:71], a[92:95], v[40:43], v[68:71]
    v_max3_f32 v97, v161, v162, v163
    v_max3_f32 v98, v98, v164, v165
    v_mfma_f32_16x16x32_bf16 v[72:75], v[40:43], a[156:159], v[72:75]
    ds_read_b128 v[40:43], v5 offset:11264
    v_max_f32 v98, v98, v97
    v_mfma_f32_16x16x32_bf16 v[64:67], a[32:35], v[12:15], v[64:67]
    v_mov_b32 v97, v98
    v_mfma_f32_16x16x32_bf16 v[68:71], a[96:99], v[12:15], v[68:71]
    s_nop 0
    v_permlane32_swap_b32 v97, v98
    v_max_f32 v98, v98, v97
    v_mfma_f32_16x16x32_bf16 v[72:75], v[12:15], a[160:163], v[72:75]
    v_mov_b32 v97, v98
    s_waitcnt lgkmcnt(2)
    s_waitcnt vmcnt(4)
    s_barrier
    ds_read_b128 v[12:15], v2 offset:12288
    v_mfma_f32_16x16x32_bf16 v[64:67], a[36:39], v[16:19], v[64:67]
    ds_read_b128 v[48:51], v46 offset:1024
    v_mfma_f32_16x16x32_bf16 v[68:71], a[100:103], v[16:19], v[68:71]
    ds_read_b128 v[52:55], v46 offset:1040
    v_mfma_f32_16x16x32_bf16 v[72:75], v[16:19], a[164:167], v[72:75]
    ds_read_b128 v[16:19], v2 offset:13312
    v_permlane16_swap_b32 v97, v98
    v_mfma_f32_16x16x32_bf16 v[64:67], a[40:43], v[20:23], v[64:67]
    v_max_f32 v98, v98, v97
    v_sub_f32 v158, v158, v98
    v_mfma_f32_16x16x32_bf16 v[68:71], a[104:107], v[20:23], v[68:71]
    v_sub_f32 v159, v159, v98
    v_sub_f32 v160, v160, v98
    v_mfma_f32_16x16x32_bf16 v[72:75], v[20:23], a[168:171], v[72:75]
    ds_read_b128 v[20:23], v2 offset:14336
    v_sub_f32 v161, v161, v98
    v_mfma_f32_16x16x32_bf16 v[64:67], a[44:47], v[24:27], v[64:67]
    v_sub_f32 v162, v162, v98
    v_sub_f32 v163, v163, v98
    v_mfma_f32_16x16x32_bf16 v[68:71], a[108:111], v[24:27], v[68:71]
    v_sub_f32 v164, v164, v98
    v_sub_f32 v165, v165, v98
    v_mfma_f32_16x16x32_bf16 v[72:75], v[24:27], a[172:175], v[72:75]
    ds_read_b128 v[24:27], v2 offset:15360
    v_mfma_f32_16x16x32_bf16 v[64:67], a[48:51], v[28:31], v[64:67]
    s_waitcnt lgkmcnt(3)
    v_add_f32 v48, v48, v49
    v_add_f32 v52, v52, v53
    v_add_f32 v50, v50, v51
    v_mfma_f32_16x16x32_bf16 v[68:71], a[112:115], v[28:31], v[68:71]
    v_add_f32 v54, v54, v55
    v_add_f32 v48, v48, v50
    v_mfma_f32_16x16x32_bf16 v[72:75], v[28:31], a[176:179], v[72:75]
    ds_read_b128 v[28:31], v3 offset:12288
    v_add_f32 v52, v52, v54
    v_mfma_f32_16x16x32_bf16 v[64:67], a[52:55], v[32:35], v[64:67]
    v_mul_f32 v48, 0x3b000000, v48
    v_mul_f32 v52, 0x3b000000, v52
    v_mfma_f32_16x16x32_bf16 v[68:71], a[116:119], v[32:35], v[68:71]
    v_fma_f32 v52, -v48, v48, v52
    v_max_f32 v52, 0, v52
    v_mfma_f32_16x16x32_bf16 v[72:75], v[32:35], a[180:183], v[72:75]
    ds_read_b128 v[32:35], v3 offset:13312
    v_add_f32 v52, 0x3727c5ac, v52
    v_mfma_f32_16x16x32_bf16 v[64:67], a[56:59], v[36:39], v[64:67]
    v_rsq_f32 v124, v52
    v_mfma_f32_16x16x32_bf16 v[68:71], a[120:123], v[36:39], v[68:71]
    v_sub_f32 v48, 0, v48
    v_mul_f32 v125, v48, v124
    v_mfma_f32_16x16x32_bf16 v[72:75], v[36:39], a[184:187], v[72:75]
    ds_read_b128 v[36:39], v3 offset:14336
    v_mfma_f32_16x16x32_bf16 v[64:67], a[60:63], v[40:43], v[64:67]
    ds_write_b32 v44, v124
    ds_write_b32 v44, v125 offset:64
    s_waitcnt lgkmcnt(7)
    v_mfma_f32_16x16x32_bf16 v[68:71], a[124:127], v[40:43], v[68:71]
    v_exp_f32 v158, v158
    v_mfma_f32_16x16x32_bf16 v[72:75], v[40:43], a[188:191], v[72:75]
    ds_read_b128 v[40:43], v3 offset:15360
    v_exp_f32 v159, v159
    v_exp_f32 v160, v160
    v_exp_f32 v161, v161
    v_exp_f32 v162, v162
    v_exp_f32 v163, v163
    v_exp_f32 v164, v164
    v_exp_f32 v165, v165
    v_cvt_pk_bf16_f32 v132, v158, v159
    v_cvt_pk_bf16_f32 v133, v160, v161
    v_cvt_pk_bf16_f32 v134, v162, v163
    v_cvt_pk_bf16_f32 v135, v164, v165
    s_nop 1
    v_mfma_f32_16x16x32_bf16 v[158:161], v[148:151], v[132:135], 0
    v_mfma_f32_16x16x32_bf16 v[162:165], v[8:11], v[132:135], 0
    s_nop 7
    v_rcp_f32 v162, v162
    s_add_u32 s47, s26, 1
    s_lshl_b32 s47, s47, 14
    s_add_u32 s47, s47, s54
    v_mul_f32 v158, v158, v162
    v_mul_f32 v159, v159, v162
    v_mul_f32 v160, v160, v162
    v_mul_f32 v161, v161, v162
    v_cvt_pk_bf16_f32 v146, v158, v159
    v_cvt_pk_bf16_f32 v147, v160, v161
    s_cbranch_vccnz L_slow_12
    buffer_store_dwordx2 v[146:147], v96, s[8:11], s47 offen
L_back_12:
    v_mfma_f32_16x16x32_bf16 v[76:79], a[0:3], v[12:15], 0
    v_mfma_f32_16x16x32_bf16 v[80:83], a[64:67], v[12:15], 0
    v_mfma_f32_16x16x32_bf16 v[84:87], v[12:15], a[128:131], 0
    v_mfma_f32_16x16x32_bf16 v[88:91], v[12:15], v[12:15], 0
    v_mfma_f32_16x16x32_bf16 v[92:95], v[8:11], v[12:15], 0
    ds_read_b128 v[12:15], v4 offset:12288
    v_mfma_f32_16x16x32_bf16 v[76:79], a[4:7], v[16:19], v[76:79]
    s_waitcnt lgkmcnt(2)
    ds_read_b128 v[132:135], v47
    ds_read_b128 v[136:139], v47 offset:64
    v_mul_f32 v56, v125, v116
    v_mfma_f32_16x16x32_bf16 v[80:83], a[68:71], v[16:19], v[80:83]
    v_mul_f32 v57, v125, v117
    v_mul_f32 v58, v125, v118
    v_mfma_f32_16x16x32_bf16 v[84:87], v[16:19], a[132:135], v[84:87]
    v_mul_f32 v59, v125, v119
    v_fma_f32 v56, v68, v124, v56
    v_mfma_f32_16x16x32_bf16 v[88:91], v[16:19], v[16:19], v[88:91]
    v_fma_f32 v57, v69, v124, v57
    v_fma_f32 v58, v70, v124, v58
    v_mfma_f32_16x16x32_bf16 v[92:95], v[8:11], v[16:19], v[92:95]
    ds_read_b128 v[16:19], v4 offset:13312
    v_fma_f32 v59, v71, v124, v59
    v_mfma_f32_16x16x32_bf16 v[76:79], a[8:11], v[20:23], v[76:79]
    v_cvt_pk_bf16_f32 v142, v56, v57
    v_cvt_pk_bf16_f32 v143, v58, v59
    v_mfma_f32_16x16x32_bf16 v[80:83], a[72:75], v[20:23], v[80:83]
    v_mul_f32 v128, 0x3eb8aa3b, v124
    v_mul_f32 v129, 0x3eb8aa3b, v125
    v_mfma_f32_16x16x32_bf16 v[84:87], v[20:23], a[136:139], v[84:87]
    v_mul_f32 v56, v129, v112
    v_mul_f32 v57, v129, v113
    v_mfma_f32_16x16x32_bf16 v[88:91], v[20:23], v[20:23], v[88:91]
    v_mul_f32 v58, v129, v114
    v_mul_f32 v59, v129, v115
    v_mfma_f32_16x16x32_bf16 v[92:95], v[8:11], v[20:23], v[92:95]
    ds_read_b128 v[20:23], v4 offset:14336
    v_fma_f32 v56, v64, v128, v56
    v_mfma_f32_16x16x32_bf16 v[76:79], a[12:15], v[24:27], v[76:79]
    v_fma_f32 v57, v65, v128, v57
    v_fma_f32 v58, v66, v128, v58
    v_mfma_f32_16x16x32_bf16 v[80:83], a[76:79], v[24:27], v[80:83]
    v_fma_f32 v59, v67, v128, v59
    v_cvt_pk_bf16_f32 v140, v56, v57
    v_mfma_f32_16x16x32_bf16 v[84:87], v[24:27], a[140:143], v[84:87]
    v_cvt_pk_bf16_f32 v141, v58, v59
    v_mfma_f32_16x16x32_bf16 v[88:91], v[24:27], v[24:27], v[88:91]
    s_nop 0
    v_mfma_f32_16x16x16_bf16 v[158:161], v[144:145], v[140:141], v[104:107]
    v_mfma_f32_16x16x32_bf16 v[92:95], v[8:11], v[24:27], v[92:95]
    ds_read_b128 v[24:27], v4 offset:15360
    v_mfma_f32_16x16x16_bf16 v[162:165], v[142:143], v[140:141], v[100:103]
    s_waitcnt lgkmcnt(3)
    v_mfma_f32_16x16x32_bf16 v[76:79], a[16:19], v[28:31], v[76:79]
    v_mul_f32 v56, v136, v120
    v_mul_f32 v57, v137, v120
    v_mfma_f32_16x16x32_bf16 v[80:83], a[80:83], v[28:31], v[80:83]
    v_mul_f32 v58, v138, v120
    v_mul_f32 v59, v139, v120
    v_mfma_f32_16x16x32_bf16 v[84:87], v[28:31], a[144:147], v[84:87]
    ds_read_b128 v[28:31], v5 offset:12288
    v_fma_f32 v56, v72, v132, v56
    v_mfma_f32_16x16x32_bf16 v[76:79], a[20:23], v[32:35], v[76:79]
    v_cndmask_b32_e64 v48, v88, v89, s[32:33]
    v_cndmask_b32_e64 v48, v48, v90, s[34:35]
    v_mfma_f32_16x16x32_bf16 v[80:83], a[84:87], v[32:35], v[80:83]
    v_cndmask_b32_e64 v48, v48, v91, s[36:37]
    v_fma_f32 v57, v73, v133, v57
    v_mfma_f32_16x16x32_bf16 v[84:87], v[32:35], a[148:151], v[84:87]
    ds_read_b128 v[32:35], v5 offset:13312
    v_fma_f32 v58, v74, v134, v58
    v_mfma_f32_16x16x32_bf16 v[76:79], a[24:27], v[36:39], v[76:79]
    ds_write_b32 v45, v92 offset:1536
    v_mfma_f32_16x16x32_bf16 v[80:83], a[88:91], v[36:39], v[80:83]
    ds_write_b32 v45, v48 offset:1552
    v_fma_f32 v59, v75, v135, v59
    v_mfma_f32_16x16x32_bf16 v[84:87], v[36:39], a[152:155], v[84:87]
    ds_read_b128 v[36:39], v5 offset:14336
    v_cvt_pk_bf16_f32 v152, v56, v57
    v_mfma_f32_16x16x32_bf16 v[76:79], a[28:31], v[40:43], v[76:79]
    v_cvt_pk_bf16_f32 v153, v58, v59
    v_max3_f32 v98, v158, v159, v160
    s_waitcnt lgkmcnt(7)
    v_mfma_f32_16x16x32_bf16 v[80:83], a[92:95], v[40:43], v[80:83]
    v_max3_f32 v97, v161, v162, v163
    v_max3_f32 v98, v98, v164, v165
    v_mfma_f32_16x16x32_bf16 v[84:87], v[40:43], a[156:159], v[84:87]
    ds_read_b128 v[40:43], v5 offset:15360
    v_max_f32 v98, v98, v97
    v_mfma_f32_16x16x32_bf16 v[76:79], a[32:35], v[12:15], v[76:79]
    v_mov_b32 v97, v98
    v_mfma_f32_16x16x32_bf16 v[80:83], a[96:99], v[12:15], v[80:83]
    s_nop 0
    v_permlane32_swap_b32 v97, v98
    v_max_f32 v98, v98, v97
    v_mfma_f32_16x16x32_bf16 v[84:87], v[12:15], a[160:163], v[84:87]
    v_mov_b32 v97, v98
    s_waitcnt lgkmcnt(2)
    s_waitcnt vmcnt(1)
    s_barrier
    ds_read_b128 v[12:15], v2 offset:16384
    v_mfma_f32_16x16x32_bf16 v[76:79], a[36:39], v[16:19], v[76:79]
    ds_read_b128 v[48:51], v46 offset:1536
    v_mfma_f32_16x16x32_bf16 v[80:83], a[100:103], v[16:19], v[80:83]
    ds_read_b128 v[52:55], v46 offset:1552
    v_mfma_f32_16x16x32_bf16 v[84:87], v[16:19], a[164:167], v[84:87]
    ds_read_b128 v[16:19], v2 offset:17408
    v_permlane16_swap_b32 v97, v98
    v_mfma_f32_16x16x32_bf16 v[76:79], a[40:43], v[20:23], v[76:79]
    v_max_f32 v98, v98, v97
    v_sub_f32 v158, v158, v98
    v_mfma_f32_16x16x32_bf16 v[80:83], a[104:107], v[20:23], v[80:83]
    v_sub_f32 v159, v159, v98
    v_sub_f32 v160, v160, v98
    v_mfma_f32_16x16x32_bf16 v[84:87], v[20:23], a[168:171], v[84:87]
    ds_read_b128 v[20:23], v2 offset:18432
    v_sub_f32 v161, v161, v98
    v_mfma_f32_16x16x32_bf16 v[76:79], a[44:47], v[24:27], v[76:79]
    v_sub_f32 v162, v162, v98
    v_sub_f32 v163, v163, v98
    v_mfma_f32_16x16x32_bf16 v[80:83], a[108:111], v[24:27], v[80:83]
    v_sub_f32 v164, v164, v98
    v_sub_f32 v165, v165, v98
    v_mfma_f32_16x16x32_bf16 v[84:87], v[24:27], a[172:175], v[84:87]
    ds_read_b128 v[24:27], v2 offset:19456
    v_mfma_f32_16x16x32_bf16 v[76:79], a[48:51], v[28:31], v[76:79]
    s_waitcnt lgkmcnt(3)
    v_add_f32 v48, v48, v49
    v_add_f32 v52, v52, v53
    v_add_f32 v50, v50, v51
    v_mfma_f32_16x16x32_bf16 v[80:83], a[112:115], v[28:31], v[80:83]
    v_add_f32 v54, v54, v55
    v_add_f32 v48, v48, v50
    v_mfma_f32_16x16x32_bf16 v[84:87], v[28:31], a[176:179], v[84:87]
    ds_read_b128 v[28:31], v3 offset:16384
    v_add_f32 v52, v52, v54
    v_mfma_f32_16x16x32_bf16 v[76:79], a[52:55], v[32:35], v[76:79]
    v_mul_f32 v48, 0x3b000000, v48
    v_mul_f32 v52, 0x3b000000, v52
    v_mfma_f32_16x16x32_bf16 v[80:83], a[116:119], v[32:35], v[80:83]
    v_fma_f32 v52, -v48, v48, v52
    v_max_f32 v52, 0, v52
    v_mfma_f32_16x16x32_bf16 v[84:87], v[32:35], a[180:183], v[84:87]
    ds_read_b128 v[32:35], v3 offset:17408
    v_add_f32 v52, 0x3727c5ac, v52
    v_mfma_f32_16x16x32_bf16 v[76:79], a[56:59], v[36:39], v[76:79]
    v_rsq_f32 v126, v52
    v_mfma_f32_16x16x32_bf16 v[80:83], a[120:123], v[36:39], v[80:83]
    v_sub_f32 v48, 0, v48
    v_mul_f32 v127, v48, v126
    v_mfma_f32_16x16x32_bf16 v[84:87], v[36:39], a[184:187], v[84:87]
    ds_read_b128 v[36:39], v3 offset:18432
    v_mfma_f32_16x16x32_bf16 v[76:79], a[60:63], v[40:43], v[76:79]
    ds_write_b32 v44, v126
    ds_write_b32 v44, v127 offset:64
    s_waitcnt lgkmcnt(7)
    v_mfma_f32_16x16x32_bf16 v[80:83], a[124:127], v[40:43], v[80:83]
    v_exp_f32 v158, v158
    v_mfma_f32_16x16x32_bf16 v[84:87], v[40:43], a[188:191], v[84:87]
    ds_read_b128 v[40:43], v3 offset:19456
    v_exp_f32 v159, v159
    v_exp_f32 v160, v160
    v_exp_f32 v161, v161
    v_exp_f32 v162, v162
    v_exp_f32 v163, v163
    v_exp_f32 v164, v164
    v_exp_f32 v165, v165
    v_cvt_pk_bf16_f32 v132, v158, v159
    v_cvt_pk_bf16_f32 v133, v160, v161
    v_cvt_pk_bf16_f32 v134, v162, v163
    v_cvt_pk_bf16_f32 v135, v164, v165
    s_nop 1
    v_mfma_f32_16x16x32_bf16 v[158:161], v[150:153], v[132:135], 0
    v_mfma_f32_16x16x32_bf16 v[162:165], v[8:11], v[132:135], 0
    s_nop 7
    v_rcp_f32 v162, v162
    s_add_u32 s47, s26, 2
    s_lshl_b32 s47, s47, 14
    s_add_u32 s47, s47, s54
    v_mul_f32 v158, v158, v162
    v_mul_f32 v159, v159, v162
    v_mul_f32 v160, v160, v162
    v_mul_f32 v161, v161, v162
    v_cvt_pk_bf16_f32 v146, v158, v159
    v_cvt_pk_bf16_f32 v147, v160, v161
    s_cbranch_vccnz L_slow_13
    buffer_store_dwordx2 v[146:147], v96, s[8:11], s47 offen
L_back_13:
    v_mfma_f32_16x16x32_bf16 v[64:67], a[0:3], v[12:15], 0
    v_mfma_f32_16x16x32_bf16 v[68:71], a[64:67], v[12:15], 0
    v_mfma_f32_16x16x32_bf16 v[72:75], v[12:15], a[128:131], 0
    v_mfma_f32_16x16x32_bf16 v[88:91], v[12:15], v[12:15], 0
    v_mfma_f32_16x16x32_bf16 v[92:95], v[8:11], v[12:15], 0
    ds_read_b128 v[12:15], v4 offset:16384
    s_add_u32 s58, s57, s16
    s_add_u32 s58, s58, 1048576
    buffer_load_dwordx4 a[192:195], v1, s[8:11], s58 offen offset:0 sc1
    v_mfma_f32_16x16x32_bf16 v[64:67], a[4:7], v[16:19], v[64:67]
    s_waitcnt lgkmcnt(2)
    ds_read_b128 v[132:135], v47
    ds_read_b128 v[136:139], v47 offset:64
    v_mul_f32 v56, v127, v116
    v_mfma_f32_16x16x32_bf16 v[68:71], a[68:71], v[16:19], v[68:71]
    v_mul_f32 v57, v127, v117
    v_mul_f32 v58, v127, v118
    v_mfma_f32_16x16x32_bf16 v[72:75], v[16:19], a[132:135], v[72:75]
    v_mul_f32 v59, v127, v119
    v_fma_f32 v56, v80, v126, v56
    v_mfma_f32_16x16x32_bf16 v[88:91], v[16:19], v[16:19], v[88:91]
    v_fma_f32 v57, v81, v126, v57
    v_fma_f32 v58, v82, v126, v58
    v_mfma_f32_16x16x32_bf16 v[92:95], v[8:11], v[16:19], v[92:95]
    ds_read_b128 v[16:19], v4 offset:17408
    v_fma_f32 v59, v83, v126, v59
    buffer_load_dwordx4 a[196:199], v1, s[8:11], s58 offen offset:1024 sc1
    v_mfma_f32_16x16x32_bf16 v[64:67], a[8:11], v[20:23], v[64:67]
    v_cvt_pk_bf16_f32 v144, v56, v57
    v_cvt_pk_bf16_f32 v145, v58, v59
    v_mfma_f32_16x16x32_bf16 v[68:71], a[72:75], v[20:23], v[68:71]
    v_mul_f32 v128, 0x3eb8aa3b, v126
    v_mul_f32 v129, 0x3eb8aa3b, v127
    v_mfma_f32_16x16x32_bf16 v[72:75], v[20:23], a[136:139], v[72:75]
    v_mul_f32 v56, v129, v112
    v_mul_f32 v57, v129, v113
    v_mfma_f32_16x16x32_bf16 v[88:91], v[20:23], v[20:23], v[88:91]
    v_mul_f32 v58, v129, v114
    v_mul_f32 v59, v129, v115
    v_mfma_f32_16x16x32_bf16 v[92:95], v[8:11], v[20:23], v[92:95]
    ds_read_b128 v[20:23], v4 offset:18432
    v_fma_f32 v56, v76, v128, v56
    buffer_load_dwordx4 a[200:203], v1, s[8:11], s58 offen offset:2048 sc1
    v_mfma_f32_16x16x32_bf16 v[64:67], a[12:15], v[24:27], v[64:67]
    v_fma_f32 v57, v77, v128, v57
    v_fma_f32 v58, v78, v128, v58
    v_mfma_f32_16x16x32_bf16 v[68:71], a[76:79], v[24:27], v[68:71]
    v_fma_f32 v59, v79, v128, v59
    v_cvt_pk_bf16_f32 v140, v56, v57
    v_mfma_f32_16x16x32_bf16 v[72:75], v[24:27], a[140:143], v[72:75]
    v_cvt_pk_bf16_f32 v141, v58, v59
    v_mfma_f32_16x16x32_bf16 v[88:91], v[24:27], v[24:27], v[88:91]
    s_nop 0
    v_mfma_f32_16x16x16_bf16 v[158:161], v[142:143], v[140:141], v[104:107]
    v_mfma_f32_16x16x32_bf16 v[92:95], v[8:11], v[24:27], v[92:95]
    ds_read_b128 v[24:27], v4 offset:19456
    v_mfma_f32_16x16x16_bf16 v[162:165], v[144:145], v[140:141], v[100:103]
    s_waitcnt lgkmcnt(3)
    buffer_load_dwordx4 a[204:207], v1, s[8:11], s58 offen offset:3072 sc1
    v_mfma_f32_16x16x32_bf16 v[64:67], a[16:19], v[28:31], v[64:67]
    v_mul_f32 v56, v136, v120
    v_mul_f32 v57, v137, v120
    v_mfma_f32_16x16x32_bf16 v[68:71], a[80:83], v[28:31], v[68:71]
    v_mul_f32 v58, v138, v120
    v_mul_f32 v59, v139, v120
    v_mfma_f32_16x16x32_bf16 v[72:75], v[28:31], a[144:147], v[72:75]
    ds_read_b128 v[28:31], v5 offset:16384
    v_fma_f32 v56, v84, v132, v56
    s_add_u32 s58, s57, s17
    s_add_u32 s58, s58, 1048576
    buffer_load_dwordx4 a[208:211], v1, s[8:11], s58 offen offset:0 sc1
    v_mfma_f32_16x16x32_bf16 v[64:67], a[20:23], v[32:35], v[64:67]
    v_cndmask_b32_e64 v48, v88, v89, s[32:33]
    v_cndmask_b32_e64 v48, v48, v90, s[34:35]
    v_mfma_f32_16x16x32_bf16 v[68:71], a[84:87], v[32:35], v[68:71]
    v_cndmask_b32_e64 v48, v48, v91, s[36:37]
    v_fma_f32 v57, v85, v133, v57
    v_mfma_f32_16x16x32_bf16 v[72:75], v[32:35], a[148:151], v[72:75]
    ds_read_b128 v[32:35], v5 offset:17408
    v_fma_f32 v58, v86, v134, v58
    buffer_load_dwordx4 a[212:215], v1, s[8:11], s58 offen offset:1024 sc1
    v_mfma_f32_16x16x32_bf16 v[64:67], a[24:27], v[36:39], v[64:67]
    ds_write_b32 v45, v92 offset:2048
    v_mfma_f32_16x16x32_bf16 v[68:71], a[88:91], v[36:39], v[68:71]
    ds_write_b32 v45, v48 offset:2064
    v_fma_f32 v59, v87, v135, v59
    v_mfma_f32_16x16x32_bf16 v[72:75], v[36:39], a[152:155], v[72:75]
    ds_read_b128 v[36:39], v5 offset:18432
    v_cvt_pk_bf16_f32 v154, v56, v57
    buffer_load_dwordx4 a[216:219], v1, s[8:11], s58 offen offset:2048 sc1
    v_mfma_f32_16x16x32_bf16 v[64:67], a[28:31], v[40:43], v[64:67]
    v_cvt_pk_bf16_f32 v155, v58, v59
    v_max3_f32 v98, v158, v159, v160
    s_waitcnt lgkmcnt(7)
    v_mfma_f32_16x16x32_bf16 v[68:71], a[92:95], v[40:43], v[68:71]
    v_max3_f32 v97, v161, v162, v163
    v_max3_f32 v98, v98, v164, v165
    v_mfma_f32_16x16x32_bf16 v[72:75], v[40:43], a[156:159], v[72:75]
    ds_read_b128 v[40:43], v5 offset:19456
    v_max_f32 v98, v98, v97
    buffer_load_dwordx4 a[220:223], v1, s[8:11], s58 offen offset:3072 sc1
    v_mfma_f32_16x16x32_bf16 v[64:67], a[32:35], v[12:15], v[64:67]
    v_mov_b32 v97, v98
    v_mfma_f32_16x16x32_bf16 v[68:71], a[96:99], v[12:15], v[68:71]
    s_nop 0
    v_permlane32_swap_b32 v97, v98
    v_max_f32 v98, v98, v97
    v_mfma_f32_16x16x32_bf16 v[72:75], v[12:15], a[160:163], v[72:75]
    v_mov_b32 v97, v98
    s_add_u32 s58, s57, s18
    s_add_u32 s58, s58, 1048576
    buffer_load_dwordx4 a[224:227], v1, s[8:11], s58 offen offset:0 sc1
    s_waitcnt lgkmcnt(2)
    s_barrier
    v_mfma_f32_16x16x32_bf16 v[64:67], a[36:39], v[16:19], v[64:67]
    ds_read_b128 v[48:51], v46 offset:2048
    v_mfma_f32_16x16x32_bf16 v[68:71], a[100:103], v[16:19], v[68:71]
    ds_read_b128 v[52:55], v46 offset:2064
    v_mfma_f32_16x16x32_bf16 v[72:75], v[16:19], a[164:167], v[72:75]
    v_permlane16_swap_b32 v97, v98
    v_max_f32 v98, v98, v97
    buffer_load_dwordx4 a[228:231], v1, s[8:11], s58 offen offset:1024 sc1
    v_mfma_f32_16x16x32_bf16 v[64:67], a[40:43], v[20:23], v[64:67]
    v_sub_f32 v158, v158, v98
    v_sub_f32 v159, v159, v98
    v_mfma_f32_16x16x32_bf16 v[68:71], a[104:107], v[20:23], v[68:71]
    v_sub_f32 v160, v160, v98
    v_sub_f32 v161, v161, v98
    v_mfma_f32_16x16x32_bf16 v[72:75], v[20:23], a[168:171], v[72:75]
    v_sub_f32 v162, v162, v98
    v_sub_f32 v163, v163, v98
    buffer_load_dwordx4 a[232:235], v1, s[8:11], s58 offen offset:2048 sc1
    v_mfma_f32_16x16x32_bf16 v[64:67], a[44:47], v[24:27], v[64:67]
    v_sub_f32 v164, v164, v98
    v_sub_f32 v165, v165, v98
    v_mfma_f32_16x16x32_bf16 v[68:71], a[108:111], v[24:27], v[68:71]
    v_exp_f32 v158, v158
    v_mfma_f32_16x16x32_bf16 v[72:75], v[24:27], a[172:175], v[72:75]
    v_exp_f32 v159, v159
    buffer_load_dwordx4 a[236:239], v1, s[8:11], s58 offen offset:3072 sc1
    v_mfma_f32_16x16x32_bf16 v[64:67], a[48:51], v[28:31], v[64:67]
    s_waitcnt lgkmcnt(0)
    v_add_f32 v48, v48, v49
    v_add_f32 v52, v52, v53
    v_mfma_f32_16x16x32_bf16 v[68:71], a[112:115], v[28:31], v[68:71]
    v_add_f32 v50, v50, v51
    v_add_f32 v54, v54, v55
    v_mfma_f32_16x16x32_bf16 v[72:75], v[28:31], a[176:179], v[72:75]
    v_add_f32 v48, v48, v50
    v_add_f32 v52, v52, v54
    s_add_u32 s58, s57, s19
    s_add_u32 s58, s58, 1048576
    buffer_load_dwordx4 a[240:243], v1, s[8:11], s58 offen offset:0 sc1
    v_mfma_f32_16x16x32_bf16 v[64:67], a[52:55], v[32:35], v[64:67]
    v_mul_f32 v48, 0x3b000000, v48
    v_mul_f32 v52, 0x3b000000, v52
    v_mfma_f32_16x16x32_bf16 v[68:71], a[116:119], v[32:35], v[68:71]
    v_fma_f32 v52, -v48, v48, v52
    v_max_f32 v52, 0, v52
    v_mfma_f32_16x16x32_bf16 v[72:75], v[32:35], a[180:183], v[72:75]
    v_add_f32 v52, 0x3727c5ac, v52
    buffer_load_dwordx4 a[244:247], v1, s[8:11], s58 offen offset:1024 sc1
    v_mfma_f32_16x16x32_bf16 v[64:67], a[56:59], v[36:39], v[64:67]
    v_rsq_f32 v124, v52
    v_sub_f32 v48, 0, v48
    v_mfma_f32_16x16x32_bf16 v[68:71], a[120:123], v[36:39], v[68:71]
    v_mul_f32 v125, v48, v124
    v_mfma_f32_16x16x32_bf16 v[72:75], v[36:39], a[184:187], v[72:75]
    ds_write_b32 v44, v124
    ds_write_b32 v44, v125 offset:64
    buffer_load_dwordx4 a[248:251], v1, s[8:11], s58 offen offset:2048 sc1
    v_mfma_f32_16x16x32_bf16 v[64:67], a[60:63], v[40:43], v[64:67]
    v_exp_f32 v160, v160
    v_mfma_f32_16x16x32_bf16 v[68:71], a[124:127], v[40:43], v[68:71]
    v_exp_f32 v161, v161
    v_mfma_f32_16x16x32_bf16 v[72:75], v[40:43], a[188:191], v[72:75]
    v_exp_f32 v162, v162
    buffer_load_dwordx4 a[252:255], v1, s[8:11], s58 offen offset:3072 sc1
    v_exp_f32 v163, v163
    v_exp_f32 v164, v164
    v_exp_f32 v165, v165
    v_cvt_pk_bf16_f32 v132, v158, v159
    v_cvt_pk_bf16_f32 v133, v160, v161
    v_cvt_pk_bf16_f32 v134, v162, v163
    v_cvt_pk_bf16_f32 v135, v164, v165
    s_nop 1
    v_mfma_f32_16x16x32_bf16 v[158:161], v[152:155], v[132:135], 0
    v_mfma_f32_16x16x32_bf16 v[162:165], v[8:11], v[132:135], 0
    s_nop 7
    v_rcp_f32 v162, v162
    s_add_u32 s47, s26, 3
    s_lshl_b32 s47, s47, 14
    s_add_u32 s47, s47, s54
    v_mul_f32 v158, v158, v162
    v_mul_f32 v159, v159, v162
    v_mul_f32 v160, v160, v162
    v_mul_f32 v161, v161, v162
    v_cvt_pk_bf16_f32 v146, v158, v159
    v_cvt_pk_bf16_f32 v147, v160, v161
    s_cbranch_vccnz L_slow_14
    buffer_store_dwordx2 v[146:147], v96, s[8:11], s47 offen
L_back_14:
    s_waitcnt lgkmcnt(0)
    ds_read_b128 v[132:135], v47
    ds_read_b128 v[136:139], v47 offset:64
    v_mul_f32 v56, v125, v116
    v_mul_f32 v57, v125, v117
    v_mul_f32 v58, v125, v118
    v_mul_f32 v59, v125, v119
    v_fma_f32 v56, v68, v124, v56
    v_fma_f32 v57, v69, v124, v57
    v_fma_f32 v58, v70, v124, v58
    v_fma_f32 v59, v71, v124, v59
    v_cvt_pk_bf16_f32 v142, v56, v57
    v_cvt_pk_bf16_f32 v143, v58, v59
    v_mul_f32 v128, 0x3eb8aa3b, v124
    v_mul_f32 v129, 0x3eb8aa3b, v125
    v_mul_f32 v56, v129, v112
    v_mul_f32 v57, v129, v113
    v_mul_f32 v58, v129, v114
    v_mul_f32 v59, v129, v115
    v_fma_f32 v56, v64, v128, v56
    v_fma_f32 v57, v65, v128, v57
    v_fma_f32 v58, v66, v128, v58
    v_fma_f32 v59, v67, v128, v59
    v_cvt_pk_bf16_f32 v140, v56, v57
    v_cvt_pk_bf16_f32 v141, v58, v59
    s_nop 1
    v_mfma_f32_16x16x16_bf16 v[158:161], v[144:145], v[140:141], v[104:107]
    v_mfma_f32_16x16x16_bf16 v[162:165], v[142:143], v[140:141], v[100:103]
    s_waitcnt lgkmcnt(0)
    v_mul_f32 v56, v136, v120
    v_mul_f32 v57, v137, v120
    v_mul_f32 v58, v138, v120
    v_mul_f32 v59, v139, v120
    v_fma_f32 v56, v72, v132, v56
    v_fma_f32 v57, v73, v133, v57
    v_fma_f32 v58, v74, v134, v58
    v_fma_f32 v59, v75, v135, v59
    v_cvt_pk_bf16_f32 v156, v56, v57
    v_cvt_pk_bf16_f32 v157, v58, v59
    v_max3_f32 v98, v158, v159, v160
    v_max3_f32 v97, v161, v162, v163
    v_max3_f32 v98, v98, v164, v165
    v_max_f32 v98, v98, v97
    v_mov_b32 v97, v98
    s_nop 1
    v_permlane32_swap_b32 v97, v98
    v_max_f32 v98, v98, v97
    v_mov_b32 v97, v98
    s_nop 1
    v_permlane16_swap_b32 v97, v98
    v_max_f32 v98, v98, v97
    v_sub_f32 v158, v158, v98
    v_sub_f32 v159, v159, v98
    v_sub_f32 v160, v160, v98
    v_sub_f32 v161, v161, v98
    v_sub_f32 v162, v162, v98
    v_sub_f32 v163, v163, v98
    v_sub_f32 v164, v164, v98
    v_sub_f32 v165, v165, v98
    v_exp_f32 v158, v158
    v_exp_f32 v159, v159
    v_exp_f32 v160, v160
    v_exp_f32 v161, v161
    v_exp_f32 v162, v162
    v_exp_f32 v163, v163
    v_exp_f32 v164, v164
    v_exp_f32 v165, v165
    v_cvt_pk_bf16_f32 v132, v158, v159
    v_cvt_pk_bf16_f32 v133, v160, v161
    v_cvt_pk_bf16_f32 v134, v162, v163
    v_cvt_pk_bf16_f32 v135, v164, v165
    s_nop 1
    v_mfma_f32_16x16x32_bf16 v[158:161], v[154:157], v[132:135], 0
    v_mfma_f32_16x16x32_bf16 v[162:165], v[8:11], v[132:135], 0
    s_nop 7
    v_rcp_f32 v162, v162
    s_add_u32 s47, s26, 4
    s_lshl_b32 s47, s47, 14
    s_add_u32 s47, s47, s54
    v_mul_f32 v158, v158, v162
    v_mul_f32 v159, v159, v162
    v_mul_f32 v160, v160, v162
    v_mul_f32 v161, v161, v162
    v_cvt_pk_bf16_f32 v146, v158, v159
    v_cvt_pk_bf16_f32 v147, v160, v161
    s_cbranch_vccnz L_slow_15
    buffer_store_dwordx2 v[146:147], v96, s[8:11], s47 offen
L_back_15:
    s_waitcnt vmcnt(0)
    s_barrier
    s_cmp_lg_u32 s22, 0
    s_cbranch_scc1 L_np2_interleave_layers__grouped_kv_mqa__sliding_local_dilated__prompt_kernel
    s_lshl_b32 s23, s20, 7
    s_lshl_b32 s28, s21, 3
    s_add_u32 s23, s23, s28
    s_add_u32 s23, s23, s56
    s_add_u32 s23, s23, 8192
    v_mov_b32 v61, 0
    v_mov_b32 v62, s50
    v_mov_b32 v63, s3
    s_mov_b64 vcc, s[40:41]
    s_mov_b64 exec, 1
    s_cbranch_vccnz L_slow_16
    buffer_store_dwordx2 v[62:63], v61, s[8:11], s23 offen
L_back_16:
    s_mov_b64 exec, -1
L_np2_interleave_layers__grouped_kv_mqa__sliding_local_dilated__prompt_kernel:
    v_mov_b32 v44, v99
    s_lshl_b32 s26, s20, 2
    s_mul_i32 s23, s16, 4
    v_add_u32 v2, s23, v1
    s_mul_i32 s23, s17, 4
    v_add_u32 v3, s23, v1
    s_mul_i32 s23, s18, 4
    v_add_u32 v4, s23, v1
    s_mul_i32 s23, s19, 4
    v_add_u32 v5, s23, v1
    v_lshlrev_b32 v64, 16, v246
    v_and_b32 v65, 0xffff0000, v246
    v_lshlrev_b32 v66, 16, v247
    v_and_b32 v67, 0xffff0000, v247
    v_lshlrev_b32 v68, 16, v248
    v_and_b32 v69, 0xffff0000, v248
    v_lshlrev_b32 v70, 16, v249
    v_and_b32 v71, 0xffff0000, v249
    v_lshlrev_b32 v72, 16, v250
    v_and_b32 v73, 0xffff0000, v250
    v_lshlrev_b32 v74, 16, v251
    v_and_b32 v75, 0xffff0000, v251
    v_lshlrev_b32 v76, 16, v252
    v_and_b32 v77, 0xffff0000, v252
    v_lshlrev_b32 v78, 16, v253
    v_and_b32 v79, 0xffff0000, v253
    s_lshl_b32 s23, s21, 7
    s_lshl_b32 s28, s22, 5
    s_add_u32 s23, s23, s28
    v_lshlrev_b32 v45, 10, v6
    v_lshl_add_u32 v45, v7, 3, v45
    v_add_u32 v45, s23, v45
    s_cmp_eq_u32 s55, 0
    s_cselect_b32 s60, s8, s12
    s_cselect_b32 s61, s9, s13
    s_cselect_b32 s62, s10, s14
    s_mov_b32 s63, 0x00020000
    s_cselect_b32 s46, 16777216, 0
    s_cselect_b64 s[28:29], -1, 0
    v_cndmask_b32_e64 v44, v45, v44, s[28:29]
    v_lshrrev_b32 v48, 2, v6
    v_cmp_eq_u32 s[30:31], v48, v7
    v_lshlrev_b32 v143, 5, v6
    s_lshl_b32 s23, s22, 2
    s_add_u32 s23, s23, 155648
    v_add_u32 v143, s23, v143
    v_mov_b32 v48, 158720
    v_cndmask_b32_e64 v143, v48, v143, s[30:31]
    v_lshlrev_b32 v158, 5, v6
    v_add_u32 v158, 155648, v158
    s_lshl_b32 s23, s22, 7
    s_add_u32 s23, s23, 158208
    v_lshlrev_b32 v142, 2, v6
    v_add_u32 v142, s23, v142
    v_lshlrev_b32 v159, 4, v7
    v_add_u32 v159, s23, v159
    s_lshl_b32 s44, s20, 2
    s_lshr_b32 s28, s21, 1
    s_add_u32 s44, s44, s28
    s_bitcmp1_b32 s21, 0
    s_cselect_b64 s[38:39], -1, 0
    v_lshrrev_b32 v48, 1, v7
    v_and_b32 v49, 1, v7
    v_lshlrev_b32 v50, 9, v48
    v_lshl_add_u32 v50, v6, 4, v50
    v_lshl_add_u32 v50, v49, 3, v50
    v_lshlrev_b32 v52, 8, v49
    v_lshl_add_u32 v52, v6, 4, v52
    v_lshl_add_u32 v52, v48, 3, v52
    v_cndmask_b32_e64 v104, v50, v52, s[38:39]
    s_lshl_b32 s23, s22, 11
    s_add_u32 s23, s23, 147456
    v_add_u32 v106, s23, v1
    v_add_u32 v107, 147456, v1
    s_lshr_b32 s23, s44, 1
    s_lshl_b32 s23, s23, 10
    s_and_b32 s28, s44, 1
    s_lshl_b32 s29, s28, 8
    s_add_u32 s29, s29, 3342336
    s_lshl_b32 s28, s28, 9
    s_add_u32 s28, s28, 3407872
    s_bitcmp1_b32 s21, 0
    s_cselect_b32 s28, s28, s29
    s_add_u32 s59, s23, s28
    s_mul_i32 s25, s22, 16384
    s_add_u32 s25, s25, 0
    s_lshl_b32 s24, s22, 12
    s_add_u32 s24, s24, s54
    v_and_b32 v61, 7, v0
    v_lshlrev_b32 v61, 3, v61
    s_lshl_b32 s23, s20, 7
    v_add_u32 v61, s23, v61
    s_add_u32 s45, s56, 8192
    v_add_u32 v61, s45, v61
    buffer_load_dwordx2 v[62:63], v61, s[8:11], 0 offen sc1
    v_mfma_f32_16x16x32_bf16 v[112:115], v[230:233], v[8:11], 0
    v_mfma_f32_16x16x32_bf16 v[116:119], v[8:11], v[230:233], 0
    v_mfma_f32_16x16x32_bf16 v[112:115], v[234:237], v[8:11], v[112:115]
    v_mfma_f32_16x16x32_bf16 v[116:119], v[8:11], v[234:237], v[116:119]
    v_mfma_f32_16x16x32_bf16 v[112:115], v[238:241], v[8:11], v[112:115]
    v_mfma_f32_16x16x32_bf16 v[116:119], v[8:11], v[238:241], v[116:119]
    v_mfma_f32_16x16x32_bf16 v[112:115], v[242:245], v[8:11], v[112:115]
    v_mfma_f32_16x16x32_bf16 v[116:119], v[8:11], v[242:245], v[116:119]
    s_nop 7
    v_cndmask_b32_e64 v112, v112, v116, s[38:39]
    v_cndmask_b32_e64 v113, v113, v116, s[38:39]
    v_cndmask_b32_e64 v114, v114, v116, s[38:39]
    v_cndmask_b32_e64 v115, v115, v116, s[38:39]
    ds_write_b128 v106, v[112:115] offset:1024
    s_waitcnt vmcnt(0)
    v_cmp_ne_u32 vcc, s50, v62
    v_cmp_ne_u32 s[28:29], s3, v63
    s_nop 0
    s_or_b64 vcc, vcc, s[28:29]
    s_cbranch_vccz L_seen2_interleave_layers__grouped_kv_mqa__sliding_local_dilated__prompt_kernel_3
    s_mov_b32 s45, 0x10000
L_poll2_interleave_layers__grouped_kv_mqa__sliding_local_dilated__prompt_kernel_3:
    buffer_load_dwordx2 v[62:63], v61, s[8:11], 0 offen sc1
    s_waitcnt vmcnt(0)
    v_cmp_ne_u32 vcc, s50, v62
    v_cmp_ne_u32 s[28:29], s3, v63
    s_nop 0
    s_or_b64 vcc, vcc, s[28:29]
    s_sub_u32 s45, s45, 1
    s_cmp_eq_u32 s45, 0
    s_cbranch_scc1 L_poll2_interleave_layers__grouped_kv_mqa__sliding_local_dilated__prompt_kernel_3_d
    s_cbranch_vccnz L_poll2_interleave_layers__grouped_kv_mqa__sliding_local_dilated__prompt_kernel_3
L_poll2_interleave_layers__grouped_kv_mqa__sliding_local_dilated__prompt_kernel_3_d:
L_seen2_interleave_layers__grouped_kv_mqa__sliding_local_dilated__prompt_kernel_3:
    s_mov_b64 vcc, s[40:41]
    s_add_u32 s23, s26, 0
    s_lshl_b32 s23, s23, 14
    s_add_u32 s27, s23, s24
    s_add_u32 m0, s25, 0
    s_nop 0
    buffer_load_dwordx4 v1, s[8:11], s27 offen offset:0 sc1 lds
    buffer_load_dwordx4 v1, s[8:11], s27 offen offset:1024 sc1 lds
    buffer_load_dwordx4 v1, s[8:11], s27 offen offset:2048 sc1 lds
    buffer_load_dwordx4 v1, s[8:11], s27 offen offset:3072 sc1 lds
    s_barrier
    s_add_u32 s23, s26, 1
    s_lshl_b32 s23, s23, 14
    s_add_u32 s27, s23, s24
    s_add_u32 m0, s25, 4096
    s_nop 0
    buffer_load_dwordx4 v1, s[8:11], s27 offen offset:0 sc1 lds
    buffer_load_dwordx4 v1, s[8:11], s27 offen offset:1024 sc1 lds
    buffer_load_dwordx4 v1, s[8:11], s27 offen offset:2048 sc1 lds
    buffer_load_dwordx4 v1, s[8:11], s27 offen offset:3072 sc1 lds
    s_barrier
    s_add_u32 s23, s26, 2
    s_lshl_b32 s23, s23, 14
    s_add_u32 s27, s23, s24
    s_add_u32 m0, s25, 8192
    s_nop 0
    buffer_load_dwordx4 v1, s[8:11], s27 offen offset:0 sc1 lds
    buffer_load_dwordx4 v1, s[8:11], s27 offen offset:1024 sc1 lds
    buffer_load_dwordx4 v1, s[8:11], s27 offen offset:2048 sc1 lds
    buffer_load_dwordx4 v1, s[8:11], s27 offen offset:3072 sc1 lds
    s_waitcnt vmcnt(8)
    s_barrier
    ds_read_b128 v[12:15], v2 offset:0
    ds_read_b128 v[16:19], v2 offset:1024
    ds_read_b128 v[20:23], v2 offset:2048
    ds_read_b128 v[24:27], v2 offset:3072
    ds_read_b128 v[28:31], v3 offset:0
    ds_read_b128 v[32:35], v3 offset:1024
    ds_read_b128 v[36:39], v3 offset:2048
    ds_read_b128 v[40:43], v3 offset:3072
    s_waitcnt lgkmcnt(6)
    v_mfma_f32_16x16x32_bf16 v[64:67], a[192:195], v[12:15], v[64:67]
    ds_read_b128 v[12:15], v4 offset:0
    s_add_u32 s23, s26, 3
    s_lshl_b32 s23, s23, 14
    s_add_u32 s27, s23, s24
    s_add_u32 m0, s25, 12288
    s_nop 0
    buffer_load_dwordx4 v1, s[8:11], s27 offen offset:0 sc1 lds
    v_mfma_f32_16x16x32_bf16 v[64:67], a[196:199], v[16:19], v[64:67]
    ds_read_b128 v[16:19], v4 offset:1024
    buffer_load_dwordx4 v1, s[8:11], s27 offen offset:1024 sc1 lds
    s_waitcnt lgkmcnt(6)
    v_mfma_f32_16x16x32_bf16 v[64:67], a[200:203], v[20:23], v[64:67]
    ds_read_b128 v[20:23], v4 offset:2048
    buffer_load_dwordx4 v1, s[8:11], s27 offen offset:2048 sc1 lds
    v_mfma_f32_16x16x32_bf16 v[64:67], a[204:207], v[24:27], v[64:67]
    ds_read_b128 v[24:27], v4 offset:3072
    buffer_load_dwordx4 v1, s[8:11], s27 offen offset:3072 sc1 lds
    s_waitcnt lgkmcnt(6)
    v_mfma_f32_16x16x32_bf16 v[64:67], a[208:211], v[28:31], v[64:67]
    ds_read_b128 v[28:31], v5 offset:0
    v_mfma_f32_16x16x32_bf16 v[64:67], a[212:215], v[32:35], v[64:67]
    ds_read_b128 v[32:35], v5 offset:1024
    s_waitcnt lgkmcnt(6)
    v_mfma_f32_16x16x32_bf16 v[64:67], a[216:219], v[36:39], v[64:67]
    ds_read_b128 v[36:39], v5 offset:2048
    v_mfma_f32_16x16x32_bf16 v[64:67], a[220:223], v[40:43], v[64:67]
    ds_read_b128 v[40:43], v5 offset:3072
    s_waitcnt lgkmcnt(6)
    v_mfma_f32_16x16x32_bf16 v[64:67], a[224:227], v[12:15], v[64:67]
    s_waitcnt vmcnt(8)
    s_barrier
    ds_read_b128 v[12:15], v2 offset:4096
    v_mfma_f32_16x16x32_bf16 v[64:67], a[228:231], v[16:19], v[64:67]
    ds_read_b128 v[16:19], v2 offset:5120
    s_waitcnt lgkmcnt(6)
    v_mfma_f32_16x16x32_bf16 v[64:67], a[232:235], v[20:23], v[64:67]
    ds_read_b128 v[20:23], v2 offset:6144
    v_mfma_f32_16x16x32_bf16 v[64:67], a[236:239], v[24:27], v[64:67]
    ds_read_b128 v[24:27], v2 offset:7168
    s_waitcnt lgkmcnt(6)
    v_mfma_f32_16x16x32_bf16 v[64:67], a[240:243], v[28:31], v[64:67]
    ds_read_b128 v[28:31], v3 offset:4096
    v_mfma_f32_16x16x32_bf16 v[64:67], a[244:247], v[32:35], v[64:67]
    ds_read_b128 v[32:35], v3 offset:5120
    s_waitcnt lgkmcnt(6)
    v_mfma_f32_16x16x32_bf16 v[64:67], a[248:251], v[36:39], v[64:67]
    ds_read_b128 v[36:39], v3 offset:6144
    v_mfma_f32_16x16x32_bf16 v[64:67], a[252:255], v[40:43], v[64:67]
    ds_read_b128 v[40:43], v3 offset:7168
    s_waitcnt lgkmcnt(6)
    v_mfma_f32_16x16x32_bf16 v[68:71], a[192:195], v[12:15], v[68:71]
    ds_read_b128 v[12:15], v4 offset:4096
    v_mfma_f32_16x16x32_bf16 v[68:71], a[196:199], v[16:19], v[68:71]
    ds_read_b128 v[16:19], v4 offset:5120
    s_waitcnt lgkmcnt(6)
    v_mfma_f32_16x16x32_bf16 v[68:71], a[200:203], v[20:23], v[68:71]
    ds_read_b128 v[20:23], v4 offset:6144
    v_mfma_f32_16x16x32_bf16 v[68:71], a[204:207], v[24:27], v[68:71]
    ds_read_b128 v[24:27], v4 offset:7168
    v_cvt_pk_bf16_f32 v88, v64, v65
    v_cvt_pk_bf16_f32 v89, v66, v67
    s_add_u32 s47, s26, 0
    s_lshl_b32 s47, s47, 14
    s_waitcnt lgkmcnt(6)
    v_mfma_f32_16x16x32_bf16 v[68:71], a[208:211], v[28:31], v[68:71]
    ds_read_b128 v[28:31], v5 offset:4096
    s_add_u32 s47, s47, s46
    v_mfma_f32_16x16x32_bf16 v[68:71], a[212:215], v[32:35], v[68:71]
    ds_read_b128 v[32:35], v5 offset:5120
    s_waitcnt lgkmcnt(6)
    v_mfma_f32_16x16x32_bf16 v[68:71], a[216:219], v[36:39], v[68:71]
    ds_read_b128 v[36:39], v5 offset:6144
    v_mfma_f32_16x16x32_bf16 v[68:71], a[220:223], v[40:43], v[68:71]
    ds_read_b128 v[40:43], v5 offset:7168
    s_cbranch_vccnz L_slow_17
    buffer_store_dwordx2 v[88:89], v44, s[60:63], s47 offen
L_back_17:
    s_waitcnt lgkmcnt(6)
    v_mfma_f32_16x16x32_bf16 v[68:71], a[224:227], v[12:15], v[68:71]
    s_waitcnt vmcnt(5)
    s_barrier
    ds_read_b128 v[12:15], v2 offset:8192
    v_mfma_f32_16x16x32_bf16 v[68:71], a[228:231], v[16:19], v[68:71]
    ds_read_b128 v[16:19], v2 offset:9216
    s_waitcnt lgkmcnt(6)
    v_mfma_f32_16x16x32_bf16 v[68:71], a[232:235], v[20:23], v[68:71]
    ds_read_b128 v[20:23], v2 offset:10240
    v_mfma_f32_16x16x32_bf16 v[68:71], a[236:239], v[24:27], v[68:71]
    ds_read_b128 v[24:27], v2 offset:11264
    s_waitcnt lgkmcnt(6)
    v_mfma_f32_16x16x32_bf16 v[68:71], a[240:243], v[28:31], v[68:71]
    ds_read_b128 v[28:31], v3 offset:8192
    v_mfma_f32_16x16x32_bf16 v[68:71], a[244:247], v[32:35], v[68:71]
    ds_read_b128 v[32:35], v3 offset:9216
    s_waitcnt lgkmcnt(6)
    v_mfma_f32_16x16x32_bf16 v[68:71], a[248:251], v[36:39], v[68:71]
    ds_read_b128 v[36:39], v3 offset:10240
    v_mfma_f32_16x16x32_bf16 v[68:71], a[252:255], v[40:43], v[68:71]
    ds_read_b128 v[40:43], v3 offset:11264
    s_waitcnt lgkmcnt(6)
    v_mfma_f32_16x16x32_bf16 v[72:75], a[192:195], v[12:15], v[72:75]
    ds_read_b128 v[12:15], v4 offset:8192
    v_mfma_f32_16x16x32_bf16 v[72:75], a[196:199], v[16:19], v[72:75]
    ds_read_b128 v[16:19], v4 offset:9216
    s_waitcnt lgkmcnt(6)
    v_mfma_f32_16x16x32_bf16 v[72:75], a[200:203], v[20:23], v[72:75]
    ds_read_b128 v[20:23], v4 offset:10240
    v_mfma_f32_16x16x32_bf16 v[72:75], a[204:207], v[24:27], v[72:75]
    ds_read_b128 v[24:27], v4 offset:11264
    v_cvt_pk_bf16_f32 v90, v68, v69
    v_cvt_pk_bf16_f32 v91, v70, v71
    s_add_u32 s47, s26, 1
    s_lshl_b32 s47, s47, 14
    s_waitcnt lgkmcnt(6)
    v_mfma_f32_16x16x32_bf16 v[72:75], a[208:211], v[28:31], v[72:75]
    ds_read_b128 v[28:31], v5 offset:8192
    s_add_u32 s47, s47, s46
    v_mfma_f32_16x16x32_bf16 v[72:75], a[212:215], v[32:35], v[72:75]
    ds_read_b128 v[32:35], v5 offset:9216
    s_waitcnt lgkmcnt(6)
    v_mfma_f32_16x16x32_bf16 v[72:75], a[216:219], v[36:39], v[72:75]
    ds_read_b128 v[36:39], v5 offset:10240
    v_mfma_f32_16x16x32_bf16 v[72:75], a[220:223], v[40:43], v[72:75]
    ds_read_b128 v[40:43], v5 offset:11264
    s_cbranch_vccnz L_slow_18
    buffer_store_dwordx2 v[90:91], v44, s[60:63], s47 offen
L_back_18:
    s_waitcnt lgkmcnt(6)
    v_mfma_f32_16x16x32_bf16 v[72:75], a[224:227], v[12:15], v[72:75]
    s_waitcnt vmcnt(2)
    s_barrier
    ds_read_b128 v[12:15], v2 offset:12288
    v_mfma_f32_16x16x32_bf16 v[72:75], a[228:231], v[16:19], v[72:75]
    ds_read_b128 v[16:19], v2 offset:13312
    s_waitcnt lgkmcnt(6)
    v_mfma_f32_16x16x32_bf16 v[72:75], a[232:235], v[20:23], v[72:75]
    ds_read_b128 v[20:23], v2 offset:14336
    v_mfma_f32_16x16x32_bf16 v[72:75], a[236:239], v[24:27], v[72:75]
    ds_read_b128 v[24:27], v2 offset:15360
    s_waitcnt lgkmcnt(6)
    v_mfma_f32_16x16x32_bf16 v[72:75], a[240:243], v[28:31], v[72:75]
    ds_read_b128 v[28:31], v3 offset:12288
    v_mfma_f32_16x16x32_bf16 v[72:75], a[244:247], v[32:35], v[72:75]
    ds_read_b128 v[32:35], v3 offset:13312
    s_waitcnt lgkmcnt(6)
    v_mfma_f32_16x16x32_bf16 v[72:75], a[248:251], v[36:39], v[72:75]
    ds_read_b128 v[36:39], v3 offset:14336
    v_mfma_f32_16x16x32_bf16 v[72:75], a[252:255], v[40:43], v[72:75]
    ds_read_b128 v[40:43], v3 offset:15360
    s_waitcnt lgkmcnt(6)
    v_mfma_f32_16x16x32_bf16 v[76:79], a[192:195], v[12:15], v[76:79]
    ds_read_b128 v[12:15], v4 offset:12288
    v_mfma_f32_16x16x32_bf16 v[76:79], a[196:199], v[16:19], v[76:79]
    ds_read_b128 v[16:19], v4 offset:13312
    s_waitcnt lgkmcnt(6)
    v_mfma_f32_16x16x32_bf16 v[76:79], a[200:203], v[20:23], v[76:79]
    ds_read_b128 v[20:23], v4 offset:14336
    v_mfma_f32_16x16x32_bf16 v[76:79], a[204:207], v[24:27], v[76:79]
    ds_read_b128 v[24:27], v4 offset:15360
    v_cvt_pk_bf16_f32 v92, v72, v73
    v_cvt_pk_bf16_f32 v93, v74, v75
    s_add_u32 s47, s26, 2
    s_lshl_b32 s47, s47, 14
    s_waitcnt lgkmcnt(6)
    v_mfma_f32_16x16x32_bf16 v[76:79], a[208:211], v[28:31], v[76:79]
    ds_read_b128 v[28:31], v5 offset:12288
    s_add_u32 s47, s47, s46
    v_mfma_f32_16x16x32_bf16 v[76:79], a[212:215], v[32:35], v[76:79]
    ds_read_b128 v[32:35], v5 offset:13312
    s_waitcnt lgkmcnt(6)
    v_mfma_f32_16x16x32_bf16 v[76:79], a[216:219], v[36:39], v[76:79]
    ds_read_b128 v[36:39], v5 offset:14336
    v_mfma_f32_16x16x32_bf16 v[76:79], a[220:223], v[40:43], v[76:79]
    ds_read_b128 v[40:43], v5 offset:15360
    s_cbranch_vccnz L_slow_19
    buffer_store_dwordx2 v[92:93], v44, s[60:63], s47 offen
L_back_19:
    s_waitcnt lgkmcnt(6)
    v_mfma_f32_16x16x32_bf16 v[76:79], a[224:227], v[12:15], v[76:79]
    v_mfma_f32_16x16x32_bf16 v[76:79], a[228:231], v[16:19], v[76:79]
    s_waitcnt lgkmcnt(4)
    v_mfma_f32_16x16x32_bf16 v[76:79], a[232:235], v[20:23], v[76:79]
    v_mfma_f32_16x16x32_bf16 v[76:79], a[236:239], v[24:27], v[76:79]
    s_waitcnt lgkmcnt(2)
    v_mfma_f32_16x16x32_bf16 v[76:79], a[240:243], v[28:31], v[76:79]
    v_mfma_f32_16x16x32_bf16 v[76:79], a[244:247], v[32:35], v[76:79]
    s_waitcnt lgkmcnt(0)
    v_mfma_f32_16x16x32_bf16 v[76:79], a[248:251], v[36:39], v[76:79]
    v_mfma_f32_16x16x32_bf16 v[76:79], a[252:255], v[40:43], v[76:79]
    s_nop 7
    v_cvt_pk_bf16_f32 v94, v76, v77
    v_cvt_pk_bf16_f32 v95, v78, v79
    s_add_u32 s47, s26, 3
    s_lshl_b32 s47, s47, 14
    s_add_u32 s47, s47, s46
    s_cbranch_vccnz L_slow_20
    buffer_store_dwordx2 v[94:95], v44, s[60:63], s47 offen
L_back_20:
    s_cmp_eq_u32 s55, 0
    s_cbranch_scc1 L_layer1
L_fin:
    s_or_b32 s23, s2, s22
    s_cmp_lg_u32 s23, 0
    s_cbranch_scc1 L_noep
    s_add_u32 s28, s100, 1
    s_addc_u32 s29, s101, 0
    v_mov_b32 v2, s28
    v_mov_b32 v3, s29
    v_mov_b32 v4, 0
    s_mov_b32 s23, 26316800
    s_mov_b64 exec, 1
    buffer_store_dwordx2 v[2:3], v4, s[8:11], s23 offen
    s_mov_b64 exec, -1
L_noep:
    s_waitcnt vmcnt(0)
    s_endpgm
L_slow_0:
    buffer_store_dwordx2 v[62:63], v61, s[8:11], s23 offen sc1
    s_branch L_back_0
L_slow_1:
    buffer_store_dwordx2 v[16:17], v9, s[8:11], s23 offen sc1
    s_branch L_back_1
L_slow_2:
    buffer_store_dwordx2 v[18:19], v9, s[8:11], s23 offen offset:256 sc1
    s_branch L_back_2
L_slow_3:
    buffer_store_dwordx2 v[20:21], v9, s[8:11], s23 offen sc1
    s_branch L_back_3
L_slow_4:
    buffer_store_dwordx2 v[22:23], v9, s[8:11], s23 offen offset:256 sc1
    s_branch L_back_4
L_slow_5:
    buffer_store_dwordx2 v[62:63], v61, s[8:11], s23 offen sc1
    s_branch L_back_5
L_slow_6:
    buffer_store_dwordx2 v[252:253], v44, s[8:11], s47 offen sc1
    s_branch L_back_6
L_slow_7:
    buffer_store_dwordx2 v[246:247], v44, s[8:11], s47 offen sc1
    s_branch L_back_7
L_slow_8:
    buffer_store_dwordx2 v[248:249], v44, s[8:11], s47 offen sc1
    s_branch L_back_8
L_slow_9:
    buffer_store_dwordx2 v[250:251], v44, s[8:11], s47 offen sc1
    s_branch L_back_9
L_slow_10:
    buffer_store_dwordx2 v[62:63], v61, s[8:11], s23 offen sc1
    s_branch L_back_10
L_slow_11:
    buffer_store_dwordx2 v[62:63], v61, s[8:11], s23 offen sc1
    s_branch L_back_11
L_slow_12:
    buffer_store_dwordx2 v[146:147], v96, s[8:11], s47 offen sc1
    s_branch L_back_12
L_slow_13:
    buffer_store_dwordx2 v[146:147], v96, s[8:11], s47 offen sc1
    s_branch L_back_13
L_slow_14:
    buffer_store_dwordx2 v[146:147], v96, s[8:11], s47 offen sc1
    s_branch L_back_14
L_slow_15:
    buffer_store_dwordx2 v[146:147], v96, s[8:11], s47 offen sc1
    s_branch L_back_15
L_slow_16:
    buffer_store_dwordx2 v[62:63], v61, s[8:11], s23 offen sc1
    s_branch L_back_16
L_slow_17:
    buffer_store_dwordx2 v[88:89], v44, s[60:63], s47 offen sc1
    s_branch L_back_17
L_slow_18:
    buffer_store_dwordx2 v[90:91], v44, s[60:63], s47 offen sc1
    s_branch L_back_18
L_slow_19:
    buffer_store_dwordx2 v[92:93], v44, s[60:63], s47 offen sc1
    s_branch L_back_19
L_slow_20:
    buffer_store_dwordx2 v[94:95], v44, s[60:63], s47 offen sc1
    s_branch L_back_20
L_code_end:
L_end_interleave_layers__grouped_kv_mqa__sliding_local_dilated__prompt_kernel:
    s_endpgm
.section .rodata,"a"
.p2align 6
.amdhsa_kernel interleave_layers__grouped_kv_mqa__sliding_local_dilated__prompt_kernel
  .amdhsa_next_free_vgpr 512
  .amdhsa_next_free_sgpr 102
  .amdhsa_accum_offset 256
  .amdhsa_group_segment_fixed_size 0
  .amdhsa_kernarg_size 88
  .amdhsa_user_sgpr_count 2
  .amdhsa_user_sgpr_kernarg_segment_ptr 1
  .amdhsa_system_sgpr_workgroup_id_x 1
  .amdhsa_float_denorm_mode_32 3
.end_amdhsa_kernel
```
